```python
import torch

def _softmax(x, axis=-1):
    return torch.softmax(x, dim=axis)
def _gelu(x):
    return torch.nn.functional.gelu(x, approximate="tanh")
def _silu(x):
    return torch.nn.functional.silu(x)
def _sigmoid(x):
    return torch.sigmoid(x)
def _layernorm(x, axis=-1, eps=1e-5):
    m = x.mean(dim=axis, keepdim=True)
    v = x.var(dim=axis, keepdim=True, unbiased=False)
    return (x - m) / torch.sqrt(v + eps)
def _scatter_add(tgt, idx, src, axis=0):
    return tgt.clone().index_add_(axis, idx, src)
def _segment_sum(src, seg, n):
    out = torch.zeros((n,) + src.shape[1:], dtype=src.dtype)
    return out.index_add_(0, seg, src)
def _pad(x, pw):
    flat = tuple(v for pair in reversed(pw) for v in pair)
    return torch.nn.functional.pad(x, flat)

kernel_name = 'sequential_preLN__grouped_kv_mqa__swiglu_ffn__prompt'

def setup_inputs():

    _w = (lambda a: (lambda t: t.to(torch.bfloat16) if t.is_floating_point() else t)(torch.as_tensor(a)))
    def _A_setup():
        B, S, D, H = 1, 2048, 640, 32
        Dh = D // H
        return {
            "x": _w((lambda *s: torch.randn(*s, dtype=torch.bfloat16) * 0.05)(B, S, D)),
            "wq": _w((lambda *s: torch.randn(*s, dtype=torch.bfloat16) * 0.05)(D, H * Dh)),
            "wk": _w((lambda *s: torch.randn(*s, dtype=torch.bfloat16) * 0.05)(D, Dh)),
            "wv": _w((lambda *s: torch.randn(*s, dtype=torch.bfloat16) * 0.05)(D, Dh)),
            "wo": _w((lambda *s: torch.randn(*s, dtype=torch.bfloat16) * 0.05)(H * Dh, D)),
        }
    _A_in = _A_setup()

    def _B_setup():
        B, S, D, F = 1, 2048, 640, 1536
        return {
            "x": _w((lambda *s: torch.randn(*s, dtype=torch.bfloat16) * 0.05)(B, S, D)),
            "w_gate": _w((lambda *s: torch.randn(*s, dtype=torch.bfloat16) * 0.05)(D, F)),
            "w_up": _w((lambda *s: torch.randn(*s, dtype=torch.bfloat16) * 0.05)(D, F)),
            "w_down": _w((lambda *s: torch.randn(*s, dtype=torch.bfloat16) * 0.05)(F, D)),
        }
    _B_in = _B_setup()

    return {
        "A_x": _A_in["x"],
        "A_wq": _A_in["wq"],
        "A_wk": _A_in["wk"],
        "A_wv": _A_in["wv"],
        "A_wo": _A_in["wo"],
        "B_x": _B_in["x"],
        "B_w_gate": _B_in["w_gate"],
        "B_w_up": _B_in["w_up"],
        "B_w_down": _B_in["w_down"],
    }

def reference(A_x, A_wq, A_wk, A_wv, A_wo, B_x, B_w_gate, B_w_up, B_w_down):
    def _A_ref(x, wq, wk, wv, wo):
        B, S, D = x.shape
        H = 32
        Dh = D // H
        q = (lambda x, *d: x.permute(*d))((x @ wq).reshape(B, S, H, Dh), 0, 2, 1, 3)
        k = x @ wk
        v = x @ wv
        scores = torch.einsum("bhqd,bkd->bhqk", q, k) * (Dh ** -0.5)
        p = _softmax(scores, axis=-1)
        o = torch.einsum("bhqk,bkd->bhqd", p, v)
        return (lambda x, *d: x.permute(*d))(o, 0, 2, 1, 3).reshape(B, S, H * Dh) @ wo

    def _B_ref(x, w_gate, w_up, w_down):
        g = _silu(x @ w_gate)
        u = x @ w_up
        return (g * u) @ w_down

    x = A_x
    h = x + _A_ref(_layernorm(x, axis=-1), A_wq, A_wk, A_wv, A_wo)
    h2 = h + _B_ref(_layernorm(h, axis=-1), B_w_gate, B_w_up, B_w_down)
    return h2
```

```asm
; @launch grid=(256,1,1) block=(256,1,1) lds=163840
.amdgcn_target "amdgcn-amd-amdhsa--gfx950"
.text
.globl sequential_preLN__grouped_kv_mqa__swiglu_ffn__prompt_kernel
.p2align 8
.type sequential_preLN__grouped_kv_mqa__swiglu_ffn__prompt_kernel,@function
sequential_preLN__grouped_kv_mqa__swiglu_ffn__prompt_kernel:
    s_load_dwordx16 s[4:19], s[0:1], 0
    s_load_dwordx8 s[20:27], s[0:1], 64
    s_cmpk_ge_u32 s2, 256
    s_cbranch_scc1 L_end
    s_getpc_b64 s[78:79]
L_pc0:
    s_lshr_b32 s77, s2, 3
    s_mulk_i32 s77, 1536
    v_min_u32 v46, 11, v0
    v_lshl_add_u32 v46, v46, 7, s77
    v_min_u32 v46, L_codeend-L_pc0-4, v46
    global_load_dword v46, v46, s[78:79]
    v_lshrrev_b32 v16, 6, v0
    v_and_b32 v0, 63, v0
    v_readfirstlane_b32 s56, v16
    v_lshrrev_b32 v19, 3, v0
    v_xor_b32 v20, v0, v19
    v_and_b32 v20, 7, v20
    v_mul_u32_u24 v18, 1280, v19
    v_lshl_add_u32 v18, v20, 4, v18
    s_bfe_u32 s57, s2, 0x30003
    s_lshr_b32 s74, s2, 6
    s_and_b32 s75, s2, 7
    s_lshl2_add_u32 s59, s75, s74
    s_mul_i32 s73, s56, 20480
    s_lshl2_add_u32 s75, s59, s56
    s_mulk_i32 s75, 20480
    s_and_b32 s62, s57, 1
    s_and_b32 s74, s57, 3
    s_mulk_i32 s74, 5120
    s_add_u32 m0, s73, s74
    s_mulk_i32 s62, 4480
    s_add_u32 s74, s75, s74
    s_sub_u32 s74, s74, s62
    s_lshl_b32 s30, 5, 19
    s_lshl_b32 s31, 1, 17
    s_waitcnt lgkmcnt(0)
    s_mov_b64 s[28:29], s[4:5]
    buffer_load_dwordx4 v18, s[28:31], s74 offen lds
    s_addk_i32 m0, 896
    s_lshr_b32 s72, s2, 5
    buffer_load_dwordx4 v18, s[28:31], s74 offen offset:128 lds
    s_addk_i32 m0, 896
    s_and_b32 s78, s57, 1
    buffer_load_dwordx4 v18, s[28:31], s74 offen offset:256 lds
    s_addk_i32 m0, 896
    s_lshl1_add_u32 s72, s72, s78
    buffer_load_dwordx4 v18, s[28:31], s74 offen offset:384 lds
    s_addk_i32 m0, 896
    s_lshl2_add_u32 s72, s72, s56
    buffer_load_dwordx4 v18, s[28:31], s74 offen offset:512 lds
    s_movk_i32 s38, 25600
    s_mov_b32 s39, 0x20000
    s_bitcmp1_b32 s57, 1
    s_cselect_b64 s[36:37], s[10:11], s[8:9]
    s_lshl_b32 s72, s72, 9
    v_min_u32 v44, 3, v0
    v_lshlrev_b32 v44, 7, v44
    buffer_load_dword v46, v44, s[36:39], s72 offen
    s_lshl2_add_u32 s76, s2, s56
    s_mul_i32 s76, s76, 7
    v_min_u32 v47, 6, v0
    v_add_u32 v47, s76, v47
    v_min_u32 v47, 6399, v47
    v_lshlrev_b32 v47, 7, v47
    global_load_dword v47, v47, s[6:7]
    s_add_u32 s26, s26, 0x3ffff
    s_addc_u32 s27, s27, 0
    s_andn2_b32 s26, s26, 0x3ffff
    s_add_u32 s76, s26, 0x2000000
    s_cmov_b32 s26, 0
    s_addc_u32 s27, s27, 0
    s_load_dword s60, s[26:27], 0
    v_lshlrev_b32 v1, 4, v0
    s_bfe_u32 s61, s2, 0x40003
    s_and_b32 s58, s59, 1
    s_xor_b32 s74, s57, 1
    s_and_b32 s62, s74, 1
    s_and_b32 s74, s74, 3
    s_mulk_i32 s74, 5120
    s_add_u32 m0, s73, s74
    s_mulk_i32 s62, 4480
    s_add_u32 s74, s75, s74
    s_sub_u32 s74, s74, s62
    buffer_load_dwordx4 v18, s[28:31], s74 offen lds
    s_addk_i32 m0, 896
    s_nop 0
    buffer_load_dwordx4 v18, s[28:31], s74 offen offset:128 lds
    s_addk_i32 m0, 896
    s_nop 0
    buffer_load_dwordx4 v18, s[28:31], s74 offen offset:256 lds
    v_and_b32 v16, 15, v0
    v_lshrrev_b32 v17, 4, v0
    v_and_b32 v26, 7, v0
    v_xor_b32 v27, v26, v17
    v_lshlrev_b32 v27, 4, v27
    v_lshl_add_u32 v27, v26, 7, v27
    v_bfe_u32 v26, v0, 3, 1
    v_mul_u32_u24 v234, 10240, v26
    v_add3_u32 v234, v234, v27, s73
    v_xor_b32 v235, 64, v234
    s_movk_i32 s77, 1280
    s_movk_i32 s5, -160
    v_mul_u32_u24 v26, 6554, v0
    v_lshrrev_b32 v27, 16, v26
    v_lshrrev_b32 v28, 17, v26
    v_and_b32 v28, 4, v28
    v_xor_b32 v28, v27, v28
    v_mad_u32_u24 v28, v28, s77, v1
    v_mad_i32_i24 v2, v27, s5, v28
    v_add_u32 v26, 419456, v26
    v_lshrrev_b32 v27, 16, v26
    v_lshrrev_b32 v28, 17, v26
    v_and_b32 v28, 4, v28
    v_xor_b32 v28, v27, v28
    v_mad_u32_u24 v28, v28, s77, v1
    v_mad_i32_i24 v3, v27, s5, v28
    v_add_u32 v26, 419456, v26
    v_lshrrev_b32 v27, 16, v26
    v_lshrrev_b32 v28, 17, v26
    v_and_b32 v28, 4, v28
    v_xor_b32 v28, v27, v28
    v_mad_u32_u24 v28, v28, s77, v1
    v_mad_i32_i24 v4, v27, s5, v28
    v_add_u32 v26, 419456, v26
    v_lshrrev_b32 v27, 16, v26
    v_lshrrev_b32 v28, 17, v26
    v_and_b32 v28, 4, v28
    v_xor_b32 v28, v27, v28
    v_mad_u32_u24 v28, v28, s77, v1
    v_mad_i32_i24 v5, v27, s5, v28
    v_add_u32 v26, 419456, v26
    v_lshrrev_b32 v27, 16, v26
    v_lshrrev_b32 v28, 17, v26
    v_and_b32 v28, 4, v28
    v_xor_b32 v28, v27, v28
    v_mad_u32_u24 v28, v28, s77, v1
    v_mad_i32_i24 v6, v27, s5, v28
    v_add_u32 v6, 4096, v6
    s_mul_i32 s77, s57, 160
    s_lshl1_add_u32 s77, s73, s77
    s_add_u32 s32, s6, s77
    s_addc_u32 s33, s7, 0
    s_mov_b32 s34, 40960
    s_mov_b32 s35, 0x20000
    s_mul_i32 s10, s56, 5120
    v_bfe_u32 v19, v0, 2, 2
    v_and_b32 v20, 3, v0
    v_lshlrev_b32 v20, 3, v20
    v_lshl_add_u32 v29, v17, 3, v19
    v_and_b32 v27, 1, v17
    v_lshlrev_b32 v27, 2, v27
    v_xor_b32 v27, v29, v27
    v_mul_u32_u24 v7, 160, v27
    v_add_u32 v7, v7, v20
    v_xor_b32 v27, 4, v27
    v_mul_u32_u24 v8, 160, v27
    v_add_u32 v8, v8, v20
    v_add_u32 v48, 61440, v7
    v_add_u32 v56, 61440, v8
    s_and_b32 s77, s57, 1
    s_lshl_b32 s77, s77, 5
    s_add_u32 s77, s77, 81920
    v_mad_u32_u24 v26, v29, 40, v20
    v_add_u32 v26, s77, v26
    v_mov_b32 v12, 0x3f803f80
    v_mov_b32 v13, v12
    v_mov_b32 v14, v12
    v_mov_b32 v15, v12
    s_lshr_b32 s4, s56, 1
    s_mov_b32 s80, 0x22222222
    s_mov_b32 s81, s80
    s_lshl_b64 s[82:83], s[80:81], 1
    s_lshl_b64 s[84:85], s[80:81], 2
    s_mov_b32 s86, 0x00f0000f
    s_mov_b32 s87, 0xf0000f00
    v_and_b32 v42, 1, v0
    v_lshlrev_b32 v42, 4, v42
    v_mov_b32 v43, 0x3f80
    v_lshlrev_b32 v42, v42, v43
    v_cndmask_b32 v42, 0, v42, s[86:87]
    s_or_b64 vcc, s[82:83], s[84:85]
    v_cndmask_b32 v22, v42, 0, vcc
    v_cndmask_b32 v23, 0, v42, vcc
    s_mov_b32 s44, s26
    s_mov_b32 s45, s27
    s_mov_b32 s46, 2097152
    s_mov_b32 s47, 0x20000
    s_lshr_b32 s72, s59, 1
    s_lshl_b32 s72, s72, 20
    s_add_u32 s72, s72, 2097152
    s_add_u32 s48, s26, s72
    s_addc_u32 s49, s27, 0
    s_mov_b32 s50, 0x100000
    s_mov_b32 s51, 0x20000
    v_lshlrev_b32 v11, 2, v0
    v_add_u32 v11, 565248, v11
    s_getreg_b32 s63, hwreg(HW_REG_XCC_ID)
    s_lshl_b32 s72, s2, 2
    s_add_u32 s72, s72, s56
    s_mul_i32 s78, s72, 6554
    s_lshr_b32 s78, s78, 16
    s_cmp_lt_u32 s78, 20
    s_cselect_b64 s[64:65], s[12:13], s[20:21]
    s_cselect_b32 s79, 0, 819200
    s_mov_b32 s66, 1966080
    s_cmov_b32 s66, 819200
    s_mov_b32 s67, 0x20000
    s_mul_i32 s78, s78, 39680
    s_lshl_b32 s20, s72, 7
    s_add_u32 s20, s20, s78
    s_sub_u32 s20, s20, s79
    s_lshl_b32 s21, s72, 12
    s_lshl_b32 s12, s56, 12
    s_add_u32 s12, s12, 81920
    s_add_u32 s68, s26, 18874368
    s_addc_u32 s69, s27, 0
    s_mov_b32 s70, 2785280
    s_mov_b32 s71, 0x20000
    s_and_b32 s72, s56, 1
    s_cselect_b64 s[40:41], s[18:19], s[16:17]
    s_cselect_b32 s11, 1966080, 0
    s_mov_b32 s42, 1966080
    s_mov_b32 s43, 0x20000
    s_lshl1_add_u32 s72, s2, s4
    s_mul_i32 s78, s72, 2731
    s_lshr_b32 s78, s78, 16
    s_mul_i32 s78, s78, 95232
    s_lshl_b32 s9, s72, 7
    s_add_u32 s9, s9, s78
    s_lshl_b32 s72, s72, 12
    s_add_u32 s11, s11, s72
    s_add_u32 s11, s11, 22020096
    s_lshr_b32 s72, s59, 1
    s_mul_i32 s72, s72, 163840
    s_add_u32 s52, s22, s72
    s_addc_u32 s53, s23, 0
    s_mov_b32 s54, 163840
    s_mov_b32 s55, 0x20000
    s_bitcmp1_b32 s57, 0
    s_cselect_b32 s6, 8, 4096
    s_mov_b32 s7, 512
    s_cmov_b32 s7, 0x400000
    s_cselect_b32 s8, 512, 8
    s_cselect_b32 s72, 3072, 0
    s_cselect_b32 s77, 256, 0
    s_cselect_b32 s0, 0xffff, -1
    s_cselect_b32 s1, 0, -1
    s_cselect_b32 s78, 0x000f000f, -1
    s_cselect_b32 vcc_lo, 0xffe0ffe0, 0
    s_addk_i32 s77, 1024
    s_bitcmp1_b32 s57, 1
    s_cmov_b32 s6, 128
    s_cmov_b32 s7, 4096
    s_cmov_b32 s8, 8
    s_cmov_b32 s72, s77
    s_cselect_b32 s86, s78, s0
    s_cselect_b32 s87, s78, s1
    s_cselect_b32 vcc_lo, vcc_lo, 0
    s_cselect_b32 s77, 9, 7
    s_mov_b32 s78, 0x3f80
    s_cmov_b32 s78, 0x3f803f80
    s_mov_b32 vcc_hi, vcc_lo
    v_mov_b32 v41, s78
    s_lshl_b32 s77, s56, s77
    s_add_u32 s72, s72, s77
    s_lshl_b32 s77, s59, 13
    s_add_u32 s72, s72, s77
    s_add_u32 s23, s72, 262144
    v_and_b32 v42, 7, v0
    v_lshlrev_b32 v42, 4, v42
    v_bfe_u32 v43, v0, 3, 1
    v_mad_u32_u24 v42, v43, s6, v42
    v_lshrrev_b32 v43, 5, v0
    v_mad_u32_u24 v42, v43, s7, v42
    v_bfe_u32 v43, v0, 4, 1
    v_mad_u32_u24 v42, v43, s8, v42
    v_mov_b32 v43, 0x7ff00000
    v_cndmask_b32 v45, v42, v43, vcc
    s_lshl_b32 s6, s59, 3
    s_add_u32 s6, s6, s57
    s_lshl_b32 s6, s6, 1
    s_and_b32 s72, s56, 1
    s_add_u32 s6, s6, s72
    s_lshl_b32 s6, s6, 4
    s_add_u32 s6, s6, 31760
    s_lshl_b32 s7, s61, 4
    s_lshr_b32 s72, s57, 2
    s_cmp_lg_u32 s72, s4
    s_cmov_b32 s23, 0x400000
    s_cmov_b32 s6, 0x400000
    s_cmov_b32 s7, 0x400000
    s_lshl_b32 s72, s56, 9
    s_add_u32 s72, s72, 151552
    v_lshl_add_u32 v230, v0, 3, s72
    v_lshl_add_u32 v231, v16, 5, s72
    v_lshl_add_u32 v231, v17, 3, v231
    v_lshrrev_b32 v40, 2, v16
    v_lshl_add_u32 v40, v40, 4, v16
    v_lshlrev_b32 v40, 2, v40
    s_mov_b64 exec, 0
    s_cmp_eq_u32 s56, 0
    s_cbranch_scc1 L_wp0
    s_cmp_eq_u32 s56, 1
    s_cbranch_scc1 L_wp1
    s_cmp_eq_u32 s56, 2
    s_cbranch_scc1 L_wp2
    s_cmp_eq_u32 s56, 3
    s_cbranch_scc1 L_wp3
L_wret0:
    s_mov_b64 exec, -1
    s_addk_i32 m0, 896
    s_nop 0
    buffer_load_dwordx4 v18, s[28:31], s74 offen offset:384 lds
    s_addk_i32 m0, 896
    s_nop 0
    buffer_load_dwordx4 v18, s[28:31], s74 offen offset:512 lds
    s_xor_b32 s74, s57, 2
    s_and_b32 s62, s74, 1
    s_and_b32 s74, s74, 3
    s_mulk_i32 s74, 5120
    s_add_u32 m0, s73, s74
    s_mulk_i32 s62, 4480
    s_add_u32 s74, s75, s74
    s_sub_u32 s74, s74, s62
    buffer_load_dwordx4 v18, s[28:31], s74 offen lds
    s_addk_i32 m0, 896
    s_nop 0
    buffer_load_dwordx4 v18, s[28:31], s74 offen offset:128 lds
    s_addk_i32 m0, 896
    s_nop 0
    buffer_load_dwordx4 v18, s[28:31], s74 offen offset:256 lds
    s_addk_i32 m0, 896
    s_nop 0
    buffer_load_dwordx4 v18, s[28:31], s74 offen offset:384 lds
    s_addk_i32 m0, 896
    s_nop 0
    buffer_load_dwordx4 v18, s[28:31], s74 offen offset:512 lds
    s_xor_b32 s74, s57, 3
    s_and_b32 s62, s74, 1
    s_and_b32 s74, s74, 3
    s_mulk_i32 s74, 5120
    s_add_u32 m0, s73, s74
    s_mulk_i32 s62, 4480
    s_add_u32 s74, s75, s74
    s_sub_u32 s74, s74, s62
    buffer_load_dwordx4 v18, s[28:31], s74 offen lds
    s_addk_i32 m0, 896
    s_nop 0
    buffer_load_dwordx4 v18, s[28:31], s74 offen offset:128 lds
    s_addk_i32 m0, 896
    s_nop 0
    buffer_load_dwordx4 v18, s[28:31], s74 offen offset:256 lds
    s_addk_i32 m0, 896
    s_nop 0
    buffer_load_dwordx4 v18, s[28:31], s74 offen offset:384 lds
    s_addk_i32 m0, 896
    s_nop 0
    buffer_load_dwordx4 v18, s[28:31], s74 offen offset:512 lds
    s_barrier
    s_mul_i32 s76, s56, 7168
    s_add_u32 m0, s76, 81920
    s_nop 0
    buffer_load_dwordx4 v1, s[36:39], s76 offen lds
    buffer_load_dwordx4 v1, s[36:39], s76 offen offset:1024 lds
    buffer_load_dwordx4 v1, s[36:39], s76 offen offset:2048 lds
    buffer_load_dwordx4 v1, s[36:39], s76 offen offset:3072 lds
    s_addk_i32 m0, 4096
    s_addk_i32 s76, 4096
    buffer_load_dwordx4 v1, s[36:39], s76 offen lds
    buffer_load_dwordx4 v1, s[36:39], s76 offen offset:1024 lds
    buffer_load_dwordx4 v1, s[36:39], s76 offen offset:2048 lds
    s_add_u32 m0, s10, 110592
    s_nop 0
    buffer_load_dwordx4 v2, s[32:35], 0 offen lds
    buffer_load_dwordx4 v3, s[32:35], 0 offen offset:1024 lds
    buffer_load_dwordx4 v4, s[32:35], 0 offen offset:2048 lds
    buffer_load_dwordx4 v5, s[32:35], 0 offen offset:3072 lds
    s_add_u32 m0, s10, 114688
    s_nop 0
    buffer_load_dwordx4 v6, s[32:35], 0 offen lds
    s_waitcnt vmcnt(12) lgkmcnt(0)
    ds_read_b128 v[60:63], v234
    ds_read_b128 v[64:67], v235
    ds_read_b128 v[68:71], v234 offset:1024
    ds_read_b128 v[72:75], v235 offset:1024
    ds_read_b128 v[76:79], v234 offset:2048
    ds_read_b128 v[80:83], v235 offset:2048
    ds_read_b128 v[84:87], v234 offset:3072
    ds_read_b128 v[88:91], v235 offset:3072
    s_add_u32 s60, s60, 16
    s_waitcnt lgkmcnt(4)
    v_mfma_f32_16x16x32_bf16 v[28:31], v[12:15], v[60:63], 0
    ds_read_b128 v[92:95], v234 offset:4096
    v_lshrrev_b32 v42, 3, v0
    v_mfma_f32_16x16x32_bf16 v[28:31], v[12:15], v[64:67], v[28:31]
    ds_read_b128 v[96:99], v235 offset:4096
    v_mfma_f32_16x16x32_bf16 v[28:31], v[12:15], v[68:71], v[28:31]
    ds_read_b128 v[100:103], v234 offset:5120
    v_mul_u32_u24 v42, 2944, v42
    v_mfma_f32_16x16x32_bf16 v[28:31], v[12:15], v[72:75], v[28:31]
    ds_read_b128 v[104:107], v235 offset:5120
    v_add_u32 v54, v42, v1
    v_mfma_f32_16x16x32_bf16 v[32:35], v[60:63], v[60:63], 0
    ds_read_b128 v[172:175], v234 offset:6144
    v_lshl_add_u32 v51, s56, 10, v1
    v_mfma_f32_16x16x32_bf16 v[32:35], v[64:67], v[64:67], v[32:35]
    ds_read_b128 v[176:179], v235 offset:6144
    v_add_u32 v52, 1966080, v51
    v_mfma_f32_16x16x32_bf16 v[32:35], v[68:71], v[68:71], v[32:35]
    ds_read_b128 v[180:183], v234 offset:7168
    v_mfma_f32_16x16x32_bf16 v[32:35], v[72:75], v[72:75], v[32:35]
    s_waitcnt lgkmcnt(7)
    s_and_b32 s72, s56, 1
    ds_read_b128 v[184:187], v235 offset:7168
    v_mfma_f32_16x16x32_bf16 v[28:31], v[12:15], v[76:79], v[28:31]
    s_lshl3_add_u32 s72, s4, s72
    s_lshl_b32 s72, s72, 7
    ds_read_b128 v[188:191], v234 offset:8192
    v_mfma_f32_16x16x32_bf16 v[28:31], v[12:15], v[80:83], v[28:31]
    s_add_u32 m0, s10, 131072
    s_addk_i32 s72, 4096
    ds_read_b128 v[192:195], v235 offset:8192
    v_mfma_f32_16x16x32_bf16 v[28:31], v[12:15], v[84:87], v[28:31]
    s_add_u32 s32, s32, 163840
    s_addc_u32 s33, s33, 0
    ds_read_b128 v[196:199], v234 offset:9216
    v_mfma_f32_16x16x32_bf16 v[28:31], v[12:15], v[88:91], v[28:31]
    ds_read_b128 v[200:203], v235 offset:9216
    v_bfe_u32 v42, v0, 3, 1
    v_mfma_f32_16x16x32_bf16 v[32:35], v[76:79], v[76:79], v[32:35]
    s_waitcnt vmcnt(5)
    s_barrier
    ds_read_b64_tr_b16 a[176:177], v26
    buffer_load_dwordx4 v2, s[32:35], 0 offen lds
    v_mfma_f32_16x16x32_bf16 v[32:35], v[80:83], v[80:83], v[32:35]
    ds_read_b64_tr_b16 a[178:179], v26 offset:160
    v_mul_u32_u24 v42, 1965952, v42
    v_mfma_f32_16x16x32_bf16 v[32:35], v[84:87], v[84:87], v[32:35]
    ds_read_b64_tr_b16 a[180:181], v26 offset:1280
    v_add3_u32 v53, v42, v1, s72
    v_mfma_f32_16x16x32_bf16 v[32:35], v[88:91], v[88:91], v[32:35]
    s_waitcnt lgkmcnt(11)
    s_lshl_b32 s72, s61, 2
    ds_read_b64_tr_b16 a[182:183], v26 offset:1440
    v_mfma_f32_16x16x32_bf16 v[28:31], v[12:15], v[92:95], v[28:31]
    s_add_u32 s72, s72, s56
    s_lshl_b32 s72, s72, 2
    ds_read_b64_tr_b16 a[184:185], v26 offset:2560
    v_mfma_f32_16x16x32_bf16 v[28:31], v[12:15], v[96:99], v[28:31]
    s_add_u32 s72, s72, 565248
    buffer_load_dwordx4 v3, s[32:35], 0 offen offset:1024 lds
    ds_read_b64_tr_b16 a[186:187], v26 offset:2720
    v_mfma_f32_16x16x32_bf16 v[28:31], v[12:15], v[100:103], v[28:31]
    ds_read_b64_tr_b16 a[188:189], v26 offset:3840
    v_mov_b32 v9, 0x7ff00000
    v_mfma_f32_16x16x32_bf16 v[28:31], v[12:15], v[104:107], v[28:31]
    s_waitcnt lgkmcnt(11)
    ds_read_b64_tr_b16 a[190:191], v26 offset:4000
    v_and_b32 v42, 31, v0
    v_mfma_f32_16x16x32_bf16 v[28:31], v[12:15], v[172:175], v[28:31]
    ds_read_b64_tr_b16 a[192:193], v26 offset:5120
    v_cmp_gt_u32 vcc, 21, v42
    v_mfma_f32_16x16x32_bf16 v[28:31], v[12:15], v[176:179], v[28:31]
    ds_read_b64_tr_b16 a[194:195], v26 offset:5280
    v_mov_b32 v50, 0xdddddddd
    v_mfma_f32_16x16x32_bf16 v[28:31], v[12:15], v[180:183], v[28:31]
    ds_read_b64_tr_b16 a[196:197], v26 offset:6400
    v_cndmask_b32 v49, v9, v1, vcc
    v_mfma_f32_16x16x32_bf16 v[28:31], v[12:15], v[184:187], v[28:31]
    buffer_load_dwordx4 v4, s[32:35], 0 offen offset:2048 lds
    ds_read_b64_tr_b16 a[198:199], v26 offset:6560
    v_mfma_f32_16x16x32_bf16 v[32:35], v[92:95], v[92:95], v[32:35]
    ds_read_b64_tr_b16 a[200:201], v26 offset:7680
    v_writelane_b32 v9, s72, 0
    v_mfma_f32_16x16x32_bf16 v[32:35], v[96:99], v[96:99], v[32:35]
    s_and_b32 s72, s56, 1
    s_mul_i32 s78, s4, 5120
    ds_read_b64_tr_b16 a[202:203], v26 offset:7840
    v_mfma_f32_16x16x32_bf16 v[32:35], v[100:103], v[100:103], v[32:35]
    s_lshl_b32 s79, s72, 7
    s_add_u32 s78, s78, s79
    ds_read_b64_tr_b16 a[204:205], v26 offset:8960
    v_mfma_f32_16x16x32_bf16 v[32:35], v[104:107], v[104:107], v[32:35]
    s_waitcnt lgkmcnt(15)
    s_add_u32 s78, s78, 110592
    ds_read_b64_tr_b16 a[206:207], v26 offset:9120
    v_mfma_f32_16x16x32_bf16 v[28:31], v[12:15], v[188:191], v[28:31]
    ds_read_b64_tr_b16 a[208:209], v26 offset:10240
    v_lshl_add_u32 v59, v16, 3, s78
    v_mfma_f32_16x16x32_bf16 v[28:31], v[12:15], v[192:195], v[28:31]
    buffer_load_dwordx4 v5, s[32:35], 0 offen offset:3072 lds
    ds_read_b64_tr_b16 a[210:211], v26 offset:10400
    v_mfma_f32_16x16x32_bf16 v[28:31], v[12:15], v[196:199], v[28:31]
    ds_read_b64_tr_b16 a[212:213], v26 offset:11520
    v_lshl_add_u32 v59, v17, 8, v59
    v_mfma_f32_16x16x32_bf16 v[28:31], v[12:15], v[200:203], v[28:31]
    s_mul_i32 s72, s72, 5120
    s_add_u32 s72, s72, 110592
    ds_read_b64_tr_b16 a[214:215], v26 offset:11680
    v_mfma_f32_16x16x32_bf16 v[32:35], v[172:175], v[172:175], v[32:35]
    s_mul_i32 s78, s4, 2560
    s_sub_u32 s79, 2560, s78
    ds_read_b64_tr_b16 a[216:217], v26 offset:12800
    v_mfma_f32_16x16x32_bf16 v[32:35], v[176:179], v[176:179], v[32:35]
    s_add_u32 m0, s10, 135168
    ds_read_b64_tr_b16 a[218:219], v26 offset:12960
    v_lshl_add_u32 v42, v42, 3, s72
    v_mfma_f32_16x16x32_bf16 v[32:35], v[180:183], v[180:183], v[32:35]
    ds_read_b64_tr_b16 a[220:221], v26 offset:14080
    v_lshrrev_b32 v43, 5, v0
    v_mfma_f32_16x16x32_bf16 v[32:35], v[184:187], v[184:187], v[32:35]
    buffer_load_dwordx4 v6, s[32:35], 0 offen lds
    ds_read_b64_tr_b16 a[222:223], v26 offset:14240
    v_mul_f32 v28, 0xbacccccd, v28
    v_mfma_f32_16x16x32_bf16 v[32:35], v[188:191], v[188:191], v[32:35]
    ds_read_b64_tr_b16 a[224:225], v26 offset:15360
    v_mul_f32 v29, 0xbacccccd, v29
    v_mfma_f32_16x16x32_bf16 v[32:35], v[192:195], v[192:195], v[32:35]
    ds_read_b64_tr_b16 a[226:227], v26 offset:15520
    v_mul_f32 v30, 0xbacccccd, v30
    v_mul_f32 v31, 0xbacccccd, v31
    v_mfma_f32_16x16x32_bf16 v[32:35], v[196:199], v[196:199], v[32:35]
    s_add_u32 m0, s73, 0
    ds_read_b64_tr_b16 a[228:229], v26 offset:16640
    v_lshl_add_u32 v42, v43, 9, v42
    v_mfma_f32_16x16x32_bf16 v[32:35], v[200:203], v[200:203], v[32:35]
    s_waitcnt lgkmcnt(15)
    s_add_u32 s32, s32, 163840
    s_addc_u32 s33, s33, 0
    ds_read_b64_tr_b16 a[230:231], v26 offset:16800
    v_mfma_f32_16x16x32_bf16 v[112:115], a[176:179], v[12:15], 0
    ds_read_b64_tr_b16 a[232:233], v26 offset:17920
    v_cmp_gt_u32 vcc, 32, v0
    v_mfma_f32_16x16x32_bf16 v[112:115], a[180:183], v[12:15], v[112:115]
    buffer_load_dwordx4 v2, s[32:35], 0 offen lds
    ds_read_b64_tr_b16 a[234:235], v26 offset:18080
    v_mfma_f32_16x16x32_bf16 v[112:115], a[184:187], v[12:15], v[112:115]
    ds_read_b64_tr_b16 a[236:237], v26 offset:19200
    v_add_u32 v238, s78, v42
    v_mfma_f32_16x16x32_bf16 v[112:115], a[188:191], v[12:15], v[112:115]
    ds_read_b64_tr_b16 a[238:239], v26 offset:19360
    v_add_u32 v239, s79, v42
    v_mfma_f32_16x16x32_bf16 v[108:111], a[176:179], v[60:63], 0
    s_branch L_wp0
    .p2align 12
L_wp0:
    s_cbranch_execz L_wp4
    ds_read_b64_tr_b16 a[240:241], v26 offset:20480
    v_cndmask_b32 v25, v32, v33, s[80:81]
    v_mfma_f32_16x16x32_bf16 v[108:111], a[180:183], v[64:67], v[108:111]
    ds_read_b64_tr_b16 a[242:243], v26 offset:20640
    v_mov_b32 v44, 120832
    v_mfma_f32_16x16x32_bf16 v[108:111], a[184:187], v[68:71], v[108:111]
    ds_read_b64_tr_b16 a[244:245], v26 offset:21760
    v_cndmask_b32 v25, v25, v34, s[82:83]
    v_mfma_f32_16x16x32_bf16 v[108:111], a[188:191], v[72:75], v[108:111]
    s_waitcnt lgkmcnt(15)
    buffer_load_dwordx4 v3, s[32:35], 0 offen offset:1024 lds
    ds_read_b64_tr_b16 a[246:247], v26 offset:21920
    v_mfma_f32_16x16x32_bf16 v[112:115], a[192:195], v[12:15], v[112:115]
    ds_read_b64_tr_b16 a[248:249], v26 offset:23040
    v_cndmask_b32 v25, v25, v35, s[84:85]
    v_mfma_f32_16x16x32_bf16 v[112:115], a[196:199], v[12:15], v[112:115]
    ds_read_b64_tr_b16 a[250:251], v26 offset:23200
    v_add_u32 v42, 1024, v238
    v_mfma_f32_16x16x32_bf16 v[112:115], a[200:203], v[12:15], v[112:115]
    ds_read_b64_tr_b16 a[252:253], v26 offset:24320
    v_add_u32 v43, 1024, v239
    v_mfma_f32_16x16x32_bf16 v[112:115], a[204:207], v[12:15], v[112:115]
    ds_bpermute_b32 v25, v40, v25
    v_cndmask_b32 v240, v44, v42, vcc
    v_mfma_f32_16x16x32_bf16 v[108:111], a[192:195], v[76:79], v[108:111]
    ds_read_b64_tr_b16 a[254:255], v26 offset:24480
    v_mov_b32 v226, s63
    v_mfma_f32_16x16x32_bf16 v[108:111], a[196:199], v[80:83], v[108:111]
    s_waitcnt vmcnt(7)
    s_barrier
    buffer_load_dwordx4 v4, s[32:35], 0 offen offset:2048 lds
    ds_read_b64_tr_b16 a[0:1], v48 offset:49280
    v_mfma_f32_16x16x32_bf16 v[108:111], a[200:203], v[84:87], v[108:111]
    ds_read_b64_tr_b16 a[2:3], v56 offset:49280
    v_mov_b32 v10, s60
    v_mfma_f32_16x16x32_bf16 v[108:111], a[204:207], v[88:91], v[108:111]
    s_waitcnt lgkmcnt(15)
    ds_read_b64_tr_b16 a[4:5], v48 offset:54400
    v_mov_b32 v224, v10
    v_mfma_f32_16x16x32_bf16 v[112:115], a[208:211], v[12:15], v[112:115]
    ds_read_b64_tr_b16 a[6:7], v56 offset:54400
    v_xor_b32 v227, 0x5bd1e995, v10
    v_mfma_f32_16x16x32_bf16 v[112:115], a[212:215], v[12:15], v[112:115]
    ds_read_b64_tr_b16 a[8:9], v48 offset:54368
    v_cndmask_b32 v241, v44, v43, vcc
    v_mfma_f32_16x16x32_bf16 v[112:115], a[216:219], v[12:15], v[112:115]
    ds_read_b64_tr_b16 a[10:11], v56 offset:54368
    v_lshrrev_b32 v42, 3, v0
    v_mfma_f32_16x16x32_bf16 v[112:115], a[220:223], v[12:15], v[112:115]
    buffer_load_dwordx4 v5, s[32:35], 0 offen offset:3072 lds
    ds_read_b64_tr_b16 a[12:13], v48 offset:49248
    v_mfma_f32_16x16x32_bf16 v[108:111], a[208:211], v[92:95], v[108:111]
    s_waitcnt lgkmcnt(8)
    ds_read_b64_tr_b16 a[14:15], v56 offset:49248
    v_mul_u32_u24 v42, 1152, v42
    v_mfma_f32_16x16x32_bf16 v[108:111], a[212:215], v[96:99], v[108:111]
    ds_read_b64_tr_b16 a[16:17], v48 offset:49216
    v_mul_f32 v25, 0x3acccccd, v25
    v_mfma_f32_16x16x32_bf16 v[108:111], a[216:219], v[100:103], v[108:111]
    ds_read_b64_tr_b16 a[18:19], v56 offset:49216
    v_fma_f32 v25, -v28, v28, v25
    v_mfma_f32_16x16x32_bf16 v[108:111], a[220:223], v[104:107], v[108:111]
    s_add_u32 m0, s73, 4096
    ds_read_b64_tr_b16 a[20:21], v48 offset:54336
    v_max_f32 v25, 0, v25
    v_mfma_f32_16x16x32_bf16 v[112:115], a[224:227], v[12:15], v[112:115]
    ds_read_b64_tr_b16 a[22:23], v56 offset:54336
    v_add_f32 v25, 0x3727c5ac, v25
    v_mfma_f32_16x16x32_bf16 v[112:115], a[228:231], v[12:15], v[112:115]
    buffer_load_dwordx4 v6, s[32:35], 0 offen lds
    ds_read_b64_tr_b16 a[24:25], v48 offset:54304
    v_mfma_f32_16x16x32_bf16 v[112:115], a[232:235], v[12:15], v[112:115]
    v_rsq_f32 v25, v25
    v_mfma_f32_16x16x32_bf16 v[112:115], a[236:239], v[12:15], v[112:115]
    ds_read_b64_tr_b16 a[26:27], v56 offset:54304
    v_add_u32 v21, v42, v1
    v_mfma_f32_16x16x32_bf16 v[108:111], a[224:227], v[172:175], v[108:111]
    s_add_u32 m0, s73, 5120
    ds_read_b64_tr_b16 a[28:29], v48 offset:49184
    v_mul_f32 v27, 0x3ea52b5c, v25
    v_mfma_f32_16x16x32_bf16 v[108:111], a[228:231], v[176:179], v[108:111]
    s_add_u32 s32, s32, 163840
    s_addc_u32 s33, s33, 0
    ds_read_b64_tr_b16 a[30:31], v56 offset:49184
    v_mfma_f32_16x16x32_bf16 v[108:111], a[232:235], v[180:183], v[108:111]
    s_mov_b64 exec, 15
    buffer_store_dword v10, v11, s[48:51], s7 offen sc1
    s_mov_b64 exec, -1
    v_mfma_f32_16x16x32_bf16 v[108:111], a[236:239], v[184:187], v[108:111]
    s_waitcnt lgkmcnt(15)
    buffer_load_dwordx4 v2, s[32:35], 0 offen lds
    ds_read_b64_tr_b16 a[32:33], v48 offset:49152
    v_mfma_f32_16x16x32_bf16 v[112:115], a[240:243], v[12:15], v[112:115]
    ds_read_b64_tr_b16 a[34:35], v56 offset:49152
    v_lshl_add_u32 v42, v17, 3, v19
    v_mfma_f32_16x16x32_bf16 v[112:115], a[244:247], v[12:15], v[112:115]
    ds_read_b64_tr_b16 a[36:37], v48 offset:54272
    v_lshl_add_u32 v42, v42, 7, v20
    v_mfma_f32_16x16x32_bf16 v[112:115], a[248:251], v[12:15], v[112:115]
    ds_read_b64_tr_b16 a[38:39], v56 offset:54272
    v_add_u32 v24, s12, v42
    v_mfma_f32_16x16x32_bf16 v[112:115], a[252:255], v[12:15], v[112:115]
    ds_read_b64_tr_b16 a[40:41], v48 offset:59392
    v_and_b32 v42, 1, v17
    v_mfma_f32_16x16x32_bf16 v[108:111], a[240:243], v[188:191], v[108:111]
    buffer_load_dwordx4 v3, s[32:35], 0 offen offset:1024 lds
    ds_read_b64_tr_b16 a[42:43], v56 offset:59392
    v_mfma_f32_16x16x32_bf16 v[108:111], a[244:247], v[192:195], v[108:111]
    ds_read_b64_tr_b16 a[44:45], v48 offset:64512
    v_mul_u32_u24 v42, 20480, v42
    v_mfma_f32_16x16x32_bf16 v[108:111], a[248:251], v[196:199], v[108:111]
    ds_read_b64_tr_b16 a[46:47], v56 offset:64512
    v_lshl_add_u32 v42, v16, 4, v42
    v_mfma_f32_16x16x32_bf16 v[108:111], a[252:255], v[200:203], v[108:111]
    v_lshrrev_b32 v43, 5, v0
    v_mul_u32_u24 v44, 248, v43
    v_add_u32 v39, v44, v42
    v_lshl_add_u32 v38, v43, 3, v42
    v_mul_u32_u24 v42, 1280, v16
    v_lshl_add_u32 v58, v17, 3, v42
    v_add_u32 v243, 122880, v1
    v_lshl_add_u32 v242, s56, 2, v243
    v_min_u32 v57, 19, v0
    v_lshlrev_b32 v57, 7, v57
    v_mfma_f32_16x16x16_bf16 v[148:151], v[22:23], v[60:61], v[28:31]
    v_mfma_f32_16x16x16_bf16 v[152:155], v[22:23], v[62:63], v[28:31]
    v_fmac_f32 v108, v28, v112
    v_fmac_f32 v109, v28, v113
    v_fmac_f32 v110, v28, v114
    v_fmac_f32 v111, v28, v115
    v_mul_f32 v108, v108, v25
    v_mul_f32 v109, v109, v25
    v_mul_f32 v110, v110, v25
    v_mul_f32 v111, v111, v25
    v_cvt_pk_bf16_f32 v116, v108, v109
    v_cvt_pk_bf16_f32 v117, v110, v111
    ds_write_b64 v231, v[116:117]
    ds_read_b64_tr_b16 v[120:121], v230
    s_bitcmp1_b32 s57, 1
    s_cselect_b64 vcc, -1, 0
    v_cndmask_b32 v118, 0, v116, s[0:1]
    v_cndmask_b32 v119, 0, v117, s[0:1]
    v_mfma_f32_16x16x16_bf16 v[156:159], v[22:23], v[64:65], v[28:31]
    buffer_load_dwordx4 v4, s[32:35], 0 offen offset:2048 lds
    ds_read_b64_tr_b16 a[48:49], v48 offset:64544
    v_mfma_f32_16x16x16_bf16 v[160:163], v[22:23], v[66:67], v[28:31]
    ds_read_b64_tr_b16 a[50:51], v56 offset:64544
    v_mfma_f32_16x16x16_bf16 v[164:167], v[22:23], v[68:69], v[28:31]
    ds_read_b64_tr_b16 a[52:53], v48 offset:59424
    v_cvt_pk_bf16_f32 v60, v148, v149
    v_cvt_pk_bf16_f32 v61, v150, v151
    v_mfma_f32_16x16x16_bf16 v[168:171], v[22:23], v[70:71], v[28:31]
    ds_read_b64_tr_b16 a[54:55], v56 offset:59424
    v_cvt_pk_bf16_f32 v62, v152, v153
    v_cvt_pk_bf16_f32 v63, v154, v155
    v_mfma_f32_16x16x16_bf16 v[148:151], v[22:23], v[72:73], v[28:31]
    s_waitcnt lgkmcnt(4)
    v_cvt_pk_bf16_f32 v64, v156, v157
    v_cvt_pk_bf16_f32 v65, v158, v159
    v_cndmask_b32 v116, v116, v120, vcc
    v_cndmask_b32 v117, v117, v121, vcc
    v_cndmask_b32 v116, v12, v116, s[86:87]
    v_cndmask_b32 v117, v41, v117, s[86:87]
    buffer_store_dwordx2 v[116:117], v45, s[44:47], s23 offen sc1
    v_mfma_f32_16x16x16_bf16 v[124:127], v[118:119], v[118:119], 0
    v_mfma_f32_16x16x16_bf16 v[152:155], v[22:23], v[74:75], v[28:31]
    ds_read_b64_tr_b16 a[56:57], v48 offset:59456
    v_cvt_pk_bf16_f32 v66, v160, v161
    v_cvt_pk_bf16_f32 v67, v162, v163
    v_mfma_f32_16x16x16_bf16 v[156:159], v[22:23], v[76:77], v[28:31]
    buffer_load_dwordx4 v5, s[32:35], 0 offen offset:3072 lds
    ds_read_b64_tr_b16 a[58:59], v56 offset:59456
    v_cvt_pk_bf16_f32 v68, v164, v165
    v_cvt_pk_bf16_f32 v69, v166, v167
    v_mfma_f32_16x16x16_bf16 v[160:163], v[22:23], v[78:79], v[28:31]
    ds_read_b64_tr_b16 a[60:61], v48 offset:64576
    v_cvt_pk_bf16_f32 v70, v168, v169
    v_cvt_pk_bf16_f32 v71, v170, v171
    v_mfma_f32_16x16x16_bf16 v[164:167], v[22:23], v[80:81], v[28:31]
    ds_read_b64_tr_b16 a[62:63], v56 offset:64576
    v_cvt_pk_bf16_f32 v72, v148, v149
    v_cvt_pk_bf16_f32 v73, v150, v151
    v_mfma_f32_16x16x16_bf16 v[168:171], v[22:23], v[82:83], v[28:31]
    ds_read_b64_tr_b16 a[64:65], v48 offset:64608
    v_cvt_pk_bf16_f32 v74, v152, v153
    v_cvt_pk_bf16_f32 v75, v154, v155
    v_max3_f32 v124, v124, v125, v126
    v_mfma_f32_16x16x16_bf16 v[148:151], v[22:23], v[84:85], v[28:31]
    s_add_u32 m0, s73, 9216
    ds_read_b64_tr_b16 a[66:67], v56 offset:64608
    v_cvt_pk_bf16_f32 v76, v156, v157
    v_cvt_pk_bf16_f32 v77, v158, v159
    v_mfma_f32_16x16x16_bf16 v[152:155], v[22:23], v[86:87], v[28:31]
    ds_read_b64_tr_b16 a[68:69], v48 offset:59488
    v_cvt_pk_bf16_f32 v78, v160, v161
    v_cvt_pk_bf16_f32 v79, v162, v163
    v_max_f32 v124, v124, v127
    v_mfma_f32_16x16x16_bf16 v[156:159], v[22:23], v[88:89], v[28:31]
    buffer_load_dwordx4 v6, s[32:35], 0 offen lds
    ds_read_b64_tr_b16 a[70:71], v56 offset:59488
    v_cvt_pk_bf16_f32 v80, v164, v165
    v_cvt_pk_bf16_f32 v81, v166, v167
    v_mfma_f32_16x16x16_bf16 v[160:163], v[22:23], v[90:91], v[28:31]
    ds_read_b64_tr_b16 a[72:73], v48 offset:59520
    v_cvt_pk_bf16_f32 v82, v168, v169
    v_cvt_pk_bf16_f32 v83, v170, v171
    v_max_f32_dpp v124, v124, v124 row_shr:1 row_mask:0xf bank_mask:0xf
    v_mfma_f32_16x16x16_bf16 v[164:167], v[22:23], v[92:93], v[28:31]
    ds_read_b64_tr_b16 a[74:75], v56 offset:59520
    v_cvt_pk_bf16_f32 v84, v148, v149
    v_cvt_pk_bf16_f32 v85, v150, v151
    v_mfma_f32_16x16x16_bf16 v[168:171], v[22:23], v[94:95], v[28:31]
    ds_read_b64_tr_b16 a[76:77], v48 offset:64640
    v_cvt_pk_bf16_f32 v86, v152, v153
    v_cvt_pk_bf16_f32 v87, v154, v155
    v_max_f32_dpp v124, v124, v124 row_shr:2 row_mask:0xf bank_mask:0xf
    v_mfma_f32_16x16x16_bf16 v[148:151], v[22:23], v[96:97], v[28:31]
    s_add_u32 m0, s73, 10240
    ds_read_b64_tr_b16 a[78:79], v56 offset:64640
    v_cvt_pk_bf16_f32 v88, v156, v157
    v_cvt_pk_bf16_f32 v89, v158, v159
    v_mfma_f32_16x16x16_bf16 v[152:155], v[22:23], v[98:99], v[28:31]
    v_cvt_pk_bf16_f32 v90, v160, v161
    v_cvt_pk_bf16_f32 v91, v162, v163
    v_max_f32_dpp v124, v124, v124 row_shr:4 row_mask:0xf bank_mask:0xf
    v_add_u32 v48, 20480, v48
    v_add_u32 v56, 20480, v56
    s_waitcnt vmcnt(12)
    s_barrier
    ds_read_b64_tr_b16 a[80:81], v48 offset:49280
    v_mfma_f32_16x16x16_bf16 v[156:159], v[22:23], v[100:101], v[28:31]
    s_add_u32 s32, s32, 163840
    s_addc_u32 s33, s33, 0
    buffer_load_dwordx4 v2, s[32:35], 0 offen lds
    ds_read_b64_tr_b16 a[82:83], v56 offset:49280
    v_cvt_pk_bf16_f32 v92, v164, v165
    v_cvt_pk_bf16_f32 v93, v166, v167
    v_mfma_f32_16x16x16_bf16 v[160:163], v[22:23], v[102:103], v[28:31]
    ds_read_b64_tr_b16 a[84:85], v48 offset:54400
    v_cvt_pk_bf16_f32 v94, v168, v169
    v_cvt_pk_bf16_f32 v95, v170, v171
    v_max_f32_dpp v124, v124, v124 row_shr:8 row_mask:0xf bank_mask:0xf
    v_mfma_f32_16x16x16_bf16 v[164:167], v[22:23], v[104:105], v[28:31]
    ds_read_b64_tr_b16 a[86:87], v56 offset:54400
    v_cvt_pk_bf16_f32 v96, v148, v149
    v_cvt_pk_bf16_f32 v97, v150, v151
    v_mfma_f32_16x16x16_bf16 v[168:171], v[22:23], v[106:107], v[28:31]
    ds_read_b64_tr_b16 a[88:89], v48 offset:54368
    v_cvt_pk_bf16_f32 v98, v152, v153
    v_cvt_pk_bf16_f32 v99, v154, v155
    v_max_f32_dpp v124, v124, v124 row_bcast:15 row_mask:0xa bank_mask:0xf
    v_mfma_f32_16x16x16_bf16 v[148:151], v[22:23], v[172:173], v[28:31]
    ds_read_b64_tr_b16 a[90:91], v56 offset:54368
    v_cvt_pk_bf16_f32 v100, v156, v157
    v_cvt_pk_bf16_f32 v101, v158, v159
    v_mfma_f32_16x16x16_bf16 v[152:155], v[22:23], v[174:175], v[28:31]
    ds_read_b64_tr_b16 a[92:93], v48 offset:49248
    v_cvt_pk_bf16_f32 v102, v160, v161
    v_cvt_pk_bf16_f32 v103, v162, v163
    v_max_f32_dpp v124, v124, v124 row_bcast:31 row_mask:0xc bank_mask:0xf
    v_mfma_f32_16x16x16_bf16 v[156:159], v[22:23], v[176:177], v[28:31]
    buffer_load_dwordx4 v3, s[32:35], 0 offen offset:1024 lds
    ds_read_b64_tr_b16 a[94:95], v56 offset:49248
    v_cvt_pk_bf16_f32 v104, v164, v165
    v_cvt_pk_bf16_f32 v105, v166, v167
    v_mfma_f32_16x16x16_bf16 v[160:163], v[22:23], v[178:179], v[28:31]
    ds_read_b64_tr_b16 a[96:97], v48 offset:49216
    v_cvt_pk_bf16_f32 v106, v168, v169
    v_cvt_pk_bf16_f32 v107, v170, v171
    v_cndmask_b32 v125, v124, 0, vcc
    v_mfma_f32_16x16x16_bf16 v[164:167], v[22:23], v[180:181], v[28:31]
    ds_read_b64_tr_b16 a[98:99], v56 offset:49216
    v_cvt_pk_bf16_f32 v172, v148, v149
    v_cvt_pk_bf16_f32 v173, v150, v151
    v_mfma_f32_16x16x16_bf16 v[168:171], v[22:23], v[182:183], v[28:31]
    ds_read_b64_tr_b16 a[100:101], v48 offset:54336
    v_cvt_pk_bf16_f32 v174, v152, v153
    v_cvt_pk_bf16_f32 v175, v154, v155
    v_cmp_lt_f32 vcc, 0x5d800000, v124
    v_mfma_f32_16x16x16_bf16 v[148:151], v[22:23], v[184:185], v[28:31]
    ds_read_b64_tr_b16 a[102:103], v56 offset:54336
    v_cvt_pk_bf16_f32 v176, v156, v157
    v_cvt_pk_bf16_f32 v177, v158, v159
    v_mfma_f32_16x16x16_bf16 v[152:155], v[22:23], v[186:187], v[28:31]
    ds_read_b64_tr_b16 a[104:105], v48 offset:54304
    v_cvt_pk_bf16_f32 v178, v160, v161
    v_cvt_pk_bf16_f32 v179, v162, v163
    v_mov_b32 v126, 0x7f800000
    v_mfma_f32_16x16x16_bf16 v[156:159], v[22:23], v[188:189], v[28:31]
    buffer_load_dwordx4 v4, s[32:35], 0 offen offset:2048 lds
    ds_read_b64_tr_b16 a[106:107], v56 offset:54304
    v_cvt_pk_bf16_f32 v180, v164, v165
    v_cvt_pk_bf16_f32 v181, v166, v167
    v_mfma_f32_16x16x16_bf16 v[160:163], v[22:23], v[190:191], v[28:31]
    ds_read_b64_tr_b16 a[108:109], v48 offset:49184
    v_cvt_pk_bf16_f32 v182, v168, v169
    v_cvt_pk_bf16_f32 v183, v170, v171
    v_cndmask_b32 v225, v125, v126, vcc
    v_mfma_f32_16x16x16_bf16 v[164:167], v[22:23], v[192:193], v[28:31]
    ds_read_b64_tr_b16 a[110:111], v56 offset:49184
    v_cvt_pk_bf16_f32 v184, v148, v149
    v_cvt_pk_bf16_f32 v185, v150, v151
    v_mfma_f32_16x16x16_bf16 v[168:171], v[22:23], v[194:195], v[28:31]
    ds_read_b64_tr_b16 a[112:113], v48 offset:49152
    v_cvt_pk_bf16_f32 v186, v152, v153
    v_cvt_pk_bf16_f32 v187, v154, v155
    v_mfma_f32_16x16x16_bf16 v[148:151], v[22:23], v[196:197], v[28:31]
    ds_read_b64_tr_b16 a[114:115], v56 offset:49152
    v_cvt_pk_bf16_f32 v188, v156, v157
    v_cvt_pk_bf16_f32 v189, v158, v159
    v_mfma_f32_16x16x16_bf16 v[152:155], v[22:23], v[198:199], v[28:31]
    ds_read_b64_tr_b16 a[116:117], v48 offset:54272
    v_cvt_pk_bf16_f32 v190, v160, v161
    v_cvt_pk_bf16_f32 v191, v162, v163
    v_mfma_f32_16x16x16_bf16 v[156:159], v[22:23], v[200:201], v[28:31]
    buffer_load_dwordx4 v5, s[32:35], 0 offen offset:3072 lds
    ds_read_b64_tr_b16 a[118:119], v56 offset:54272
    v_cvt_pk_bf16_f32 v192, v164, v165
    v_cvt_pk_bf16_f32 v193, v166, v167
    v_mfma_f32_16x16x16_bf16 v[160:163], v[22:23], v[202:203], v[28:31]
    ds_read_b64_tr_b16 a[120:121], v48 offset:59392
    v_cvt_pk_bf16_f32 v194, v168, v169
    v_cvt_pk_bf16_f32 v195, v170, v171
    v_mfma_f32_16x16x32_bf16 v[144:147], a[0:3], v[60:63], 0
    ds_read_b64_tr_b16 a[122:123], v56 offset:59392
    ds_read_b64_tr_b16 a[124:125], v48 offset:64512
    v_cvt_pk_bf16_f32 v196, v148, v149
    v_cvt_pk_bf16_f32 v197, v150, v151
    v_mfma_f32_16x16x32_bf16 v[144:147], a[4:7], v[64:67], v[144:147]
    ds_read_b64_tr_b16 a[126:127], v56 offset:64512
    ds_read_b64_tr_b16 a[128:129], v48 offset:64544
    v_cvt_pk_bf16_f32 v198, v152, v153
    v_cvt_pk_bf16_f32 v199, v154, v155
    v_mfma_f32_16x16x32_bf16 v[140:143], a[8:11], v[64:67], 0
    s_waitcnt vmcnt(6)
    s_mov_b32 exec_lo, 0
    s_mov_b32 exec_hi, 0x80000000
    buffer_store_dwordx4 v[224:227], v1, s[44:47], s6 offen sc1
    s_mov_b64 exec, -1
    ds_read_b64_tr_b16 a[130:131], v56 offset:64544
    v_cvt_pk_bf16_f32 v200, v156, v157
    v_cvt_pk_bf16_f32 v201, v158, v159
    v_mfma_f32_16x16x32_bf16 v[140:143], a[12:15], v[60:63], v[140:143]
    s_add_u32 m0, s73, 14336
    ds_read_b64_tr_b16 a[132:133], v48 offset:59424
    ds_read_b64_tr_b16 a[134:135], v56 offset:59424
    v_cvt_pk_bf16_f32 v202, v160, v161
    v_cvt_pk_bf16_f32 v203, v162, v163
    v_mfma_f32_16x16x32_bf16 v[136:139], a[16:19], v[60:63], 0
    buffer_load_dwordx4 v6, s[32:35], 0 offen lds
    ds_read_b64_tr_b16 a[136:137], v48 offset:59456
    v_mfma_f32_16x16x32_bf16 v[136:139], a[20:23], v[64:67], v[136:139]
    ds_read_b64_tr_b16 a[138:139], v56 offset:59456
    v_mfma_f32_16x16x32_bf16 v[132:135], a[24:27], v[64:67], 0
    ds_read_b64_tr_b16 a[140:141], v48 offset:64576
    ds_read_b64_tr_b16 a[142:143], v56 offset:64576
    v_mfma_f32_16x16x32_bf16 v[132:135], a[28:31], v[60:63], v[132:135]
    ds_read_b64_tr_b16 a[144:145], v48 offset:64608
    v_mfma_f32_16x16x32_bf16 v[128:131], a[32:35], v[60:63], 0
    ds_read_b64_tr_b16 a[146:147], v56 offset:64608
    ds_read_b64_tr_b16 a[148:149], v48 offset:59488
    v_mfma_f32_16x16x32_bf16 v[128:131], a[36:39], v[64:67], v[128:131]
    s_waitcnt lgkmcnt(15)
    ds_read_b64_tr_b16 a[150:151], v56 offset:59488
    ds_read_b64_tr_b16 a[152:153], v48 offset:59520
    v_mfma_f32_16x16x32_bf16 v[128:131], a[40:43], v[68:71], v[128:131]
    ds_read_b64_tr_b16 a[154:155], v56 offset:59520
    v_mfma_f32_16x16x32_bf16 v[128:131], a[44:47], v[72:75], v[128:131]
    ds_read_b64_tr_b16 a[156:157], v48 offset:64640
    ds_read_b64_tr_b16 a[158:159], v56 offset:64640
    v_mfma_f32_16x16x32_bf16 v[132:135], a[48:51], v[72:75], v[132:135]
    v_add_u32 v48, -20480, v48
    v_add_u32 v56, -20480, v56
    s_barrier
    ds_read_b64_tr_b16 a[160:161], v7 offset:128
    v_mfma_f32_16x16x32_bf16 v[132:135], a[52:55], v[68:71], v[132:135]
    ds_read_b64_tr_b16 a[162:163], v8 offset:128
    ds_read_b64_tr_b16 a[164:165], v7 offset:20608
    v_mfma_f32_16x16x32_bf16 v[136:139], a[56:59], v[68:71], v[136:139]
    ds_read_b64_tr_b16 a[166:167], v8 offset:20608
    ds_read_b64_tr_b16 a[168:169], v7 offset:20576
    v_mfma_f32_16x16x32_bf16 v[136:139], a[60:63], v[72:75], v[136:139]
    s_mov_b32 m0, s12
    ds_read_b64_tr_b16 a[170:171], v8 offset:20576
    v_mfma_f32_16x16x32_bf16 v[140:143], a[64:67], v[72:75], v[140:143]
    ds_read_b64_tr_b16 a[172:173], v7 offset:96
    ds_read_b64_tr_b16 a[174:175], v8 offset:96
    v_mfma_f32_16x16x32_bf16 v[140:143], a[68:71], v[68:71], v[140:143]
    ds_read_b64_tr_b16 a[0:1], v7 offset:64
    v_mfma_f32_16x16x32_bf16 v[144:147], a[72:75], v[68:71], v[144:147]
    ds_read_b64_tr_b16 a[2:3], v8 offset:64
    ds_read_b64_tr_b16 a[4:5], v7 offset:20544
    v_mfma_f32_16x16x32_bf16 v[144:147], a[76:79], v[72:75], v[144:147]
    ds_read_b64_tr_b16 a[6:7], v8 offset:20544
    v_mfma_f32_16x16x32_bf16 v[144:147], a[80:83], v[76:79], v[144:147]
    ds_read_b64_tr_b16 a[8:9], v7 offset:20512
    ds_read_b64_tr_b16 a[10:11], v8 offset:20512
    v_mfma_f32_16x16x32_bf16 v[144:147], a[84:87], v[80:83], v[144:147]
    ds_read_b64_tr_b16 a[12:13], v7 offset:32
    ds_read_b64_tr_b16 a[14:15], v8 offset:32
    v_mfma_f32_16x16x32_bf16 v[140:143], a[88:91], v[80:83], v[140:143]
    ds_read_b64_tr_b16 a[16:17], v7
    v_mfma_f32_16x16x32_bf16 v[140:143], a[92:95], v[76:79], v[140:143]
    ds_read_b64_tr_b16 a[18:19], v8
    ds_read_b64_tr_b16 a[20:21], v7 offset:20480
    v_mfma_f32_16x16x32_bf16 v[136:139], a[96:99], v[76:79], v[136:139]
    ds_read_b64_tr_b16 a[22:23], v8 offset:20480
    v_mfma_f32_16x16x32_bf16 v[136:139], a[100:103], v[80:83], v[136:139]
    ds_read_b64_tr_b16 a[24:25], v7 offset:40960
    ds_read_b64_tr_b16 a[26:27], v8 offset:40960
    v_mfma_f32_16x16x32_bf16 v[132:135], a[104:107], v[80:83], v[132:135]
    ds_read_b64_tr_b16 a[28:29], v7 offset:61440
    ds_read_b64_tr_b16 a[30:31], v8 offset:61440
    v_mfma_f32_16x16x32_bf16 v[132:135], a[108:111], v[76:79], v[132:135]
    ds_read_b64_tr_b16 a[32:33], v7 offset:61472
    v_mfma_f32_16x16x32_bf16 v[128:131], a[112:115], v[76:79], v[128:131]
    ds_read_b64_tr_b16 a[34:35], v8 offset:61472
    ds_read_b64_tr_b16 a[36:37], v7 offset:40992
    v_mfma_f32_16x16x32_bf16 v[128:131], a[116:119], v[80:83], v[128:131]
    s_waitcnt lgkmcnt(15)
    ds_read_b64_tr_b16 a[38:39], v8 offset:40992
    v_mfma_f32_16x16x32_bf16 v[128:131], a[120:123], v[84:87], v[128:131]
    ds_read_b64_tr_b16 a[40:41], v7 offset:41024
    ds_read_b64_tr_b16 a[42:43], v8 offset:41024
    v_mfma_f32_16x16x32_bf16 v[128:131], a[124:127], v[88:91], v[128:131]
    ds_read_b64_tr_b16 a[44:45], v7 offset:61504
    ds_read_b64_tr_b16 a[46:47], v8 offset:61504
    v_mfma_f32_16x16x32_bf16 v[132:135], a[128:131], v[88:91], v[132:135]
    ds_read_b64_tr_b16 a[48:49], v7 offset:61536
    v_mfma_f32_16x16x32_bf16 v[132:135], a[132:135], v[84:87], v[132:135]
    ds_read_b64_tr_b16 a[50:51], v8 offset:61536
    ds_read_b64_tr_b16 a[52:53], v7 offset:41056
    buffer_load_dwordx4 v54, s[40:43], s9 offen lds
    s_addk_i32 s9, 23552
    buffer_load_dwordx4 v54, s[40:43], s9 offen offset:1024 lds
    s_addk_i32 s9, 23552
    buffer_load_dwordx4 v54, s[40:43], s9 offen offset:2048 lds
    s_addk_i32 s9, 23552
    buffer_load_dwordx4 v54, s[40:43], s9 offen offset:3072 lds
    v_mfma_f32_16x16x32_bf16 v[136:139], a[136:139], v[84:87], v[136:139]
    ds_read_b64_tr_b16 a[54:55], v8 offset:41056
    v_mfma_f32_16x16x32_bf16 v[136:139], a[140:143], v[88:91], v[136:139]
    ds_read_b64_tr_b16 a[56:57], v7 offset:41088
    ds_read_b64_tr_b16 a[58:59], v8 offset:41088
    v_mfma_f32_16x16x32_bf16 v[140:143], a[144:147], v[88:91], v[140:143]
    ds_read_b64_tr_b16 a[60:61], v7 offset:61568
    v_mfma_f32_16x16x32_bf16 v[140:143], a[148:151], v[84:87], v[140:143]
    s_waitcnt vmcnt(10)
    s_barrier
    ds_read_b64_tr_b16 a[62:63], v8 offset:61568
    ds_read_b64_tr_b16 a[64:65], v7 offset:5248
    v_mfma_f32_16x16x32_bf16 v[144:147], a[152:155], v[84:87], v[144:147]
    ds_read_b64_tr_b16 a[66:67], v8 offset:5248
    ds_read_b64_tr_b16 a[68:69], v7 offset:25728
    v_mfma_f32_16x16x32_bf16 v[144:147], a[156:159], v[88:91], v[144:147]
    ds_read_b64_tr_b16 a[70:71], v8 offset:25728
    v_mfma_f32_16x16x32_bf16 v[144:147], a[160:163], v[92:95], v[144:147]
    ds_read_b64_tr_b16 a[72:73], v7 offset:25696
    ds_read_b64_tr_b16 a[74:75], v8 offset:25696
    v_mfma_f32_16x16x32_bf16 v[144:147], a[164:167], v[96:99], v[144:147]
    ds_read_b64_tr_b16 a[76:77], v7 offset:5216
    v_mfma_f32_16x16x32_bf16 v[140:143], a[168:171], v[96:99], v[140:143]
    ds_read_b64_tr_b16 a[78:79], v8 offset:5216
    ds_read_b64_tr_b16 a[80:81], v7 offset:5184
    v_mfma_f32_16x16x32_bf16 v[140:143], a[172:175], v[92:95], v[140:143]
    ds_read_b64_tr_b16 a[82:83], v8 offset:5184
    ds_read_b64_tr_b16 a[84:85], v7 offset:25664
    v_mfma_f32_16x16x32_bf16 v[136:139], a[0:3], v[92:95], v[136:139]
    s_waitcnt lgkmcnt(15)
    ds_read_b64_tr_b16 a[86:87], v8 offset:25664
    v_mfma_f32_16x16x32_bf16 v[136:139], a[4:7], v[96:99], v[136:139]
    ds_read_b64_tr_b16 a[88:89], v7 offset:25632
    ds_read_b64_tr_b16 a[90:91], v8 offset:25632
    v_mfma_f32_16x16x32_bf16 v[132:135], a[8:11], v[96:99], v[132:135]
    ds_read_b64_tr_b16 a[92:93], v7 offset:5152
    v_mfma_f32_16x16x32_bf16 v[132:135], a[12:15], v[92:95], v[132:135]
    ds_read_b64_tr_b16 a[94:95], v8 offset:5152
    ds_read_b64_tr_b16 a[96:97], v7 offset:5120
    v_mfma_f32_16x16x32_bf16 v[128:131], a[16:19], v[92:95], v[128:131]
    ds_read_b64_tr_b16 a[98:99], v8 offset:5120
    ds_read_b64_tr_b16 a[100:101], v7 offset:25600
    v_mfma_f32_16x16x32_bf16 v[128:131], a[20:23], v[96:99], v[128:131]
    ds_read_b64_tr_b16 a[102:103], v8 offset:25600
    v_mfma_f32_16x16x32_bf16 v[128:131], a[24:27], v[100:103], v[128:131]
    ds_read_b64_tr_b16 a[104:105], v7 offset:46080
    ds_read_b64_tr_b16 a[106:107], v8 offset:46080
    v_mfma_f32_16x16x32_bf16 v[128:131], a[28:31], v[104:107], v[128:131]
    ds_read_b64_tr_b16 a[108:109], v48 offset:5120
    v_mfma_f32_16x16x32_bf16 v[132:135], a[32:35], v[104:107], v[132:135]
    ds_read_b64_tr_b16 a[110:111], v56 offset:5120
    ds_read_b64_tr_b16 a[112:113], v48 offset:5152
    v_mfma_f32_16x16x32_bf16 v[132:135], a[36:39], v[100:103], v[132:135]
    ds_read_b64_tr_b16 a[114:115], v56 offset:5152
    v_mfma_f32_16x16x32_bf16 v[136:139], a[40:43], v[100:103], v[136:139]
    s_waitcnt lgkmcnt(15)
    ds_read_b64_tr_b16 a[116:117], v7 offset:46112
    ds_read_b64_tr_b16 a[118:119], v8 offset:46112
    v_mfma_f32_16x16x32_bf16 v[136:139], a[44:47], v[104:107], v[136:139]
    ds_read_b64_tr_b16 a[120:121], v7 offset:46144
    ds_read_b64_tr_b16 a[122:123], v8 offset:46144
    v_mfma_f32_16x16x32_bf16 v[140:143], a[48:51], v[104:107], v[140:143]
    ds_read_b64_tr_b16 a[124:125], v48 offset:5184
    v_mfma_f32_16x16x32_bf16 v[140:143], a[52:55], v[100:103], v[140:143]
    ds_read_b64_tr_b16 a[126:127], v56 offset:5184
    ds_read_b64_tr_b16 a[128:129], v48 offset:5216
    v_mfma_f32_16x16x32_bf16 v[144:147], a[56:59], v[100:103], v[144:147]
    ds_read_b64_tr_b16 a[130:131], v56 offset:5216
    v_mfma_f32_16x16x32_bf16 v[144:147], a[60:63], v[104:107], v[144:147]
    ds_read_b64_tr_b16 a[132:133], v7 offset:46176
    ds_read_b64_tr_b16 a[134:135], v8 offset:46176
    v_mfma_f32_16x16x32_bf16 v[144:147], a[64:67], v[172:175], v[144:147]
    ds_read_b64_tr_b16 a[136:137], v7 offset:46208
    ds_read_b64_tr_b16 a[138:139], v8 offset:46208
    v_mfma_f32_16x16x32_bf16 v[144:147], a[68:71], v[176:179], v[144:147]
    ds_read_b64_tr_b16 a[140:141], v48 offset:5248
    v_mfma_f32_16x16x32_bf16 v[140:143], a[72:75], v[176:179], v[140:143]
    s_waitcnt vmcnt(4)
    s_barrier
    ds_read_b64_tr_b16 a[142:143], v56 offset:5248
    ds_read_b64_tr_b16 a[144:145], v7 offset:10368
    v_mfma_f32_16x16x32_bf16 v[140:143], a[76:79], v[172:175], v[140:143]
    ds_read_b64_tr_b16 a[146:147], v8 offset:10368
    v_mfma_f32_16x16x32_bf16 v[136:139], a[80:83], v[172:175], v[136:139]
    s_waitcnt lgkmcnt(15)
    ds_read_b64_tr_b16 a[148:149], v7 offset:30848
    ds_read_b64_tr_b16 a[150:151], v8 offset:30848
    v_mfma_f32_16x16x32_bf16 v[136:139], a[84:87], v[176:179], v[136:139]
    ds_read_b64_tr_b16 a[152:153], v7 offset:30816
    ds_read_b64_tr_b16 a[154:155], v8 offset:30816
    v_mfma_f32_16x16x32_bf16 v[132:135], a[88:91], v[176:179], v[132:135]
    ds_read_b64_tr_b16 a[156:157], v7 offset:10336
    v_mfma_f32_16x16x32_bf16 v[132:135], a[92:95], v[172:175], v[132:135]
    ds_read_b64_tr_b16 a[158:159], v8 offset:10336
    ds_read_b64_tr_b16 a[160:161], v7 offset:10304
    v_mfma_f32_16x16x32_bf16 v[128:131], a[96:99], v[172:175], v[128:131]
    ds_read_b64_tr_b16 a[162:163], v8 offset:10304
    v_mfma_f32_16x16x32_bf16 v[128:131], a[100:103], v[176:179], v[128:131]
    s_waitcnt lgkmcnt(15)
    ds_read_b64_tr_b16 a[164:165], v7 offset:30784
    ds_read_b64_tr_b16 a[166:167], v8 offset:30784
    v_mfma_f32_16x16x32_bf16 v[128:131], a[104:107], v[180:183], v[128:131]
    ds_read_b64_tr_b16 a[168:169], v7 offset:30752
    v_mov_b32 v70, 0
    v_mfma_f32_16x16x32_bf16 v[128:131], a[108:111], v[184:187], v[128:131]
L_wp1:
    s_cbranch_execz L_wp5
    ds_read_b64_tr_b16 a[170:171], v8 offset:30752
    ds_read_b64_tr_b16 a[172:173], v7 offset:10272
    v_mfma_f32_16x16x32_bf16 v[132:135], a[112:115], v[184:187], v[132:135]
    ds_read_b64_tr_b16 a[174:175], v8 offset:10272
    ds_read_b64_tr_b16 a[0:1], v7 offset:10240
    v_mfma_f32_16x16x32_bf16 v[132:135], a[116:119], v[180:183], v[132:135]
    ds_read_b64_tr_b16 a[2:3], v8 offset:10240
    v_mov_b32 v71, 0
    v_mfma_f32_16x16x32_bf16 v[136:139], a[120:123], v[180:183], v[136:139]
    s_waitcnt lgkmcnt(15)
    ds_read_b64_tr_b16 a[4:5], v7 offset:30720
    ds_read_b64_tr_b16 a[6:7], v8 offset:30720
    v_mfma_f32_16x16x32_bf16 v[136:139], a[124:127], v[184:187], v[136:139]
    ds_read_b64_tr_b16 a[8:9], v7 offset:51200
    v_mov_b32 v72, 120832
    v_mfma_f32_16x16x32_bf16 v[140:143], a[128:131], v[184:187], v[140:143]
    ds_read_b64_tr_b16 a[10:11], v8 offset:51200
    ds_read_b64_tr_b16 a[12:13], v48 offset:10240
    v_mfma_f32_16x16x32_bf16 v[140:143], a[132:135], v[180:183], v[140:143]
    ds_read_b64_tr_b16 a[14:15], v56 offset:10240
    ds_read_b64_tr_b16 a[16:17], v48 offset:10272
    v_mfma_f32_16x16x32_bf16 v[144:147], a[136:139], v[180:183], v[144:147]
    ds_read_b64_tr_b16 a[18:19], v56 offset:10272
    v_add_u32 v25, -488448, v11
    v_mfma_f32_16x16x32_bf16 v[144:147], a[140:143], v[184:187], v[144:147]
    s_waitcnt lgkmcnt(15)
    ds_read_b64_tr_b16 a[20:21], v7 offset:51232
    ds_read_b64_tr_b16 a[22:23], v8 offset:51232
    v_mfma_f32_16x16x32_bf16 v[144:147], a[144:147], v[188:191], v[144:147]
    s_mul_i32 s74, s56, 3072
    ds_read_b64_tr_b16 a[24:25], v7 offset:51264
    v_mfma_f32_16x16x32_bf16 v[144:147], a[148:151], v[192:195], v[144:147]
    ds_read_b64_tr_b16 a[26:27], v8 offset:51264
    ds_read_b64_tr_b16 a[28:29], v48 offset:10304
    v_mfma_f32_16x16x32_bf16 v[140:143], a[152:155], v[192:195], v[140:143]
    ds_read_b64_tr_b16 a[30:31], v56 offset:10304
    ds_read_b64_tr_b16 a[32:33], v48 offset:10336
    v_mfma_f32_16x16x32_bf16 v[140:143], a[156:159], v[188:191], v[140:143]
    s_xor_b32 s13, s60, 0x5bd1e995
    s_lshr_b32 s72, s59, 2
    ds_read_b64_tr_b16 a[34:35], v56 offset:10336
    v_mfma_f32_16x16x32_bf16 v[136:139], a[160:163], v[188:191], v[136:139]
    s_waitcnt lgkmcnt(14)
    ds_read_b64_tr_b16 a[36:37], v7 offset:51296
    ds_read_b64_tr_b16 a[38:39], v8 offset:51296
    v_mfma_f32_16x16x32_bf16 v[136:139], a[164:167], v[192:195], v[136:139]
    s_lshl1_add_u32 s72, s72, s4
    s_lshl_b32 s72, s72, 14
    ds_read_b64_tr_b16 a[40:41], v7 offset:51328
    v_mfma_f32_16x16x32_bf16 v[132:135], a[168:171], v[192:195], v[132:135]
    ds_read_b64_tr_b16 a[42:43], v8 offset:51328
    ds_read_b64_tr_b16 a[44:45], v48 offset:10368
    v_mfma_f32_16x16x32_bf16 v[132:135], a[172:175], v[188:191], v[132:135]
    s_add_u32 s72, s72, 262144
    ds_read_b64_tr_b16 a[46:47], v56 offset:10368
    v_mfma_f32_16x16x32_bf16 v[128:131], a[0:3], v[188:191], v[128:131]
    s_add_u32 s36, s26, s72
    s_addc_u32 s37, s27, 0
    v_mfma_f32_16x16x32_bf16 v[128:131], a[4:7], v[192:195], v[128:131]
    s_waitcnt lgkmcnt(10)
    v_mfma_f32_16x16x32_bf16 v[128:131], a[8:11], v[196:199], v[128:131]
    s_mov_b32 s38, 4096
    v_mfma_f32_16x16x32_bf16 v[128:131], a[12:15], v[200:203], v[128:131]
    v_mfma_f32_16x16x32_bf16 v[132:135], a[16:19], v[200:203], v[132:135]
    s_lshl_b32 s76, s56, 11
    v_mfma_f32_16x16x32_bf16 v[132:135], a[20:23], v[196:199], v[132:135]
    s_add_u32 s76, s76, 32768
    buffer_load_dwordx4 v[204:207], v1, s[44:47], s76 offen sc1
    v_mfma_f32_16x16x32_bf16 v[136:139], a[24:27], v[196:199], v[136:139]
    s_waitcnt lgkmcnt(0)
    v_mfma_f32_16x16x32_bf16 v[136:139], a[28:31], v[200:203], v[136:139]
    buffer_load_dwordx4 v[208:211], v1, s[44:47], s76 offen offset:1024 sc1
    v_mfma_f32_16x16x32_bf16 v[140:143], a[32:35], v[200:203], v[140:143]
    v_mul_f32 v128, v128, v27
    v_mul_f32 v129, v129, v27
    v_mfma_f32_16x16x32_bf16 v[140:143], a[36:39], v[196:199], v[140:143]
    v_mul_f32 v130, v130, v27
    v_mul_f32 v131, v131, v27
    v_cvt_pk_bf16_f32 v60, v128, v129
    v_cvt_pk_bf16_f32 v61, v130, v131
    v_mfma_f32_16x16x32_bf16 v[144:147], a[40:43], v[196:199], v[144:147]
    v_mul_f32 v132, v132, v27
    v_mfma_f32_16x16x32_bf16 v[144:147], a[44:47], v[200:203], v[144:147]
    v_mul_f32 v133, v133, v27
    v_mul_f32 v134, v134, v27
    v_mul_f32 v135, v135, v27
    ds_write_b32 v25, v70
    ds_write2_b64 v72, v[70:71], v[70:71] offset0:0 offset1:160
    ds_write_b64 v59, v[60:61]
    v_cvt_pk_bf16_f32 v62, v132, v133
    v_cvt_pk_bf16_f32 v63, v134, v135
    v_mul_f32 v136, v136, v27
    v_mul_f32 v137, v137, v27
    v_mul_f32 v138, v138, v27
    v_mul_f32 v139, v139, v27
    v_cvt_pk_bf16_f32 v64, v136, v137
    v_cvt_pk_bf16_f32 v65, v138, v139
    v_mfma_f32_16x16x32_bf16 v[76:79], v[60:63], v[60:63], 0
    ds_write_b64 v59, v[62:63] offset:1024
    ds_write_b64 v59, v[64:65] offset:2048
    v_mul_f32 v140, v140, v27
    v_mul_f32 v141, v141, v27
    v_mul_f32 v142, v142, v27
    v_mul_f32 v143, v143, v27
    v_cvt_pk_bf16_f32 v66, v140, v141
    v_cvt_pk_bf16_f32 v67, v142, v143
    v_mul_f32 v144, v144, v27
    v_mul_f32 v145, v145, v27
    v_mul_f32 v146, v146, v27
    v_mul_f32 v147, v147, v27
    v_cvt_pk_bf16_f32 v68, v144, v145
    v_cvt_pk_bf16_f32 v69, v146, v147
    v_mfma_f32_16x16x32_bf16 v[76:79], v[64:67], v[64:67], v[76:79]
    ds_write_b64 v59, v[66:67] offset:3072
    v_mfma_f32_16x16x32_bf16 v[76:79], v[68:71], v[68:71], v[76:79]
    ds_write_b64 v59, v[68:69] offset:4096
    s_mov_b32 s3, 1048576
    s_waitcnt vmcnt(0)
L_kvchk:
    v_xor_b32 v204, s60, v204
    v_xor_b32 v208, s60, v208
    v_xor_b32 v207, s13, v207
    v_xor_b32 v211, s13, v211
    v_or_b32 v204, v204, v207
    v_or3_b32 v204, v204, v208, v211
    v_cmp_ne_u32 vcc, 0, v204
    s_cbranch_vccnz L_kvlate
L_kvok:
    v_max_f32 v209, v205, v209
    ds_write_b32 v242, v209
    v_max3_f32 v76, v76, v77, v78
    v_max_f32 v76, v76, v79
    ds_write_b32 v242, v76 offset:1024
    s_waitcnt lgkmcnt(0)
    s_barrier
    buffer_load_dwordx4 v[196:199], v1, s[36:39], 0 offen
    buffer_load_dwordx4 v[244:247], v1, s[36:39], 0 offen offset:3072
    buffer_load_dwordx4 v[212:215], v49, s[36:39], 0 offen offset:1024
    buffer_load_dwordx4 v[216:219], v49, s[36:39], 0 offen offset:2048
    ds_read2_b64 v[188:191], v241 offset0:0 offset1:160
    ds_read2_b64 v[172:175], v239 offset0:0 offset1:32
    ds_read_b128 v[28:31], v243
    ds_read_b128 v[32:35], v243 offset:1024
    ds_read2_b64 v[192:195], v240 offset0:0 offset1:160
    ds_read2_b64 v[176:179], v239 offset0:160 offset1:192
    ds_read2_b64 v[180:183], v238 offset0:0 offset1:32
    ds_read2_b64 v[184:187], v238 offset0:160 offset1:192
    v_mfma_f32_32x32x8_bf16 v[108:123], v[70:71], v[70:71], 0
    s_xor_b32 s36, s36, 4096
    buffer_load_dwordx4 v[200:203], v1, s[36:39], 0 offen
    s_cmp_lt_u32 s9, 1966080
    s_cselect_b32 s42, 4096, 0
    v_mfma_f32_32x32x8_bf16 v[124:139], v[70:71], v[70:71], 0
    buffer_load_dwordx4 v[220:223], v49, s[36:39], 0 offen offset:1024
    s_add_u32 s40, s26, s11
    s_mov_b32 s41, s27
    v_mfma_f32_32x32x8_bf16 v[140:155], v[70:71], v[70:71], 0
    buffer_load_dwordx4 v[224:227], v49, s[36:39], 0 offen offset:2048
    ds_read_b64_tr_b16 a[224:225], v24
    ds_read_b64_tr_b16 a[226:227], v24 offset:512
    v_mfma_f32_32x32x8_bf16 v[156:171], v[70:71], v[70:71], 0
    s_xor_b32 s36, s36, 12288
    buffer_load_dwordx4 v[204:207], v1, s[36:39], 0 offen
    ds_read_b64_tr_b16 a[228:229], v24 offset:32
    ds_read_b64_tr_b16 a[230:231], v24 offset:544
    buffer_load_dwordx4 v[248:251], v1, s[36:39], 0 offen offset:3072
    ds_read_b64_tr_b16 a[232:233], v24 offset:64
    ds_read_b64_tr_b16 a[234:235], v24 offset:576
    buffer_load_dwordx4 v[228:231], v49, s[36:39], 0 offen offset:1024
    ds_read_b64_tr_b16 a[236:237], v24 offset:96
    ds_read_b64_tr_b16 a[238:239], v24 offset:608
    buffer_load_dwordx4 v[232:235], v49, s[36:39], 0 offen offset:2048
    s_waitcnt lgkmcnt(12)
    v_max3_f32 v28, v28, v29, v30
    v_max3_f32 v32, v32, v33, v34
    v_max_f32 v28, v28, v31
    v_max_f32 v32, v32, v35
    v_add_u32 v2, 4096, v1
    v_max_f32_dpp v28, v28, v28 row_shr:1 row_mask:0xf bank_mask:0xf
    v_lshlrev_b32 v7, 5, v16
    v_lshlrev_b32 v8, 7, v0
    v_max_f32_dpp v28, v28, v28 row_shr:2 row_mask:0xf bank_mask:0xf
    s_waitcnt vmcnt(7)
    v_mfma_f32_32x32x8_bf16 v[60:75], v[244:245], v[188:189], 0
    v_max_f32_dpp v28, v28, v28 row_shr:4 row_mask:0xf bank_mask:0xf
    v_mfma_f32_32x32x16_bf16 v[60:75], v[196:199], v[172:175], v[60:75]
    s_waitcnt lgkmcnt(8)
    v_max_f32_dpp v28, v28, v28 row_shr:8 row_mask:0xf bank_mask:0xf
    s_nop 1
    v_max_f32_dpp v28, v28, v28 row_bcast:15 row_mask:0xa bank_mask:0xf
    s_nop 1
    v_max_f32_dpp v28, v28, v28 row_bcast:31 row_mask:0xc bank_mask:0xf
    s_nop 0
    v_readlane_b32 s76, v28, 63
    s_nop 1
    v_mul_f32 v32, s76, v32
    v_cmp_nge_f32 vcc, 0x45480000, v32
    s_cbranch_vccnz L_rowmax
L_attn:
    v_mfma_f32_32x32x8_bf16 v[76:91], v[244:245], v[190:191], 0
    v_exp_f32 v60, v60
    v_exp_f32 v61, v61
    v_exp_f32 v62, v62
    v_exp_f32 v63, v63
    v_mfma_f32_32x32x16_bf16 v[76:91], v[196:199], v[176:179], v[76:91]
    s_xor_b32 s36, s36, 4096
    v_exp_f32 v64, v64
    v_exp_f32 v65, v65
    v_exp_f32 v66, v66
    v_exp_f32 v67, v67
    buffer_load_dwordx4 v[208:211], v1, s[36:39], 0 offen
    buffer_load_dwordx4 v[236:239], v49, s[36:39], 0 offen offset:1024
    v_exp_f32 v68, v68
    v_exp_f32 v69, v69
    v_exp_f32 v70, v70
    v_exp_f32 v71, v71
    v_smfmac_f32_32x32x32_bf16 v[108:123], v[212:215], v[60:67], v50
    s_lshr_b32 s76, s59, 1
    s_lshl_b32 s76, s76, 9
    v_exp_f32 v72, v72
    v_exp_f32 v73, v73
    v_exp_f32 v74, v74
    v_exp_f32 v75, v75
    v_mfma_f32_32x32x8_bf16 v[92:107], v[244:245], v[192:193], 0
    v_exp_f32 v76, v76
    v_exp_f32 v77, v77
    v_exp_f32 v78, v78
    v_exp_f32 v79, v79
    v_mfma_f32_32x32x16_bf16 v[92:107], v[196:199], v[180:183], v[92:107]
    buffer_load_dwordx4 v[240:243], v49, s[36:39], 0 offen offset:2048
    v_exp_f32 v80, v80
    v_exp_f32 v81, v81
    v_exp_f32 v82, v82
    v_exp_f32 v83, v83
    v_smfmac_f32_32x32x32_bf16 v[108:123], v[216:219], v[68:75], v50
    s_waitcnt lgkmcnt(0)
    s_add_u32 s76, s76, 32768
    v_exp_f32 v84, v84
    v_exp_f32 v85, v85
    v_exp_f32 v86, v86
    v_exp_f32 v87, v87
    v_smfmac_f32_32x32x32_bf16 v[124:139], v[212:215], v[76:83], v50
    buffer_store_dwordx4 a[224:227], v1, s[40:43], 0 offen sc1
    v_exp_f32 v88, v88
    v_exp_f32 v89, v89
    v_exp_f32 v90, v90
    v_exp_f32 v91, v91
    v_mfma_f32_32x32x8_bf16 v[60:75], v[244:245], v[194:195], 0
    v_exp_f32 v92, v92
    v_exp_f32 v93, v93
    v_exp_f32 v94, v94
    v_exp_f32 v95, v95
    v_mfma_f32_32x32x16_bf16 v[60:75], v[196:199], v[184:187], v[60:75]
    buffer_store_dwordx4 a[228:231], v1, s[40:43], 0 offen offset:1024 sc1
    buffer_store_dwordx4 a[232:235], v1, s[40:43], 0 offen offset:2048 sc1
    v_exp_f32 v96, v96
    v_exp_f32 v97, v97
    v_exp_f32 v98, v98
    v_exp_f32 v99, v99
    v_smfmac_f32_32x32x32_bf16 v[124:139], v[216:219], v[84:91], v50
    s_lshl2_add_u32 s16, s61, s56
    s_lshl_b32 s75, s59, 2
    v_exp_f32 v100, v100
    v_exp_f32 v101, v101
    v_exp_f32 v102, v102
    v_exp_f32 v103, v103
    v_smfmac_f32_32x32x32_bf16 v[140:155], v[212:215], v[92:99], v50
    s_waitcnt vmcnt(10)
    s_add_u32 s75, s75, s56
    v_exp_f32 v104, v104
    v_exp_f32 v105, v105
    v_exp_f32 v106, v106
    v_exp_f32 v107, v107
    v_mfma_f32_32x32x8_bf16 v[76:91], v[246:247], v[188:189], 0
    v_exp_f32 v60, v60
    v_exp_f32 v61, v61
    v_exp_f32 v62, v62
    v_exp_f32 v63, v63
    v_mfma_f32_32x32x16_bf16 v[76:91], v[200:203], v[172:175], v[76:91]
    buffer_store_dwordx4 a[236:239], v1, s[40:43], 0 offen offset:3072 sc1
    v_exp_f32 v64, v64
    v_exp_f32 v65, v65
    v_exp_f32 v66, v66
    v_exp_f32 v67, v67
    v_smfmac_f32_32x32x32_bf16 v[140:155], v[216:219], v[100:107], v50
    s_xor_b32 s36, s36, 45056
    s_mul_i32 s75, s75, 20480
    v_exp_f32 v68, v68
    v_exp_f32 v69, v69
    v_exp_f32 v70, v70
    v_exp_f32 v71, v71
    v_smfmac_f32_32x32x32_bf16 v[156:171], v[212:215], v[60:67], v50
    s_mul_i32 s77, s57, 160
    s_add_u32 s75, s75, s77
    v_exp_f32 v72, v72
    v_exp_f32 v73, v73
    v_exp_f32 v74, v74
    v_exp_f32 v75, v75
    v_mfma_f32_32x32x8_bf16 v[92:107], v[246:247], v[190:191], 0
    v_exp_f32 v76, v76
    v_exp_f32 v77, v77
    v_exp_f32 v78, v78
    v_exp_f32 v79, v79
    v_mfma_f32_32x32x16_bf16 v[92:107], v[200:203], v[176:179], v[92:107]
    v_mov_b32 v46, s60
    v_exp_f32 v80, v80
    v_exp_f32 v81, v81
    v_exp_f32 v82, v82
    v_exp_f32 v83, v83
    v_smfmac_f32_32x32x32_bf16 v[156:171], v[216:219], v[68:75], v50
    buffer_load_dwordx4 v[196:199], v1, s[36:39], 0 offen
    buffer_load_dwordx4 v[252:255], v1, s[36:39], 0 offen offset:3072
    v_exp_f32 v84, v84
    v_exp_f32 v85, v85
    v_exp_f32 v86, v86
    v_exp_f32 v87, v87
    v_smfmac_f32_32x32x32_bf16 v[108:123], v[220:223], v[76:83], v50
    s_add_u32 s28, s28, s75
    s_addc_u32 s29, s29, 0
    v_exp_f32 v88, v88
    v_exp_f32 v89, v89
    v_exp_f32 v90, v90
    v_exp_f32 v91, v91
    v_mfma_f32_32x32x8_bf16 v[60:75], v[246:247], v[192:193], 0
    v_exp_f32 v92, v92
    v_exp_f32 v93, v93
    v_exp_f32 v94, v94
    v_exp_f32 v95, v95
    v_mfma_f32_32x32x16_bf16 v[60:75], v[200:203], v[180:183], v[60:75]
    v_mov_b32 v47, s13
    v_exp_f32 v96, v96
    v_exp_f32 v97, v97
    v_exp_f32 v98, v98
    v_exp_f32 v99, v99
    v_smfmac_f32_32x32x32_bf16 v[108:123], v[224:227], v[84:91], v50
    buffer_load_dwordx4 v[212:215], v49, s[36:39], 0 offen offset:1024
    buffer_load_dwordx4 v[216:219], v49, s[36:39], 0 offen offset:2048
    v_exp_f32 v100, v100
    v_exp_f32 v101, v101
    v_exp_f32 v102, v102
    v_exp_f32 v103, v103
    v_smfmac_f32_32x32x32_bf16 v[124:139], v[220:223], v[92:99], v50
    s_mov_b32 m0, s12
    s_mov_b32 s30, 20480
    v_exp_f32 v104, v104
    v_exp_f32 v105, v105
    v_exp_f32 v106, v106
    v_exp_f32 v107, v107
    v_mfma_f32_32x32x8_bf16 v[76:91], v[246:247], v[194:195], 0
    v_exp_f32 v60, v60
    v_exp_f32 v61, v61
    v_exp_f32 v62, v62
    v_exp_f32 v63, v63
    v_mfma_f32_32x32x16_bf16 v[76:91], v[200:203], v[184:187], v[76:91]
    buffer_load_dwordx4 v21, s[64:67], s20 offen lds
    v_exp_f32 v64, v64
    v_exp_f32 v65, v65
    v_exp_f32 v66, v66
    v_exp_f32 v67, v67
    v_smfmac_f32_32x32x32_bf16 v[124:139], v[224:227], v[100:107], v50
    s_addk_i32 s20, 9216
    s_lshl_b32 s78, s59, 3
    v_exp_f32 v68, v68
    v_exp_f32 v69, v69
    v_exp_f32 v70, v70
    v_exp_f32 v71, v71
    v_smfmac_f32_32x32x32_bf16 v[140:155], v[220:223], v[60:67], v50
    s_waitcnt vmcnt(12)
    s_add_u32 s78, s78, s57
    v_exp_f32 v72, v72
    v_exp_f32 v73, v73
    v_exp_f32 v74, v74
    v_exp_f32 v75, v75
    v_mfma_f32_32x32x8_bf16 v[92:107], v[248:249], v[188:189], 0
    v_exp_f32 v76, v76
    v_exp_f32 v77, v77
    v_exp_f32 v78, v78
    v_exp_f32 v79, v79
    v_mfma_f32_32x32x16_bf16 v[92:107], v[204:207], v[172:175], v[92:107]
    buffer_load_dwordx4 v21, s[64:67], s20 offen offset:1024 lds
    buffer_load_dword v7, v7, s[44:47], s76 offen offset:8 sc1
    v_exp_f32 v80, v80
    v_exp_f32 v81, v81
    v_exp_f32 v82, v82
    v_exp_f32 v83, v83
    v_smfmac_f32_32x32x32_bf16 v[140:155], v[224:227], v[68:75], v50
    s_xor_b32 s36, s36, 4096
    s_lshl_b32 s78, s78, 4
    v_exp_f32 v84, v84
    v_exp_f32 v85, v85
    v_exp_f32 v86, v86
    v_exp_f32 v87, v87
    v_smfmac_f32_32x32x32_bf16 v[156:171], v[220:223], v[76:83], v50
    s_lshl_b32 s77, s61, 4
    s_sub_u32 s78, s78, s77
    v_exp_f32 v88, v88
    v_exp_f32 v89, v89
    v_exp_f32 v90, v90
    v_exp_f32 v91, v91
    v_mfma_f32_32x32x8_bf16 v[60:75], v[248:249], v[190:191], 0
    v_exp_f32 v92, v92
    v_exp_f32 v93, v93
    v_exp_f32 v94, v94
    v_exp_f32 v95, v95
    v_mfma_f32_32x32x16_bf16 v[60:75], v[204:207], v[176:179], v[60:75]
    v_cmp_gt_u32 vcc, 13, v0
    v_exp_f32 v96, v96
    v_exp_f32 v97, v97
    v_exp_f32 v98, v98
    v_exp_f32 v99, v99
    v_smfmac_f32_32x32x32_bf16 v[156:171], v[224:227], v[84:91], v50
    buffer_load_dwordx4 v[200:203], v1, s[36:39], 0 offen
    buffer_load_dwordx4 v[220:223], v49, s[36:39], 0 offen offset:1024
    v_exp_f32 v100, v100
    v_exp_f32 v101, v101
    v_exp_f32 v102, v102
    v_exp_f32 v103, v103
    v_smfmac_f32_32x32x32_bf16 v[108:123], v[228:231], v[92:99], v50
    s_add_u32 s78, s78, 614400
    s_lshl_b32 s77, s56, 22
    v_exp_f32 v104, v104
    v_exp_f32 v105, v105
    v_exp_f32 v106, v106
    v_exp_f32 v107, v107
    v_mfma_f32_32x32x8_bf16 v[76:91], v[248:249], v[192:193], 0
    v_exp_f32 v60, v60
    v_exp_f32 v61, v61
    v_exp_f32 v62, v62
    v_exp_f32 v63, v63
    v_mfma_f32_32x32x16_bf16 v[76:91], v[204:207], v[180:183], v[76:91]
    v_mov_b32 v44, 0x7ff00000
    v_exp_f32 v64, v64
    v_exp_f32 v65, v65
    v_exp_f32 v66, v66
    v_exp_f32 v67, v67
    v_smfmac_f32_32x32x32_bf16 v[108:123], v[232:235], v[100:107], v50
    buffer_load_dwordx4 v[224:227], v49, s[36:39], 0 offen offset:2048
    v_exp_f32 v68, v68
    v_exp_f32 v69, v69
    v_exp_f32 v70, v70
    v_exp_f32 v71, v71
    v_smfmac_f32_32x32x32_bf16 v[124:139], v[228:231], v[60:67], v50
    s_addk_i32 s20, 9216
    s_add_u32 s78, s78, s77
    v_exp_f32 v72, v72
    v_exp_f32 v73, v73
    v_exp_f32 v74, v74
    v_exp_f32 v75, v75
    v_mfma_f32_32x32x8_bf16 v[92:107], v[248:249], v[194:195], 0
    v_exp_f32 v76, v76
    v_exp_f32 v77, v77
    v_exp_f32 v78, v78
    v_exp_f32 v79, v79
    v_mfma_f32_32x32x16_bf16 v[92:107], v[204:207], v[184:187], v[92:107]
    v_cndmask_b32 v8, v44, v8, vcc
    v_exp_f32 v80, v80
    v_exp_f32 v81, v81
    v_exp_f32 v82, v82
    v_exp_f32 v83, v83
    v_smfmac_f32_32x32x32_bf16 v[124:139], v[232:235], v[68:75], v50
    buffer_load_dwordx4 v21, s[64:67], s20 offen offset:2048 lds
    v_exp_f32 v84, v84
    v_exp_f32 v85, v85
    v_exp_f32 v86, v86
    v_exp_f32 v87, v87
    v_smfmac_f32_32x32x32_bf16 v[140:155], v[228:231], v[76:83], v50
    s_waitcnt vmcnt(15)
    s_addk_i32 s20, 9216
    v_exp_f32 v88, v88
    v_exp_f32 v89, v89
    v_exp_f32 v90, v90
    v_exp_f32 v91, v91
    v_mfma_f32_32x32x8_bf16 v[60:75], v[250:251], v[188:189], 0
    v_exp_f32 v92, v92
    v_exp_f32 v93, v93
    v_exp_f32 v94, v94
    v_exp_f32 v95, v95
    v_mfma_f32_32x32x16_bf16 v[60:75], v[208:211], v[172:175], v[60:75]
    v_mov_b32 v19, 1
    v_exp_f32 v96, v96
    v_exp_f32 v97, v97
    v_exp_f32 v98, v98
    v_exp_f32 v99, v99
    v_smfmac_f32_32x32x32_bf16 v[140:155], v[232:235], v[84:91], v50
    buffer_load_dwordx4 v21, s[64:67], s20 offen offset:3072 lds
    v_exp_f32 v100, v100
    v_exp_f32 v101, v101
    v_exp_f32 v102, v102
    v_exp_f32 v103, v103
    v_smfmac_f32_32x32x32_bf16 v[156:171], v[228:231], v[92:99], v50
    s_xor_b32 s36, s36, 12288
    s_lshl_b32 s79, s56, 10
    v_exp_f32 v104, v104
    v_exp_f32 v105, v105
    v_exp_f32 v106, v106
    v_exp_f32 v107, v107
    v_mfma_f32_32x32x8_bf16 v[76:91], v[250:251], v[190:191], 0
    v_exp_f32 v60, v60
    v_exp_f32 v61, v61
    v_exp_f32 v62, v62
    v_exp_f32 v63, v63
    v_mfma_f32_32x32x16_bf16 v[76:91], v[208:211], v[176:179], v[76:91]
    s_add_u32 s64, s68, s21
    s_mov_b32 s65, s69
    v_exp_f32 v64, v64
    v_exp_f32 v65, v65
    v_exp_f32 v66, v66
    v_exp_f32 v67, v67
    v_smfmac_f32_32x32x32_bf16 v[156:171], v[232:235], v[100:107], v50
    buffer_load_dwordx4 v[204:207], v1, s[36:39], 0 offen
    buffer_load_dwordx4 v[244:247], v1, s[36:39], 0 offen offset:3072
    v_exp_f32 v68, v68
    v_exp_f32 v69, v69
    v_exp_f32 v70, v70
    v_exp_f32 v71, v71
    v_smfmac_f32_32x32x32_bf16 v[108:123], v[236:239], v[60:67], v50
    s_add_u32 s79, s79, 1179648
    s_lshl_b32 s18, s58, 1
    v_exp_f32 v72, v72
    v_exp_f32 v73, v73
    v_exp_f32 v74, v74
    v_exp_f32 v75, v75
    v_mfma_f32_32x32x8_bf16 v[92:107], v[250:251], v[192:193], 0
    v_exp_f32 v76, v76
    v_exp_f32 v77, v77
    v_exp_f32 v78, v78
    v_exp_f32 v79, v79
    v_mfma_f32_32x32x16_bf16 v[92:107], v[208:211], v[180:183], v[92:107]
    s_cmp_lt_u32 s21, 2785280
    s_cselect_b32 s66, 4096, 0
    v_exp_f32 v80, v80
    v_exp_f32 v81, v81
    v_exp_f32 v82, v82
    v_exp_f32 v83, v83
    v_smfmac_f32_32x32x32_bf16 v[108:123], v[240:243], v[68:75], v50
    buffer_load_dwordx4 v[228:231], v49, s[36:39], 0 offen offset:1024
    buffer_load_dwordx4 v[232:235], v49, s[36:39], 0 offen offset:2048
    v_exp_f32 v84, v84
    v_exp_f32 v85, v85
    v_exp_f32 v86, v86
    v_exp_f32 v87, v87
    v_smfmac_f32_32x32x32_bf16 v[124:139], v[236:239], v[76:83], v50
    s_and_b32 s77, s56, 1
    s_add_u32 s18, s18, s77
    v_exp_f32 v88, v88
    v_exp_f32 v89, v89
    v_exp_f32 v90, v90
    v_exp_f32 v91, v91
    v_mfma_f32_32x32x8_bf16 v[60:75], v[250:251], v[194:195], 0
    v_exp_f32 v92, v92
    v_exp_f32 v93, v93
    v_exp_f32 v94, v94
    v_exp_f32 v95, v95
    v_mfma_f32_32x32x16_bf16 v[60:75], v[208:211], v[184:187], v[60:75]
    buffer_load_dword v43, v11, s[48:51], 0 offen sc1
    v_exp_f32 v96, v96
    v_exp_f32 v97, v97
    v_exp_f32 v98, v98
    v_exp_f32 v99, v99
    v_smfmac_f32_32x32x32_bf16 v[124:139], v[240:243], v[84:91], v50
    s_xor_b32 s36, s36, 4096
    s_mul_i32 s18, s18, 40960
    v_exp_f32 v100, v100
    v_exp_f32 v101, v101
    v_exp_f32 v102, v102
    v_exp_f32 v103, v103
    v_smfmac_f32_32x32x32_bf16 v[140:155], v[236:239], v[92:99], v50
    s_waitcnt vmcnt(13)
    s_lshl_b32 s77, s57, 1
    v_exp_f32 v104, v104
    v_exp_f32 v105, v105
    v_exp_f32 v106, v106
    v_exp_f32 v107, v107
    v_mfma_f32_32x32x8_bf16 v[76:91], v[252:253], v[188:189], 0
    v_exp_f32 v60, v60
    v_exp_f32 v61, v61
    v_exp_f32 v62, v62
    v_exp_f32 v63, v63
    v_mfma_f32_32x32x16_bf16 v[76:91], v[196:199], v[172:175], v[76:91]
    ds_add_u32 v25, v19
    v_exp_f32 v64, v64
    v_exp_f32 v65, v65
    v_exp_f32 v66, v66
    v_exp_f32 v67, v67
    v_smfmac_f32_32x32x32_bf16 v[140:155], v[240:243], v[100:107], v50
    s_add_u32 s77, s77, s4
    s_mul_i32 s77, s77, 1280
    v_exp_f32 v68, v68
    v_exp_f32 v69, v69
    v_exp_f32 v70, v70
    v_exp_f32 v71, v71
    v_smfmac_f32_32x32x32_bf16 v[156:171], v[236:239], v[60:67], v50
    s_add_u32 s18, s18, s77
    s_add_u32 s18, s18, 8192
    v_exp_f32 v72, v72
    v_exp_f32 v73, v73
    v_exp_f32 v74, v74
    v_exp_f32 v75, v75
    v_mfma_f32_32x32x8_bf16 v[92:107], v[252:253], v[190:191], 0
    v_exp_f32 v76, v76
    v_exp_f32 v77, v77
    v_exp_f32 v78, v78
    v_exp_f32 v79, v79
    v_mfma_f32_32x32x16_bf16 v[92:107], v[196:199], v[176:179], v[92:107]
    ds_read_b32 v5, v25
    v_exp_f32 v80, v80
    v_exp_f32 v81, v81
    v_exp_f32 v82, v82
    v_exp_f32 v83, v83
    v_smfmac_f32_32x32x32_bf16 v[156:171], v[240:243], v[68:75], v50
    buffer_load_dwordx4 v[208:211], v1, s[36:39], 0 offen
    buffer_load_dwordx4 v[236:239], v49, s[36:39], 0 offen offset:1024
    v_exp_f32 v84, v84
    v_exp_f32 v85, v85
    v_exp_f32 v86, v86
    v_exp_f32 v87, v87
    v_smfmac_f32_32x32x32_bf16 v[108:123], v[212:215], v[76:83], v50
    s_waitcnt lgkmcnt(0)
    v_cmp_gt_u32 vcc, 4, v5
    v_exp_f32 v88, v88
    v_exp_f32 v89, v89
    v_exp_f32 v90, v90
    v_exp_f32 v91, v91
    v_mfma_f32_32x32x8_bf16 v[60:75], v[252:253], v[192:193], 0
    v_exp_f32 v92, v92
    v_exp_f32 v93, v93
    v_exp_f32 v94, v94
    v_exp_f32 v95, v95
    v_mfma_f32_32x32x16_bf16 v[60:75], v[196:199], v[180:183], v[60:75]
    s_cbranch_vccnz L_bl1
L_bk1:
    s_waitcnt vmcnt(12)
    v_exp_f32 v96, v96
    v_exp_f32 v97, v97
    v_exp_f32 v98, v98
    v_exp_f32 v99, v99
    v_smfmac_f32_32x32x32_bf16 v[108:123], v[216:219], v[84:91], v50
    buffer_load_dwordx4 v[240:243], v49, s[36:39], 0 offen offset:2048
    buffer_store_dwordx2 v[46:47], v9, s[44:47], s78 offen sc1
    v_exp_f32 v100, v100
    v_exp_f32 v101, v101
    v_exp_f32 v102, v102
    v_exp_f32 v103, v103
    v_smfmac_f32_32x32x32_bf16 v[124:139], v[212:215], v[92:99], v50
    s_lshl_b32 s6, s58, 2
    s_add_u32 s6, s6, s56
    v_exp_f32 v104, v104
    v_exp_f32 v105, v105
    v_exp_f32 v106, v106
    v_exp_f32 v107, v107
    v_mfma_f32_32x32x8_bf16 v[76:91], v[252:253], v[194:195], 0
    v_exp_f32 v60, v60
    v_exp_f32 v61, v61
    v_exp_f32 v62, v62
    v_exp_f32 v63, v63
    v_mfma_f32_32x32x16_bf16 v[76:91], v[196:199], v[184:187], v[76:91]
    v_cmp_ne_u32 vcc, s63, v7
    v_exp_f32 v64, v64
    v_exp_f32 v65, v65
    v_exp_f32 v66, v66
    v_exp_f32 v67, v67
    v_smfmac_f32_32x32x32_bf16 v[124:139], v[216:219], v[100:107], v50
    buffer_load_dwordx2 v[28:29], v58, s[28:31], 0 offen
    buffer_load_dwordx2 v[30:31], v58, s[28:31], 0 offen offset:32
    v_exp_f32 v68, v68
    v_exp_f32 v69, v69
    v_exp_f32 v70, v70
    v_exp_f32 v71, v71
    v_smfmac_f32_32x32x32_bf16 v[140:155], v[212:215], v[60:67], v50
    s_waitcnt vmcnt(13)
    s_mul_i32 s6, s6, 20480
    v_exp_f32 v72, v72
    v_exp_f32 v73, v73
    v_exp_f32 v74, v74
    v_exp_f32 v75, v75
    v_mfma_f32_32x32x8_bf16 v[92:107], v[254:255], v[188:189], 0
    v_exp_f32 v76, v76
    v_exp_f32 v77, v77
    v_exp_f32 v78, v78
    v_exp_f32 v79, v79
    v_mfma_f32_32x32x16_bf16 v[92:107], v[200:203], v[172:175], v[92:107]
    s_cmp_lg_u64 vcc, 0
    s_cselect_b64 s[62:63], 1, 0
    s_cselect_b32 s16, 0x1000, s16
    v_exp_f32 v80, v80
    v_exp_f32 v81, v81
    v_exp_f32 v82, v82
    v_exp_f32 v83, v83
    v_smfmac_f32_32x32x32_bf16 v[140:155], v[216:219], v[68:75], v50
    buffer_load_dwordx2 v[32:33], v58, s[28:31], 0 offen offset:64
    v_exp_f32 v84, v84
    v_exp_f32 v85, v85
    v_exp_f32 v86, v86
    v_exp_f32 v87, v87
    v_smfmac_f32_32x32x32_bf16 v[156:171], v[212:215], v[76:83], v50
    s_xor_b32 s36, s36, 110592
    s_mul_i32 s22, s56, 491520
    v_exp_f32 v88, v88
    v_exp_f32 v89, v89
    v_exp_f32 v90, v90
    v_exp_f32 v91, v91
    v_mfma_f32_32x32x8_bf16 v[60:75], v[254:255], v[190:191], 0
    v_exp_f32 v92, v92
    v_exp_f32 v93, v93
    v_exp_f32 v94, v94
    v_exp_f32 v95, v95
    v_mfma_f32_32x32x16_bf16 v[60:75], v[200:203], v[176:179], v[60:75]
    buffer_load_dwordx4 v[196:199], v1, s[36:39], 0 offen
    v_exp_f32 v96, v96
    v_exp_f32 v97, v97
    v_exp_f32 v98, v98
    v_exp_f32 v99, v99
    v_smfmac_f32_32x32x32_bf16 v[156:171], v[216:219], v[84:91], v50
    buffer_load_dwordx4 v[248:251], v1, s[36:39], 0 offen offset:3072
    v_exp_f32 v100, v100
    v_exp_f32 v101, v101
    v_exp_f32 v102, v102
    v_exp_f32 v103, v103
    v_smfmac_f32_32x32x32_bf16 v[108:123], v[220:223], v[92:99], v50
    s_add_u32 s22, s22, 819200
    s_lshr_b32 s17, s2, 3
    v_exp_f32 v104, v104
    v_exp_f32 v105, v105
    v_exp_f32 v106, v106
    v_exp_f32 v107, v107
    v_mfma_f32_32x32x8_bf16 v[76:91], v[254:255], v[192:193], 0
    v_exp_f32 v60, v60
    v_exp_f32 v61, v61
    v_exp_f32 v62, v62
    v_exp_f32 v63, v63
    v_mfma_f32_32x32x16_bf16 v[76:91], v[200:203], v[180:183], v[76:91]
    buffer_load_dwordx4 v[212:215], v49, s[36:39], 0 offen offset:1024
    buffer_load_dwordx4 v[216:219], v49, s[36:39], 0 offen offset:2048
    v_exp_f32 v64, v64
    v_exp_f32 v65, v65
    v_exp_f32 v66, v66
    v_exp_f32 v67, v67
    v_smfmac_f32_32x32x32_bf16 v[108:123], v[224:227], v[100:107], v50
    s_mul_i32 s19, s16, 1664
    s_mul_i32 s17, s17, 2560
    v_exp_f32 v68, v68
    v_exp_f32 v69, v69
    v_exp_f32 v70, v70
    v_exp_f32 v71, v71
    v_smfmac_f32_32x32x32_bf16 v[124:139], v[220:223], v[60:67], v50
L_wp2:
    s_cbranch_execz L_wret0
    s_add_u32 s17, s17, s22
    s_mul_i32 s77, s57, 5120
    v_exp_f32 v72, v72
    v_exp_f32 v73, v73
    v_exp_f32 v74, v74
    v_exp_f32 v75, v75
    v_mfma_f32_32x32x8_bf16 v[92:107], v[254:255], v[194:195], 0
    v_exp_f32 v76, v76
    v_exp_f32 v77, v77
    v_exp_f32 v78, v78
    v_exp_f32 v79, v79
    v_mfma_f32_32x32x16_bf16 v[92:107], v[200:203], v[184:187], v[92:107]
    buffer_load_dword v42, v8, s[48:51], s19 offen sc1
    v_exp_f32 v80, v80
    v_exp_f32 v81, v81
    v_exp_f32 v82, v82
    v_exp_f32 v83, v83
    v_smfmac_f32_32x32x32_bf16 v[124:139], v[224:227], v[68:75], v50
    s_xor_b32 s36, s36, 4096
    s_add_u32 s22, s22, s77
    v_exp_f32 v84, v84
    v_exp_f32 v85, v85
    v_exp_f32 v86, v86
    v_exp_f32 v87, v87
    v_smfmac_f32_32x32x32_bf16 v[140:155], v[220:223], v[76:83], v50
    s_waitcnt vmcnt(13)
    s_mul_i32 s8, s56, 40960
    v_exp_f32 v88, v88
    v_exp_f32 v89, v89
    v_exp_f32 v90, v90
    v_exp_f32 v91, v91
    v_mfma_f32_32x32x8_bf16 v[60:75], v[244:245], v[188:189], 0
    v_exp_f32 v92, v92
    v_exp_f32 v93, v93
    v_exp_f32 v94, v94
    v_exp_f32 v95, v95
    v_mfma_f32_32x32x16_bf16 v[60:75], v[204:207], v[172:175], v[60:75]
    s_add_u32 s8, s8, s77
    v_exp_f32 v96, v96
    v_exp_f32 v97, v97
    v_exp_f32 v98, v98
    v_exp_f32 v99, v99
    v_smfmac_f32_32x32x32_bf16 v[140:155], v[224:227], v[84:91], v50
    s_mul_i32 s9, s56, 5120
    v_exp_f32 v100, v100
    v_exp_f32 v101, v101
    v_exp_f32 v102, v102
    v_exp_f32 v103, v103
    v_smfmac_f32_32x32x32_bf16 v[156:171], v[220:223], v[92:99], v50
    s_add_u32 s32, s68, s8
    s_addc_u32 s33, s69, 0
    v_exp_f32 v104, v104
    v_exp_f32 v105, v105
    v_exp_f32 v106, v106
    v_exp_f32 v107, v107
    v_mfma_f32_32x32x8_bf16 v[76:91], v[244:245], v[190:191], 0
    v_exp_f32 v60, v60
    v_exp_f32 v61, v61
    v_exp_f32 v62, v62
    v_exp_f32 v63, v63
    v_mfma_f32_32x32x16_bf16 v[76:91], v[204:207], v[176:179], v[76:91]
    ds_read_b64_tr_b16 a[240:241], v24
    ds_read_b64_tr_b16 a[242:243], v24 offset:512
    v_exp_f32 v64, v64
    v_exp_f32 v65, v65
    v_exp_f32 v66, v66
    v_exp_f32 v67, v67
    v_smfmac_f32_32x32x32_bf16 v[156:171], v[224:227], v[100:107], v50
    buffer_load_dwordx4 v[200:203], v1, s[36:39], 0 offen
    buffer_load_dwordx4 v[220:223], v49, s[36:39], 0 offen offset:1024
    v_exp_f32 v68, v68
    v_exp_f32 v69, v69
    v_exp_f32 v70, v70
    v_exp_f32 v71, v71
    v_smfmac_f32_32x32x32_bf16 v[108:123], v[228:231], v[60:67], v50
    s_mov_b32 s34, 8192
    s_mul_i32 s7, s56, 15360
    v_exp_f32 v72, v72
    v_exp_f32 v73, v73
    v_exp_f32 v74, v74
    v_exp_f32 v75, v75
    v_mfma_f32_32x32x8_bf16 v[92:107], v[244:245], v[192:193], 0
    v_exp_f32 v76, v76
    v_exp_f32 v77, v77
    v_exp_f32 v78, v78
    v_exp_f32 v79, v79
    v_mfma_f32_32x32x16_bf16 v[92:107], v[204:207], v[180:183], v[92:107]
    ds_read_b64_tr_b16 a[244:245], v24 offset:32
    ds_read_b64_tr_b16 a[246:247], v24 offset:544
    ds_read_b64_tr_b16 a[248:249], v24 offset:64
    v_exp_f32 v80, v80
    v_exp_f32 v81, v81
    v_exp_f32 v82, v82
    v_exp_f32 v83, v83
    v_smfmac_f32_32x32x32_bf16 v[108:123], v[232:235], v[68:75], v50
    buffer_load_dwordx4 v[224:227], v49, s[36:39], 0 offen offset:2048
    v_exp_f32 v84, v84
    v_exp_f32 v85, v85
    v_exp_f32 v86, v86
    v_exp_f32 v87, v87
    v_smfmac_f32_32x32x32_bf16 v[124:139], v[228:231], v[76:83], v50
    s_xor_b32 s36, s36, 12288
    s_add_u32 s7, s7, 40960
    v_exp_f32 v88, v88
    v_exp_f32 v89, v89
    v_exp_f32 v90, v90
    v_exp_f32 v91, v91
    v_mfma_f32_32x32x8_bf16 v[60:75], v[244:245], v[194:195], 0
    v_exp_f32 v92, v92
    v_exp_f32 v93, v93
    v_exp_f32 v94, v94
    v_exp_f32 v95, v95
    v_mfma_f32_32x32x16_bf16 v[60:75], v[204:207], v[184:187], v[60:75]
    ds_read_b64_tr_b16 a[250:251], v24 offset:576
    ds_read_b64_tr_b16 a[252:253], v24 offset:96
    ds_read_b64_tr_b16 a[254:255], v24 offset:608
    v_exp_f32 v96, v96
    v_exp_f32 v97, v97
    v_exp_f32 v98, v98
    v_exp_f32 v99, v99
    v_smfmac_f32_32x32x32_bf16 v[124:139], v[232:235], v[84:91], v50
    s_xor_b32 s10, s56, 2
    s_mul_i32 s10, s10, 15360
    v_exp_f32 v100, v100
    v_exp_f32 v101, v101
    v_exp_f32 v102, v102
    v_exp_f32 v103, v103
    v_smfmac_f32_32x32x32_bf16 v[140:155], v[228:231], v[92:99], v50
    s_waitcnt vmcnt(12)
    s_add_u32 s10, s10, 40960
    v_exp_f32 v104, v104
    v_exp_f32 v105, v105
    v_exp_f32 v106, v106
    v_exp_f32 v107, v107
    v_mfma_f32_32x32x8_bf16 v[76:91], v[246:247], v[188:189], 0
    v_exp_f32 v60, v60
    v_exp_f32 v61, v61
    v_exp_f32 v62, v62
    v_exp_f32 v63, v63
    v_mfma_f32_32x32x16_bf16 v[76:91], v[208:211], v[172:175], v[76:91]
    s_mul_i32 s77, s61, 6144
    v_exp_f32 v64, v64
    v_exp_f32 v65, v65
    v_exp_f32 v66, v66
    v_exp_f32 v67, v67
    v_smfmac_f32_32x32x32_bf16 v[140:155], v[232:235], v[100:107], v50
    s_add_u32 s77, s77, 22020096
    v_exp_f32 v68, v68
    v_exp_f32 v69, v69
    v_exp_f32 v70, v70
    v_exp_f32 v71, v71
    v_smfmac_f32_32x32x32_bf16 v[156:171], v[228:231], v[60:67], v50
    s_add_u32 s40, s26, s77
    s_addc_u32 s41, s27, 0
    v_exp_f32 v72, v72
    v_exp_f32 v73, v73
    v_exp_f32 v74, v74
    v_exp_f32 v75, v75
    v_mfma_f32_32x32x8_bf16 v[92:107], v[246:247], v[190:191], 0
    v_exp_f32 v76, v76
    v_exp_f32 v77, v77
    v_exp_f32 v78, v78
    v_exp_f32 v79, v79
    v_mfma_f32_32x32x16_bf16 v[92:107], v[208:211], v[176:179], v[92:107]
    buffer_load_dwordx4 v[204:207], v1, s[36:39], 0 offen
    v_exp_f32 v80, v80
    v_exp_f32 v81, v81
    v_exp_f32 v82, v82
    v_exp_f32 v83, v83
    v_smfmac_f32_32x32x32_bf16 v[156:171], v[232:235], v[68:75], v50
    buffer_load_dwordx4 v[252:255], v1, s[36:39], 0 offen offset:3072
    buffer_load_dwordx4 v[228:231], v49, s[36:39], 0 offen offset:1024
    v_exp_f32 v84, v84
    v_exp_f32 v85, v85
    v_exp_f32 v86, v86
    v_exp_f32 v87, v87
    v_smfmac_f32_32x32x32_bf16 v[108:123], v[236:239], v[76:83], v50
    s_mov_b32 s42, 1972224
    v_exp_f32 v88, v88
    v_exp_f32 v89, v89
    v_exp_f32 v90, v90
    v_exp_f32 v91, v91
    v_mfma_f32_32x32x8_bf16 v[60:75], v[246:247], v[192:193], 0
    v_exp_f32 v92, v92
    v_exp_f32 v93, v93
    v_exp_f32 v94, v94
    v_exp_f32 v95, v95
    v_mfma_f32_32x32x16_bf16 v[60:75], v[208:211], v[180:183], v[60:75]
    buffer_load_dwordx4 v[232:235], v49, s[36:39], 0 offen offset:2048
    v_exp_f32 v96, v96
    v_exp_f32 v97, v97
    v_exp_f32 v98, v98
    v_exp_f32 v99, v99
    v_smfmac_f32_32x32x32_bf16 v[108:123], v[240:243], v[84:91], v50
    s_waitcnt lgkmcnt(0)
    v_exp_f32 v100, v100
    v_exp_f32 v101, v101
    v_exp_f32 v102, v102
    v_exp_f32 v103, v103
    v_smfmac_f32_32x32x32_bf16 v[124:139], v[236:239], v[92:99], v50
    buffer_store_dwordx4 a[240:243], v1, s[64:67], 0 offen sc1
    v_exp_f32 v104, v104
    v_exp_f32 v105, v105
    v_exp_f32 v106, v106
    v_exp_f32 v107, v107
    v_mfma_f32_32x32x8_bf16 v[76:91], v[246:247], v[194:195], 0
    v_exp_f32 v60, v60
    v_exp_f32 v61, v61
    v_exp_f32 v62, v62
    v_exp_f32 v63, v63
    v_mfma_f32_32x32x16_bf16 v[76:91], v[208:211], v[184:187], v[76:91]
    buffer_store_dwordx4 a[244:247], v1, s[64:67], 0 offen offset:1024 sc1
    buffer_store_dwordx4 a[248:251], v1, s[64:67], 0 offen offset:2048 sc1
    v_exp_f32 v64, v64
    v_exp_f32 v65, v65
    v_exp_f32 v66, v66
    v_exp_f32 v67, v67
    v_smfmac_f32_32x32x32_bf16 v[124:139], v[240:243], v[100:107], v50
    v_exp_f32 v68, v68
    v_exp_f32 v69, v69
    v_exp_f32 v70, v70
    v_exp_f32 v71, v71
    v_smfmac_f32_32x32x32_bf16 v[140:155], v[236:239], v[60:67], v50
    s_waitcnt vmcnt(11)
    v_exp_f32 v72, v72
    v_exp_f32 v73, v73
    v_exp_f32 v74, v74
    v_exp_f32 v75, v75
    v_mfma_f32_32x32x8_bf16 v[92:107], v[248:249], v[188:189], 0
    v_exp_f32 v76, v76
    v_exp_f32 v77, v77
    v_exp_f32 v78, v78
    v_exp_f32 v79, v79
    v_mfma_f32_32x32x16_bf16 v[92:107], v[196:199], v[172:175], v[92:107]
    buffer_store_dwordx4 a[252:255], v1, s[64:67], 0 offen offset:3072 sc1
    v_exp_f32 v80, v80
    v_exp_f32 v81, v81
    v_exp_f32 v82, v82
    v_exp_f32 v83, v83
    v_smfmac_f32_32x32x32_bf16 v[140:155], v[240:243], v[68:75], v50
    s_add_u32 s19, s19, 106496
    v_exp_f32 v84, v84
    v_exp_f32 v85, v85
    v_exp_f32 v86, v86
    v_exp_f32 v87, v87
    v_smfmac_f32_32x32x32_bf16 v[156:171], v[236:239], v[76:83], v50
    buffer_load_dword v42, v8, s[48:51], s19 offen sc1
    v_exp_f32 v88, v88
    v_exp_f32 v89, v89
    v_exp_f32 v90, v90
    v_exp_f32 v91, v91
    v_mfma_f32_32x32x8_bf16 v[60:75], v[248:249], v[190:191], 0
    v_exp_f32 v92, v92
    v_exp_f32 v93, v93
    v_exp_f32 v94, v94
    v_exp_f32 v95, v95
    v_mfma_f32_32x32x16_bf16 v[60:75], v[196:199], v[176:179], v[60:75]
    s_xor_b32 s36, s36, 4096
    v_exp_f32 v96, v96
    v_exp_f32 v97, v97
    v_exp_f32 v98, v98
    v_exp_f32 v99, v99
    v_smfmac_f32_32x32x32_bf16 v[156:171], v[240:243], v[84:91], v50
    buffer_load_dwordx4 v[208:211], v1, s[36:39], 0 offen
    buffer_load_dwordx4 v[236:239], v49, s[36:39], 0 offen offset:1024
    v_exp_f32 v100, v100
    v_exp_f32 v101, v101
    v_exp_f32 v102, v102
    v_exp_f32 v103, v103
    v_smfmac_f32_32x32x32_bf16 v[108:123], v[212:215], v[92:99], v50
    v_exp_f32 v104, v104
    v_exp_f32 v105, v105
    v_exp_f32 v106, v106
    v_exp_f32 v107, v107
    v_mfma_f32_32x32x8_bf16 v[76:91], v[248:249], v[192:193], 0
    v_exp_f32 v60, v60
    v_exp_f32 v61, v61
    v_exp_f32 v62, v62
    v_exp_f32 v63, v63
    v_mfma_f32_32x32x16_bf16 v[76:91], v[196:199], v[180:183], v[76:91]
    buffer_load_dwordx4 v[240:243], v49, s[36:39], 0 offen offset:2048
    v_exp_f32 v64, v64
    v_exp_f32 v65, v65
    v_exp_f32 v66, v66
    v_exp_f32 v67, v67
    v_smfmac_f32_32x32x32_bf16 v[108:123], v[216:219], v[100:107], v50
    v_exp_f32 v68, v68
    v_exp_f32 v69, v69
    v_exp_f32 v70, v70
    v_exp_f32 v71, v71
    v_smfmac_f32_32x32x32_bf16 v[124:139], v[212:215], v[60:67], v50
    v_exp_f32 v72, v72
    v_exp_f32 v73, v73
    v_exp_f32 v74, v74
    v_exp_f32 v75, v75
    v_mfma_f32_32x32x8_bf16 v[92:107], v[248:249], v[194:195], 0
    v_exp_f32 v76, v76
    v_exp_f32 v77, v77
    v_exp_f32 v78, v78
    v_exp_f32 v79, v79
    v_mfma_f32_32x32x16_bf16 v[92:107], v[196:199], v[184:187], v[92:107]
    v_exp_f32 v80, v80
    v_exp_f32 v81, v81
    v_exp_f32 v82, v82
    v_exp_f32 v83, v83
    v_smfmac_f32_32x32x32_bf16 v[124:139], v[216:219], v[68:75], v50
    v_exp_f32 v84, v84
    v_exp_f32 v85, v85
    v_exp_f32 v86, v86
    v_exp_f32 v87, v87
    v_smfmac_f32_32x32x32_bf16 v[140:155], v[212:215], v[76:83], v50
    s_waitcnt vmcnt(12)
    v_exp_f32 v88, v88
    v_exp_f32 v89, v89
    v_exp_f32 v90, v90
    v_exp_f32 v91, v91
    v_mfma_f32_32x32x8_bf16 v[60:75], v[250:251], v[188:189], 0
    v_exp_f32 v92, v92
    v_exp_f32 v93, v93
    v_exp_f32 v94, v94
    v_exp_f32 v95, v95
    v_mfma_f32_32x32x16_bf16 v[60:75], v[200:203], v[172:175], v[60:75]
    v_exp_f32 v96, v96
    v_exp_f32 v97, v97
    v_exp_f32 v98, v98
    v_exp_f32 v99, v99
    v_smfmac_f32_32x32x32_bf16 v[140:155], v[216:219], v[84:91], v50
    v_exp_f32 v100, v100
    v_exp_f32 v101, v101
    v_exp_f32 v102, v102
    v_exp_f32 v103, v103
    v_smfmac_f32_32x32x32_bf16 v[156:171], v[212:215], v[92:99], v50
    v_exp_f32 v104, v104
    v_exp_f32 v105, v105
    v_exp_f32 v106, v106
    v_exp_f32 v107, v107
    v_mfma_f32_32x32x8_bf16 v[76:91], v[250:251], v[190:191], 0
    v_exp_f32 v60, v60
    v_exp_f32 v61, v61
    v_exp_f32 v62, v62
    v_exp_f32 v63, v63
    v_mfma_f32_32x32x16_bf16 v[76:91], v[200:203], v[176:179], v[76:91]
    v_exp_f32 v64, v64
    v_exp_f32 v65, v65
    v_exp_f32 v66, v66
    v_exp_f32 v67, v67
    v_smfmac_f32_32x32x32_bf16 v[156:171], v[216:219], v[100:107], v50
    buffer_load_dwordx2 v[26:27], v1, s[44:47], s79 offen sc1
    v_exp_f32 v68, v68
    v_exp_f32 v69, v69
    v_exp_f32 v70, v70
    v_exp_f32 v71, v71
    v_smfmac_f32_32x32x32_bf16 v[108:123], v[220:223], v[60:67], v50
    s_xor_b32 s36, s36, 45056
    v_exp_f32 v72, v72
    v_exp_f32 v73, v73
    v_exp_f32 v74, v74
    v_exp_f32 v75, v75
    v_mfma_f32_32x32x8_bf16 v[92:107], v[250:251], v[192:193], 0
    v_exp_f32 v76, v76
    v_exp_f32 v77, v77
    v_exp_f32 v78, v78
    v_exp_f32 v79, v79
    v_mfma_f32_32x32x16_bf16 v[92:107], v[200:203], v[180:183], v[92:107]
    buffer_load_dwordx4 v[196:199], v1, s[36:39], 0 offen
    buffer_load_dwordx4 v[244:247], v1, s[36:39], 0 offen offset:3072
    v_exp_f32 v80, v80
    v_exp_f32 v81, v81
    v_exp_f32 v82, v82
    v_exp_f32 v83, v83
    v_smfmac_f32_32x32x32_bf16 v[108:123], v[224:227], v[68:75], v50
    buffer_load_dwordx4 v[212:215], v49, s[36:39], 0 offen offset:1024
    v_exp_f32 v84, v84
    v_exp_f32 v85, v85
    v_exp_f32 v86, v86
    v_exp_f32 v87, v87
    v_smfmac_f32_32x32x32_bf16 v[124:139], v[220:223], v[76:83], v50
    v_exp_f32 v88, v88
    v_exp_f32 v89, v89
    v_exp_f32 v90, v90
    v_exp_f32 v91, v91
    v_mfma_f32_32x32x8_bf16 v[60:75], v[250:251], v[194:195], 0
    v_exp_f32 v92, v92
    v_exp_f32 v93, v93
    v_exp_f32 v94, v94
    v_exp_f32 v95, v95
    v_mfma_f32_32x32x16_bf16 v[60:75], v[200:203], v[184:187], v[60:75]
    buffer_load_dwordx4 v[216:219], v49, s[36:39], 0 offen offset:2048
    buffer_load_dwordx2 v[34:35], v58, s[28:31], 0 offen offset:96
    v_exp_f32 v96, v96
    v_exp_f32 v97, v97
    v_exp_f32 v98, v98
    v_exp_f32 v99, v99
    v_smfmac_f32_32x32x32_bf16 v[124:139], v[224:227], v[84:91], v50
    v_exp_f32 v100, v100
    v_exp_f32 v101, v101
    v_exp_f32 v102, v102
    v_exp_f32 v103, v103
    v_smfmac_f32_32x32x32_bf16 v[140:155], v[220:223], v[92:99], v50
    s_waitcnt vmcnt(14)
    v_exp_f32 v104, v104
    v_exp_f32 v105, v105
    v_exp_f32 v106, v106
    v_exp_f32 v107, v107
    v_mfma_f32_32x32x8_bf16 v[76:91], v[252:253], v[188:189], 0
    v_exp_f32 v60, v60
    v_exp_f32 v61, v61
    v_exp_f32 v62, v62
    v_exp_f32 v63, v63
    v_mfma_f32_32x32x16_bf16 v[76:91], v[204:207], v[172:175], v[76:91]
    buffer_load_dwordx2 v[36:37], v58, s[28:31], 0 offen offset:128
    v_exp_f32 v64, v64
    v_exp_f32 v65, v65
    v_exp_f32 v66, v66
    v_exp_f32 v67, v67
    v_smfmac_f32_32x32x32_bf16 v[140:155], v[224:227], v[100:107], v50
    s_mul_i32 s19, s16, 1280
    v_exp_f32 v68, v68
    v_exp_f32 v69, v69
    v_exp_f32 v70, v70
    v_exp_f32 v71, v71
    v_smfmac_f32_32x32x32_bf16 v[156:171], v[220:223], v[60:67], v50
    buffer_load_dword v42, v8, s[52:55], s19 offen sc1
    v_exp_f32 v72, v72
    v_exp_f32 v73, v73
    v_exp_f32 v74, v74
    v_exp_f32 v75, v75
    v_mfma_f32_32x32x8_bf16 v[92:107], v[252:253], v[190:191], 0
    v_exp_f32 v76, v76
    v_exp_f32 v77, v77
    v_exp_f32 v78, v78
    v_exp_f32 v79, v79
    v_mfma_f32_32x32x16_bf16 v[92:107], v[204:207], v[176:179], v[92:107]
    s_xor_b32 s36, s36, 4096
    v_exp_f32 v80, v80
    v_exp_f32 v81, v81
    v_exp_f32 v82, v82
    v_exp_f32 v83, v83
    v_smfmac_f32_32x32x32_bf16 v[156:171], v[224:227], v[68:75], v50
    buffer_load_dwordx4 v[200:203], v1, s[36:39], 0 offen
    buffer_load_dwordx4 v[220:223], v49, s[36:39], 0 offen offset:1024
    v_exp_f32 v84, v84
    v_exp_f32 v85, v85
    v_exp_f32 v86, v86
    v_exp_f32 v87, v87
    v_smfmac_f32_32x32x32_bf16 v[108:123], v[228:231], v[76:83], v50
    v_exp_f32 v88, v88
    v_exp_f32 v89, v89
    v_exp_f32 v90, v90
    v_exp_f32 v91, v91
    v_mfma_f32_32x32x8_bf16 v[60:75], v[252:253], v[192:193], 0
    v_exp_f32 v92, v92
    v_exp_f32 v93, v93
    v_exp_f32 v94, v94
    v_exp_f32 v95, v95
    v_mfma_f32_32x32x16_bf16 v[60:75], v[204:207], v[180:183], v[60:75]
    buffer_load_dwordx4 v[224:227], v49, s[36:39], 0 offen offset:2048
    v_exp_f32 v96, v96
    v_exp_f32 v97, v97
    v_exp_f32 v98, v98
    v_exp_f32 v99, v99
    v_smfmac_f32_32x32x32_bf16 v[108:123], v[232:235], v[84:91], v50
    s_add_u32 s19, s19, 81920
    v_exp_f32 v100, v100
    v_exp_f32 v101, v101
    v_exp_f32 v102, v102
    v_exp_f32 v103, v103
    v_smfmac_f32_32x32x32_bf16 v[124:139], v[228:231], v[92:99], v50
    buffer_load_dword v42, v8, s[52:55], s19 offen sc1
    v_exp_f32 v104, v104
    v_exp_f32 v105, v105
    v_exp_f32 v106, v106
    v_exp_f32 v107, v107
    v_mfma_f32_32x32x8_bf16 v[76:91], v[252:253], v[194:195], 0
    v_exp_f32 v60, v60
    v_exp_f32 v61, v61
    v_exp_f32 v62, v62
    v_exp_f32 v63, v63
    v_mfma_f32_32x32x16_bf16 v[76:91], v[204:207], v[184:187], v[76:91]
    s_waitcnt vmcnt(11)
    v_xor_b32 v26, s60, v26
    v_xor_b32 v27, s13, v27
    v_or_b32 v26, v26, v27
    v_cmp_ne_u32 vcc, 0, v26
    v_exp_f32 v64, v64
    v_exp_f32 v65, v65
    v_exp_f32 v66, v66
    v_exp_f32 v67, v67
    v_smfmac_f32_32x32x32_bf16 v[124:139], v[232:235], v[100:107], v50
    s_xor_b32 s36, s36, 12288
    v_exp_f32 v68, v68
    v_exp_f32 v69, v69
    v_exp_f32 v70, v70
    v_exp_f32 v71, v71
    v_smfmac_f32_32x32x32_bf16 v[140:155], v[228:231], v[60:67], v50
    v_exp_f32 v72, v72
    v_exp_f32 v73, v73
    v_exp_f32 v74, v74
    v_exp_f32 v75, v75
    v_mfma_f32_32x32x8_bf16 v[92:107], v[254:255], v[188:189], 0
    v_exp_f32 v76, v76
    v_exp_f32 v77, v77
    v_exp_f32 v78, v78
    v_exp_f32 v79, v79
    v_mfma_f32_32x32x16_bf16 v[92:107], v[208:211], v[172:175], v[92:107]
    s_cbranch_vccnz L_gulate
L_guok:
    ds_add_u32 v25, v19
    v_exp_f32 v80, v80
    v_exp_f32 v81, v81
    v_exp_f32 v82, v82
    v_exp_f32 v83, v83
    v_smfmac_f32_32x32x32_bf16 v[140:155], v[232:235], v[68:75], v50
    v_exp_f32 v84, v84
    v_exp_f32 v85, v85
    v_exp_f32 v86, v86
    v_exp_f32 v87, v87
    v_smfmac_f32_32x32x32_bf16 v[156:171], v[228:231], v[76:83], v50
    v_exp_f32 v88, v88
    v_exp_f32 v89, v89
    v_exp_f32 v90, v90
    v_exp_f32 v91, v91
    v_mfma_f32_32x32x8_bf16 v[60:75], v[254:255], v[190:191], 0
    v_exp_f32 v92, v92
    v_exp_f32 v93, v93
    v_exp_f32 v94, v94
    v_exp_f32 v95, v95
    v_mfma_f32_32x32x16_bf16 v[60:75], v[208:211], v[176:179], v[60:75]
    ds_read_b32 v5, v25
    v_exp_f32 v96, v96
    v_exp_f32 v97, v97
    v_exp_f32 v98, v98
    v_exp_f32 v99, v99
    v_smfmac_f32_32x32x32_bf16 v[156:171], v[232:235], v[84:91], v50
    buffer_load_dwordx4 v[204:207], v1, s[36:39], 0 offen
    buffer_load_dwordx4 v[248:251], v1, s[36:39], 0 offen offset:3072
    v_exp_f32 v100, v100
    v_exp_f32 v101, v101
    v_exp_f32 v102, v102
    v_exp_f32 v103, v103
    v_smfmac_f32_32x32x32_bf16 v[108:123], v[236:239], v[92:99], v50
    s_waitcnt lgkmcnt(0)
    v_cmp_gt_u32 vcc, 8, v5
    v_exp_f32 v104, v104
    v_exp_f32 v105, v105
    v_exp_f32 v106, v106
    v_exp_f32 v107, v107
    v_mfma_f32_32x32x8_bf16 v[76:91], v[254:255], v[192:193], 0
    v_exp_f32 v60, v60
    v_exp_f32 v61, v61
    v_exp_f32 v62, v62
    v_exp_f32 v63, v63
    v_mfma_f32_32x32x16_bf16 v[76:91], v[208:211], v[180:183], v[76:91]
    s_cbranch_vccnz L_bl2
L_bk2:
    v_exp_f32 v64, v64
    v_exp_f32 v65, v65
    v_exp_f32 v66, v66
    v_exp_f32 v67, v67
    v_smfmac_f32_32x32x32_bf16 v[108:123], v[240:243], v[100:107], v50
    buffer_load_dwordx4 v[228:231], v49, s[36:39], 0 offen offset:1024
    buffer_load_dwordx4 v[232:235], v49, s[36:39], 0 offen offset:2048
    v_exp_f32 v68, v68
    v_exp_f32 v69, v69
    v_exp_f32 v70, v70
    v_exp_f32 v71, v71
    v_smfmac_f32_32x32x32_bf16 v[124:139], v[236:239], v[60:67], v50
    s_addk_i32 s78, 4096
    v_exp_f32 v72, v72
    v_exp_f32 v73, v73
    v_exp_f32 v74, v74
    v_exp_f32 v75, v75
    v_mfma_f32_32x32x8_bf16 v[92:107], v[254:255], v[194:195], 0
    v_exp_f32 v76, v76
    v_exp_f32 v77, v77
    v_exp_f32 v78, v78
    v_exp_f32 v79, v79
    v_mfma_f32_32x32x16_bf16 v[92:107], v[208:211], v[184:187], v[92:107]
    buffer_store_dwordx2 v[46:47], v9, s[44:47], s78 offen sc1
    buffer_load_dwordx4 a[0:3], v51, s[40:43], 0 offen sc1
    v_exp_f32 v80, v80
    v_exp_f32 v81, v81
    v_exp_f32 v82, v82
    v_exp_f32 v83, v83
    v_smfmac_f32_32x32x32_bf16 v[124:139], v[240:243], v[68:75], v50
    s_add_u32 s64, s68, s22
    s_addc_u32 s65, s69, 0
    v_exp_f32 v84, v84
    v_exp_f32 v85, v85
    v_exp_f32 v86, v86
    v_exp_f32 v87, v87
    v_smfmac_f32_32x32x32_bf16 v[140:155], v[236:239], v[76:83], v50
    s_waitcnt vmcnt(13)
    s_mov_b32 s66, 8192
    v_exp_f32 v88, v88
    v_exp_f32 v89, v89
    v_exp_f32 v90, v90
    v_exp_f32 v91, v91
    v_mfma_f32_32x32x8_bf16 v[60:75], v[244:245], v[188:189], 0
    v_exp_f32 v92, v92
    v_exp_f32 v93, v93
    v_exp_f32 v94, v94
    v_exp_f32 v95, v95
    v_mfma_f32_32x32x16_bf16 v[60:75], v[196:199], v[172:175], v[60:75]
    buffer_load_dwordx4 a[4:7], v52, s[40:43], 0 offen sc1
    buffer_load_dwordx4 a[8:11], v53, s[40:43], 0 offen sc1
    v_exp_f32 v96, v96
    v_exp_f32 v97, v97
    v_exp_f32 v98, v98
    v_exp_f32 v99, v99
    v_smfmac_f32_32x32x32_bf16 v[140:155], v[240:243], v[84:91], v50
    s_xor_b32 s36, s36, 4096
    v_exp_f32 v100, v100
    v_exp_f32 v101, v101
    v_exp_f32 v102, v102
    v_exp_f32 v103, v103
    v_smfmac_f32_32x32x32_bf16 v[156:171], v[236:239], v[92:99], v50
    s_add_u32 s28, s68, s22
    s_addc_u32 s29, s69, 0
    v_exp_f32 v104, v104
    v_exp_f32 v105, v105
    v_exp_f32 v106, v106
    v_exp_f32 v107, v107
    v_mfma_f32_32x32x8_bf16 v[76:91], v[244:245], v[190:191], 0
    v_exp_f32 v60, v60
    v_exp_f32 v61, v61
    v_exp_f32 v62, v62
    v_exp_f32 v63, v63
    v_mfma_f32_32x32x16_bf16 v[76:91], v[196:199], v[176:179], v[76:91]
    buffer_load_dwordx4 v[208:211], v1, s[36:39], 0 offen
    v_exp_f32 v64, v64
    v_exp_f32 v65, v65
    v_exp_f32 v66, v66
    v_exp_f32 v67, v67
    v_smfmac_f32_32x32x32_bf16 v[156:171], v[240:243], v[100:107], v50
    buffer_load_dwordx4 v[236:239], v49, s[36:39], 0 offen offset:1024
    buffer_load_dwordx4 v[240:243], v49, s[36:39], 0 offen offset:2048
    v_exp_f32 v68, v68
    v_exp_f32 v69, v69
    v_exp_f32 v70, v70
    v_exp_f32 v71, v71
    v_smfmac_f32_32x32x32_bf16 v[108:123], v[212:215], v[60:67], v50
    s_add_u32 s40, s40, 98304
    s_mov_b32 s30, 8192
    v_exp_f32 v72, v72
    v_exp_f32 v73, v73
    v_exp_f32 v74, v74
    v_exp_f32 v75, v75
    v_mfma_f32_32x32x8_bf16 v[92:107], v[244:245], v[192:193], 0
    v_exp_f32 v76, v76
    v_exp_f32 v77, v77
    v_exp_f32 v78, v78
    v_exp_f32 v79, v79
    v_mfma_f32_32x32x16_bf16 v[92:107], v[196:199], v[180:183], v[92:107]
    buffer_load_dwordx4 a[12:15], v51, s[40:43], 0 offen sc1
    buffer_load_dwordx4 a[16:19], v52, s[40:43], 0 offen sc1
    v_exp_f32 v80, v80
    v_exp_f32 v81, v81
    v_exp_f32 v82, v82
    v_exp_f32 v83, v83
    v_smfmac_f32_32x32x32_bf16 v[108:123], v[216:219], v[68:75], v50
    s_add_u32 s28, s28, 204800
    v_exp_f32 v84, v84
    v_exp_f32 v85, v85
    v_exp_f32 v86, v86
    v_exp_f32 v87, v87
    v_smfmac_f32_32x32x32_bf16 v[124:139], v[212:215], v[76:83], v50
    v_exp_f32 v88, v88
    v_exp_f32 v89, v89
    v_exp_f32 v90, v90
    v_exp_f32 v91, v91
    v_mfma_f32_32x32x8_bf16 v[60:75], v[244:245], v[194:195], 0
    v_exp_f32 v92, v92
    v_exp_f32 v93, v93
    v_exp_f32 v94, v94
    v_exp_f32 v95, v95
    v_mfma_f32_32x32x16_bf16 v[60:75], v[196:199], v[184:187], v[60:75]
    buffer_load_dwordx4 a[20:23], v53, s[40:43], 0 offen sc1
    v_exp_f32 v96, v96
    v_exp_f32 v97, v97
    v_exp_f32 v98, v98
    v_exp_f32 v99, v99
    v_smfmac_f32_32x32x32_bf16 v[124:139], v[216:219], v[84:91], v50
    s_add_u32 s40, s40, 98304
    v_exp_f32 v100, v100
    v_exp_f32 v101, v101
    v_exp_f32 v102, v102
    v_exp_f32 v103, v103
    v_smfmac_f32_32x32x32_bf16 v[140:155], v[212:215], v[92:99], v50
    s_waitcnt vmcnt(15)
    v_exp_f32 v104, v104
    v_exp_f32 v105, v105
    v_exp_f32 v106, v106
    v_exp_f32 v107, v107
    v_mfma_f32_32x32x8_bf16 v[76:91], v[246:247], v[188:189], 0
    v_exp_f32 v60, v60
    v_exp_f32 v61, v61
    v_exp_f32 v62, v62
    v_exp_f32 v63, v63
    v_mfma_f32_32x32x16_bf16 v[76:91], v[200:203], v[172:175], v[76:91]
    buffer_load_dwordx4 a[24:27], v51, s[40:43], 0 offen sc1
    buffer_load_dwordx4 a[28:31], v52, s[40:43], 0 offen sc1
    v_exp_f32 v64, v64
    v_exp_f32 v65, v65
    v_exp_f32 v66, v66
    v_exp_f32 v67, v67
    v_smfmac_f32_32x32x32_bf16 v[140:155], v[216:219], v[100:107], v50
    buffer_load_dwordx4 a[32:35], v53, s[40:43], 0 offen sc1
    v_exp_f32 v68, v68
    v_exp_f32 v69, v69
    v_exp_f32 v70, v70
    v_exp_f32 v71, v71
    v_smfmac_f32_32x32x32_bf16 v[156:171], v[212:215], v[60:67], v50
    s_xor_b32 s36, s36, 241664
    v_exp_f32 v72, v72
    v_exp_f32 v73, v73
    v_exp_f32 v74, v74
    v_exp_f32 v75, v75
    v_mfma_f32_32x32x8_bf16 v[92:107], v[246:247], v[190:191], 0
    v_exp_f32 v76, v76
    v_exp_f32 v77, v77
    v_exp_f32 v78, v78
    v_exp_f32 v79, v79
    v_mfma_f32_32x32x16_bf16 v[92:107], v[200:203], v[176:179], v[92:107]
    buffer_load_dwordx4 v[196:199], v1, s[36:39], 0 offen
    v_exp_f32 v80, v80
    v_exp_f32 v81, v81
    v_exp_f32 v82, v82
    v_exp_f32 v83, v83
    v_smfmac_f32_32x32x32_bf16 v[156:171], v[216:219], v[68:75], v50
    buffer_load_dwordx4 v[252:255], v1, s[36:39], 0 offen offset:3072
    buffer_load_dwordx4 v[212:215], v49, s[36:39], 0 offen offset:1024
    v_exp_f32 v84, v84
    v_exp_f32 v85, v85
    v_exp_f32 v86, v86
    v_exp_f32 v87, v87
    v_smfmac_f32_32x32x32_bf16 v[108:123], v[220:223], v[76:83], v50
    v_exp_f32 v88, v88
    v_exp_f32 v89, v89
    v_exp_f32 v90, v90
    v_exp_f32 v91, v91
    v_mfma_f32_32x32x8_bf16 v[60:75], v[246:247], v[192:193], 0
    v_exp_f32 v92, v92
    v_exp_f32 v93, v93
    v_exp_f32 v94, v94
    v_exp_f32 v95, v95
    v_mfma_f32_32x32x16_bf16 v[60:75], v[200:203], v[180:183], v[60:75]
    buffer_load_dwordx4 v[216:219], v49, s[36:39], 0 offen offset:2048
    v_exp_f32 v96, v96
    v_exp_f32 v97, v97
    v_exp_f32 v98, v98
    v_exp_f32 v99, v99
    v_smfmac_f32_32x32x32_bf16 v[108:123], v[224:227], v[84:91], v50
    s_add_u32 s40, s40, 98304
    v_exp_f32 v100, v100
    v_exp_f32 v101, v101
    v_exp_f32 v102, v102
    v_exp_f32 v103, v103
    v_smfmac_f32_32x32x32_bf16 v[124:139], v[220:223], v[92:99], v50
    buffer_load_dwordx4 a[36:39], v51, s[40:43], 0 offen sc1
    v_exp_f32 v104, v104
    v_exp_f32 v105, v105
    v_exp_f32 v106, v106
    v_exp_f32 v107, v107
    v_mfma_f32_32x32x8_bf16 v[76:91], v[246:247], v[194:195], 0
    v_exp_f32 v60, v60
    v_exp_f32 v61, v61
    v_exp_f32 v62, v62
    v_exp_f32 v63, v63
    v_mfma_f32_32x32x16_bf16 v[76:91], v[200:203], v[184:187], v[76:91]
    buffer_load_dwordx4 a[40:43], v52, s[40:43], 0 offen sc1
    buffer_load_dwordx4 a[44:47], v53, s[40:43], 0 offen sc1
    v_exp_f32 v64, v64
    v_exp_f32 v65, v65
    v_exp_f32 v66, v66
    v_exp_f32 v67, v67
    v_smfmac_f32_32x32x32_bf16 v[124:139], v[224:227], v[100:107], v50
    s_add_u32 s40, s40, 98304
    v_exp_f32 v68, v68
    v_exp_f32 v69, v69
    v_exp_f32 v70, v70
    v_exp_f32 v71, v71
    v_smfmac_f32_32x32x32_bf16 v[140:155], v[220:223], v[60:67], v50
    s_waitcnt vmcnt(20)
    v_exp_f32 v72, v72
    v_exp_f32 v73, v73
    v_exp_f32 v74, v74
    v_exp_f32 v75, v75
    v_mfma_f32_32x32x8_bf16 v[92:107], v[248:249], v[188:189], 0
    v_exp_f32 v76, v76
    v_exp_f32 v77, v77
    v_exp_f32 v78, v78
    v_exp_f32 v79, v79
    v_mfma_f32_32x32x16_bf16 v[92:107], v[204:207], v[172:175], v[92:107]
L_wp3:
    s_cbranch_execz L_wret0
    buffer_load_dwordx4 a[48:51], v51, s[40:43], 0 offen sc1
    buffer_load_dwordx4 a[52:55], v52, s[40:43], 0 offen sc1
    v_exp_f32 v80, v80
    v_exp_f32 v81, v81
    v_exp_f32 v82, v82
    v_exp_f32 v83, v83
    v_smfmac_f32_32x32x32_bf16 v[140:155], v[224:227], v[68:75], v50
    s_xor_b32 s36, s36, 4096
    v_exp_f32 v84, v84
    v_exp_f32 v85, v85
    v_exp_f32 v86, v86
    v_exp_f32 v87, v87
    v_smfmac_f32_32x32x32_bf16 v[156:171], v[220:223], v[76:83], v50
    v_exp_f32 v88, v88
    v_exp_f32 v89, v89
    v_exp_f32 v90, v90
    v_exp_f32 v91, v91
    v_mfma_f32_32x32x8_bf16 v[60:75], v[248:249], v[190:191], 0
    v_exp_f32 v92, v92
    v_exp_f32 v93, v93
    v_exp_f32 v94, v94
    v_exp_f32 v95, v95
    v_mfma_f32_32x32x16_bf16 v[60:75], v[204:207], v[176:179], v[60:75]
    buffer_load_dwordx4 v[200:203], v1, s[36:39], 0 offen
    v_exp_f32 v96, v96
    v_exp_f32 v97, v97
    v_exp_f32 v98, v98
    v_exp_f32 v99, v99
    v_smfmac_f32_32x32x32_bf16 v[156:171], v[224:227], v[84:91], v50
    buffer_load_dwordx4 v[220:223], v49, s[36:39], 0 offen offset:1024
    buffer_load_dwordx4 v[224:227], v49, s[36:39], 0 offen offset:2048
    v_exp_f32 v100, v100
    v_exp_f32 v101, v101
    v_exp_f32 v102, v102
    v_exp_f32 v103, v103
    v_smfmac_f32_32x32x32_bf16 v[108:123], v[228:231], v[92:99], v50
    v_exp_f32 v104, v104
    v_exp_f32 v105, v105
    v_exp_f32 v106, v106
    v_exp_f32 v107, v107
    v_mfma_f32_32x32x8_bf16 v[76:91], v[248:249], v[192:193], 0
    v_exp_f32 v60, v60
    v_exp_f32 v61, v61
    v_exp_f32 v62, v62
    v_exp_f32 v63, v63
    v_mfma_f32_32x32x16_bf16 v[76:91], v[204:207], v[180:183], v[76:91]
    buffer_load_dwordx4 a[56:59], v53, s[40:43], 0 offen sc1
    v_exp_f32 v64, v64
    v_exp_f32 v65, v65
    v_exp_f32 v66, v66
    v_exp_f32 v67, v67
    v_smfmac_f32_32x32x32_bf16 v[108:123], v[232:235], v[100:107], v50
    s_add_u32 s40, s40, 98304
    v_exp_f32 v68, v68
    v_exp_f32 v69, v69
    v_exp_f32 v70, v70
    v_exp_f32 v71, v71
    v_smfmac_f32_32x32x32_bf16 v[124:139], v[228:231], v[60:67], v50
    buffer_load_dwordx4 a[60:63], v51, s[40:43], 0 offen sc1
    v_exp_f32 v72, v72
    v_exp_f32 v73, v73
    v_exp_f32 v74, v74
    v_exp_f32 v75, v75
    v_mfma_f32_32x32x8_bf16 v[92:107], v[248:249], v[194:195], 0
    v_exp_f32 v76, v76
    v_exp_f32 v77, v77
    v_exp_f32 v78, v78
    v_exp_f32 v79, v79
    v_mfma_f32_32x32x16_bf16 v[92:107], v[204:207], v[184:187], v[92:107]
    buffer_load_dwordx4 a[64:67], v52, s[40:43], 0 offen sc1
    buffer_load_dwordx4 a[68:71], v53, s[40:43], 0 offen sc1
    v_exp_f32 v80, v80
    v_exp_f32 v81, v81
    v_exp_f32 v82, v82
    v_exp_f32 v83, v83
    v_smfmac_f32_32x32x32_bf16 v[124:139], v[232:235], v[68:75], v50
    s_add_u32 s40, s40, 98304
    v_exp_f32 v84, v84
    v_exp_f32 v85, v85
    v_exp_f32 v86, v86
    v_exp_f32 v87, v87
    v_smfmac_f32_32x32x32_bf16 v[140:155], v[228:231], v[76:83], v50
    s_waitcnt vmcnt(22)
    v_exp_f32 v88, v88
    v_exp_f32 v89, v89
    v_exp_f32 v90, v90
    v_exp_f32 v91, v91
    v_mfma_f32_32x32x8_bf16 v[60:75], v[250:251], v[188:189], 0
    v_exp_f32 v92, v92
    v_exp_f32 v93, v93
    v_exp_f32 v94, v94
    v_exp_f32 v95, v95
    v_mfma_f32_32x32x16_bf16 v[60:75], v[208:211], v[172:175], v[60:75]
    buffer_load_dwordx4 a[72:75], v51, s[40:43], 0 offen sc1
    buffer_load_dwordx4 a[76:79], v52, s[40:43], 0 offen sc1
    v_exp_f32 v96, v96
    v_exp_f32 v97, v97
    v_exp_f32 v98, v98
    v_exp_f32 v99, v99
    v_smfmac_f32_32x32x32_bf16 v[140:155], v[232:235], v[84:91], v50
    s_xor_b32 s36, s36, 12288
    v_exp_f32 v100, v100
    v_exp_f32 v101, v101
    v_exp_f32 v102, v102
    v_exp_f32 v103, v103
    v_smfmac_f32_32x32x32_bf16 v[156:171], v[228:231], v[92:99], v50
    v_exp_f32 v104, v104
    v_exp_f32 v105, v105
    v_exp_f32 v106, v106
    v_exp_f32 v107, v107
    v_mfma_f32_32x32x8_bf16 v[76:91], v[250:251], v[190:191], 0
    v_exp_f32 v60, v60
    v_exp_f32 v61, v61
    v_exp_f32 v62, v62
    v_exp_f32 v63, v63
    v_mfma_f32_32x32x16_bf16 v[76:91], v[208:211], v[176:179], v[76:91]
    buffer_load_dwordx4 v[204:207], v1, s[36:39], 0 offen
    v_exp_f32 v64, v64
    v_exp_f32 v65, v65
    v_exp_f32 v66, v66
    v_exp_f32 v67, v67
    v_smfmac_f32_32x32x32_bf16 v[156:171], v[232:235], v[100:107], v50
    buffer_load_dwordx4 v[244:247], v1, s[36:39], 0 offen offset:3072
    buffer_load_dwordx4 v[228:231], v49, s[36:39], 0 offen offset:1024
    v_exp_f32 v68, v68
    v_exp_f32 v69, v69
    v_exp_f32 v70, v70
    v_exp_f32 v71, v71
    v_smfmac_f32_32x32x32_bf16 v[108:123], v[236:239], v[60:67], v50
    v_exp_f32 v72, v72
    v_exp_f32 v73, v73
    v_exp_f32 v74, v74
    v_exp_f32 v75, v75
    v_mfma_f32_32x32x8_bf16 v[92:107], v[250:251], v[192:193], 0
    v_exp_f32 v76, v76
    v_exp_f32 v77, v77
    v_exp_f32 v78, v78
    v_exp_f32 v79, v79
    v_mfma_f32_32x32x16_bf16 v[92:107], v[208:211], v[180:183], v[92:107]
    buffer_load_dwordx4 v[232:235], v49, s[36:39], 0 offen offset:2048
    buffer_load_dwordx4 a[80:83], v53, s[40:43], 0 offen sc1
    v_exp_f32 v80, v80
    v_exp_f32 v81, v81
    v_exp_f32 v82, v82
    v_exp_f32 v83, v83
    v_smfmac_f32_32x32x32_bf16 v[108:123], v[240:243], v[68:75], v50
    s_add_u32 s40, s40, 98304
    v_exp_f32 v84, v84
    v_exp_f32 v85, v85
    v_exp_f32 v86, v86
    v_exp_f32 v87, v87
    v_smfmac_f32_32x32x32_bf16 v[124:139], v[236:239], v[76:83], v50
    v_exp_f32 v88, v88
    v_exp_f32 v89, v89
    v_exp_f32 v90, v90
    v_exp_f32 v91, v91
    v_mfma_f32_32x32x8_bf16 v[60:75], v[250:251], v[194:195], 0
    v_exp_f32 v92, v92
    v_exp_f32 v93, v93
    v_exp_f32 v94, v94
    v_exp_f32 v95, v95
    v_mfma_f32_32x32x16_bf16 v[60:75], v[208:211], v[184:187], v[60:75]
    buffer_load_dwordx4 a[84:87], v51, s[40:43], 0 offen sc1
    buffer_load_dwordx4 a[88:91], v52, s[40:43], 0 offen sc1
    v_exp_f32 v96, v96
    v_exp_f32 v97, v97
    v_exp_f32 v98, v98
    v_exp_f32 v99, v99
    v_smfmac_f32_32x32x32_bf16 v[124:139], v[240:243], v[84:91], v50
    v_exp_f32 v100, v100
    v_exp_f32 v101, v101
    v_exp_f32 v102, v102
    v_exp_f32 v103, v103
    v_smfmac_f32_32x32x32_bf16 v[140:155], v[236:239], v[92:99], v50
    s_waitcnt vmcnt(21)
    v_exp_f32 v104, v104
    v_exp_f32 v105, v105
    v_exp_f32 v106, v106
    v_exp_f32 v107, v107
    v_mfma_f32_32x32x8_bf16 v[76:91], v[252:253], v[188:189], 0
    v_exp_f32 v60, v60
    v_exp_f32 v61, v61
    v_exp_f32 v62, v62
    v_exp_f32 v63, v63
    v_mfma_f32_32x32x16_bf16 v[76:91], v[196:199], v[172:175], v[76:91]
    buffer_load_dwordx4 a[92:95], v53, s[40:43], 0 offen sc1
    v_exp_f32 v64, v64
    v_exp_f32 v65, v65
    v_exp_f32 v66, v66
    v_exp_f32 v67, v67
    v_smfmac_f32_32x32x32_bf16 v[140:155], v[240:243], v[100:107], v50
    s_add_u32 s40, s40, 98304
    v_exp_f32 v68, v68
    v_exp_f32 v69, v69
    v_exp_f32 v70, v70
    v_exp_f32 v71, v71
    v_smfmac_f32_32x32x32_bf16 v[156:171], v[236:239], v[60:67], v50
    buffer_load_dwordx4 a[96:99], v51, s[40:43], 0 offen sc1
    v_exp_f32 v72, v72
    v_exp_f32 v73, v73
    v_exp_f32 v74, v74
    v_exp_f32 v75, v75
    v_mfma_f32_32x32x8_bf16 v[92:107], v[252:253], v[190:191], 0
    v_exp_f32 v76, v76
    v_exp_f32 v77, v77
    v_exp_f32 v78, v78
    v_exp_f32 v79, v79
    v_mfma_f32_32x32x16_bf16 v[92:107], v[196:199], v[176:179], v[92:107]
    s_xor_b32 s36, s36, 4096
    v_exp_f32 v80, v80
    v_exp_f32 v81, v81
    v_exp_f32 v82, v82
    v_exp_f32 v83, v83
    v_smfmac_f32_32x32x32_bf16 v[156:171], v[240:243], v[68:75], v50
    buffer_load_dwordx4 v[208:211], v1, s[36:39], 0 offen
    buffer_load_dwordx4 v[236:239], v49, s[36:39], 0 offen offset:1024
    v_exp_f32 v84, v84
    v_exp_f32 v85, v85
    v_exp_f32 v86, v86
    v_exp_f32 v87, v87
    v_smfmac_f32_32x32x32_bf16 v[108:123], v[212:215], v[76:83], v50
    buffer_load_dwordx4 v[240:243], v49, s[36:39], 0 offen offset:2048
    v_exp_f32 v88, v88
    v_exp_f32 v89, v89
    v_exp_f32 v90, v90
    v_exp_f32 v91, v91
    v_mfma_f32_32x32x8_bf16 v[60:75], v[252:253], v[192:193], 0
    v_exp_f32 v92, v92
    v_exp_f32 v93, v93
    v_exp_f32 v94, v94
    v_exp_f32 v95, v95
    v_mfma_f32_32x32x16_bf16 v[60:75], v[196:199], v[180:183], v[60:75]
    buffer_load_dwordx4 a[100:103], v52, s[40:43], 0 offen sc1
    buffer_load_dwordx4 a[104:107], v53, s[40:43], 0 offen sc1
    v_exp_f32 v96, v96
    v_exp_f32 v97, v97
    v_exp_f32 v98, v98
    v_exp_f32 v99, v99
    v_smfmac_f32_32x32x32_bf16 v[108:123], v[216:219], v[84:91], v50
    s_add_u32 s40, s40, 98304
    v_exp_f32 v100, v100
    v_exp_f32 v101, v101
    v_exp_f32 v102, v102
    v_exp_f32 v103, v103
    v_smfmac_f32_32x32x32_bf16 v[124:139], v[212:215], v[92:99], v50
    v_exp_f32 v104, v104
    v_exp_f32 v105, v105
    v_exp_f32 v106, v106
    v_exp_f32 v107, v107
    v_mfma_f32_32x32x8_bf16 v[76:91], v[252:253], v[194:195], 0
    v_exp_f32 v60, v60
    v_exp_f32 v61, v61
    v_exp_f32 v62, v62
    v_exp_f32 v63, v63
    v_mfma_f32_32x32x16_bf16 v[76:91], v[196:199], v[184:187], v[76:91]
    buffer_load_dwordx4 a[108:111], v51, s[40:43], 0 offen sc1
    buffer_load_dwordx4 a[112:115], v52, s[40:43], 0 offen sc1
    v_exp_f32 v64, v64
    v_exp_f32 v65, v65
    v_exp_f32 v66, v66
    v_exp_f32 v67, v67
    v_smfmac_f32_32x32x32_bf16 v[124:139], v[216:219], v[100:107], v50
    v_exp_f32 v68, v68
    v_exp_f32 v69, v69
    v_exp_f32 v70, v70
    v_exp_f32 v71, v71
    v_smfmac_f32_32x32x32_bf16 v[140:155], v[212:215], v[60:67], v50
    s_waitcnt vmcnt(22)
    v_exp_f32 v72, v72
    v_exp_f32 v73, v73
    v_exp_f32 v74, v74
    v_exp_f32 v75, v75
    v_mfma_f32_32x32x8_bf16 v[92:107], v[254:255], v[188:189], 0
    v_exp_f32 v76, v76
    v_exp_f32 v77, v77
    v_exp_f32 v78, v78
    v_exp_f32 v79, v79
    v_mfma_f32_32x32x16_bf16 v[92:107], v[200:203], v[172:175], v[92:107]
    buffer_load_dwordx4 a[116:119], v53, s[40:43], 0 offen sc1
    v_exp_f32 v80, v80
    v_exp_f32 v81, v81
    v_exp_f32 v82, v82
    v_exp_f32 v83, v83
    v_smfmac_f32_32x32x32_bf16 v[140:155], v[216:219], v[68:75], v50
    s_add_u32 s40, s40, 98304
    v_exp_f32 v84, v84
    v_exp_f32 v85, v85
    v_exp_f32 v86, v86
    v_exp_f32 v87, v87
    v_smfmac_f32_32x32x32_bf16 v[156:171], v[212:215], v[76:83], v50
    buffer_load_dwordx4 a[120:123], v51, s[40:43], 0 offen sc1
    v_exp_f32 v88, v88
    v_exp_f32 v89, v89
    v_exp_f32 v90, v90
    v_exp_f32 v91, v91
    v_mfma_f32_32x32x8_bf16 v[60:75], v[254:255], v[190:191], 0
    v_exp_f32 v92, v92
    v_exp_f32 v93, v93
    v_exp_f32 v94, v94
    v_exp_f32 v95, v95
    v_mfma_f32_32x32x16_bf16 v[60:75], v[200:203], v[176:179], v[60:75]
    s_xor_b32 s36, s36, 45056
    v_exp_f32 v96, v96
    v_exp_f32 v97, v97
    v_exp_f32 v98, v98
    v_exp_f32 v99, v99
    v_smfmac_f32_32x32x32_bf16 v[156:171], v[216:219], v[84:91], v50
    buffer_load_dwordx4 v[196:199], v1, s[36:39], 0 offen
    buffer_load_dwordx4 v[248:251], v1, s[36:39], 0 offen offset:3072
    v_exp_f32 v100, v100
    v_exp_f32 v101, v101
    v_exp_f32 v102, v102
    v_exp_f32 v103, v103
    v_smfmac_f32_32x32x32_bf16 v[108:123], v[220:223], v[92:99], v50
    buffer_load_dwordx4 v[212:215], v49, s[36:39], 0 offen offset:1024
    v_exp_f32 v104, v104
    v_exp_f32 v105, v105
    v_exp_f32 v106, v106
    v_exp_f32 v107, v107
    v_mfma_f32_32x32x8_bf16 v[76:91], v[254:255], v[192:193], 0
    v_exp_f32 v60, v60
    v_exp_f32 v61, v61
    v_exp_f32 v62, v62
    v_exp_f32 v63, v63
    v_mfma_f32_32x32x16_bf16 v[76:91], v[200:203], v[180:183], v[76:91]
    buffer_load_dwordx4 v[216:219], v49, s[36:39], 0 offen offset:2048
    buffer_load_dwordx4 a[124:127], v52, s[40:43], 0 offen sc1
    v_exp_f32 v64, v64
    v_exp_f32 v65, v65
    v_exp_f32 v66, v66
    v_exp_f32 v67, v67
    v_smfmac_f32_32x32x32_bf16 v[108:123], v[224:227], v[100:107], v50
    v_exp_f32 v68, v68
    v_exp_f32 v69, v69
    v_exp_f32 v70, v70
    v_exp_f32 v71, v71
    v_smfmac_f32_32x32x32_bf16 v[124:139], v[220:223], v[60:67], v50
    v_exp_f32 v72, v72
    v_exp_f32 v73, v73
    v_exp_f32 v74, v74
    v_exp_f32 v75, v75
    v_mfma_f32_32x32x8_bf16 v[92:107], v[254:255], v[194:195], 0
    v_exp_f32 v76, v76
    v_exp_f32 v77, v77
    v_exp_f32 v78, v78
    v_exp_f32 v79, v79
    v_mfma_f32_32x32x16_bf16 v[92:107], v[200:203], v[184:187], v[92:107]
    buffer_load_dwordx4 a[128:131], v53, s[40:43], 0 offen sc1
    v_exp_f32 v80, v80
    v_exp_f32 v81, v81
    v_exp_f32 v82, v82
    v_exp_f32 v83, v83
    v_smfmac_f32_32x32x32_bf16 v[124:139], v[224:227], v[68:75], v50
    s_add_u32 s40, s40, 98304
    v_exp_f32 v84, v84
    v_exp_f32 v85, v85
    v_exp_f32 v86, v86
    v_exp_f32 v87, v87
    v_smfmac_f32_32x32x32_bf16 v[140:155], v[220:223], v[76:83], v50
    s_waitcnt vmcnt(20)
    v_exp_f32 v88, v88
    v_exp_f32 v89, v89
    v_exp_f32 v90, v90
    v_exp_f32 v91, v91
    v_mfma_f32_32x32x8_bf16 v[60:75], v[244:245], v[188:189], 0
    v_exp_f32 v92, v92
    v_exp_f32 v93, v93
    v_exp_f32 v94, v94
    v_exp_f32 v95, v95
    v_mfma_f32_32x32x16_bf16 v[60:75], v[204:207], v[172:175], v[60:75]
    buffer_load_dwordx4 a[132:135], v51, s[40:43], 0 offen sc1
    buffer_load_dwordx4 a[136:139], v52, s[40:43], 0 offen sc1
    v_exp_f32 v96, v96
    v_exp_f32 v97, v97
    v_exp_f32 v98, v98
    v_exp_f32 v99, v99
    v_smfmac_f32_32x32x32_bf16 v[140:155], v[224:227], v[84:91], v50
    buffer_load_dwordx4 a[140:143], v53, s[40:43], 0 offen sc1
    v_exp_f32 v100, v100
    v_exp_f32 v101, v101
    v_exp_f32 v102, v102
    v_exp_f32 v103, v103
    v_smfmac_f32_32x32x32_bf16 v[156:171], v[220:223], v[92:99], v50
    s_addk_i32 s79, 4096
    v_exp_f32 v104, v104
    v_exp_f32 v105, v105
    v_exp_f32 v106, v106
    v_exp_f32 v107, v107
    v_mfma_f32_32x32x8_bf16 v[76:91], v[244:245], v[190:191], 0
    v_exp_f32 v60, v60
    v_exp_f32 v61, v61
    v_exp_f32 v62, v62
    v_exp_f32 v63, v63
    v_mfma_f32_32x32x16_bf16 v[76:91], v[204:207], v[176:179], v[76:91]
    v_exp_f32 v64, v64
    v_exp_f32 v65, v65
    v_exp_f32 v66, v66
    v_exp_f32 v67, v67
    v_smfmac_f32_32x32x32_bf16 v[156:171], v[224:227], v[100:107], v50
    buffer_load_dwordx2 v[26:27], v1, s[44:47], s79 offen sc1
    v_exp_f32 v68, v68
    v_exp_f32 v69, v69
    v_exp_f32 v70, v70
    v_exp_f32 v71, v71
    v_smfmac_f32_32x32x32_bf16 v[108:123], v[228:231], v[60:67], v50
    s_xor_b32 s36, s36, 4096
    v_exp_f32 v72, v72
    v_exp_f32 v73, v73
    v_exp_f32 v74, v74
    v_exp_f32 v75, v75
    v_mfma_f32_32x32x8_bf16 v[92:107], v[244:245], v[192:193], 0
    v_exp_f32 v76, v76
    v_exp_f32 v77, v77
    v_exp_f32 v78, v78
    v_exp_f32 v79, v79
    v_mfma_f32_32x32x16_bf16 v[92:107], v[204:207], v[180:183], v[92:107]
    buffer_load_dwordx4 v[200:203], v1, s[36:39], 0 offen
    buffer_load_dwordx4 v[220:223], v49, s[36:39], 0 offen offset:1024
    v_exp_f32 v80, v80
    v_exp_f32 v81, v81
    v_exp_f32 v82, v82
    v_exp_f32 v83, v83
    v_smfmac_f32_32x32x32_bf16 v[108:123], v[232:235], v[68:75], v50
    buffer_load_dwordx4 v[224:227], v49, s[36:39], 0 offen offset:2048
    v_exp_f32 v84, v84
    v_exp_f32 v85, v85
    v_exp_f32 v86, v86
    v_exp_f32 v87, v87
    v_smfmac_f32_32x32x32_bf16 v[124:139], v[228:231], v[76:83], v50
    s_add_u32 s40, s40, 98304
    v_exp_f32 v88, v88
    v_exp_f32 v89, v89
    v_exp_f32 v90, v90
    v_exp_f32 v91, v91
    v_mfma_f32_32x32x8_bf16 v[60:75], v[244:245], v[194:195], 0
    v_exp_f32 v92, v92
    v_exp_f32 v93, v93
    v_exp_f32 v94, v94
    v_exp_f32 v95, v95
    v_mfma_f32_32x32x16_bf16 v[60:75], v[204:207], v[184:187], v[60:75]
    buffer_load_dwordx4 a[144:147], v51, s[40:43], 0 offen sc1
    buffer_load_dwordx4 a[148:151], v52, s[40:43], 0 offen sc1
    v_exp_f32 v96, v96
    v_exp_f32 v97, v97
    v_exp_f32 v98, v98
    v_exp_f32 v99, v99
    v_smfmac_f32_32x32x32_bf16 v[124:139], v[232:235], v[84:91], v50
    buffer_load_dwordx4 a[152:155], v53, s[40:43], 0 offen sc1
    v_exp_f32 v100, v100
    v_exp_f32 v101, v101
    v_exp_f32 v102, v102
    v_exp_f32 v103, v103
    v_smfmac_f32_32x32x32_bf16 v[140:155], v[228:231], v[92:99], v50
    s_waitcnt vmcnt(22)
    s_add_u32 s40, s40, 98304
    v_exp_f32 v104, v104
    v_exp_f32 v105, v105
    v_exp_f32 v106, v106
    v_exp_f32 v107, v107
    v_mfma_f32_32x32x8_bf16 v[76:91], v[246:247], v[188:189], 0
    v_exp_f32 v60, v60
    v_exp_f32 v61, v61
    v_exp_f32 v62, v62
    v_exp_f32 v63, v63
    v_mfma_f32_32x32x16_bf16 v[76:91], v[208:211], v[172:175], v[76:91]
    buffer_load_dwordx4 a[156:159], v51, s[40:43], 0 offen sc1
    buffer_load_dwordx4 a[160:163], v52, s[40:43], 0 offen sc1
    v_exp_f32 v64, v64
    v_exp_f32 v65, v65
    v_exp_f32 v66, v66
    v_exp_f32 v67, v67
    v_smfmac_f32_32x32x32_bf16 v[140:155], v[232:235], v[100:107], v50
    s_xor_b32 s36, s36, 12288
    v_exp_f32 v68, v68
    v_exp_f32 v69, v69
    v_exp_f32 v70, v70
    v_exp_f32 v71, v71
    v_smfmac_f32_32x32x32_bf16 v[156:171], v[228:231], v[60:67], v50
    v_exp_f32 v72, v72
    v_exp_f32 v73, v73
    v_exp_f32 v74, v74
    v_exp_f32 v75, v75
    v_mfma_f32_32x32x8_bf16 v[92:107], v[246:247], v[190:191], 0
    v_exp_f32 v76, v76
    v_exp_f32 v77, v77
    v_exp_f32 v78, v78
    v_exp_f32 v79, v79
    v_mfma_f32_32x32x16_bf16 v[92:107], v[208:211], v[176:179], v[92:107]
    buffer_load_dwordx4 v[204:207], v1, s[36:39], 0 offen
    v_exp_f32 v80, v80
    v_exp_f32 v81, v81
    v_exp_f32 v82, v82
    v_exp_f32 v83, v83
    v_smfmac_f32_32x32x32_bf16 v[156:171], v[232:235], v[68:75], v50
    buffer_load_dwordx4 v[252:255], v1, s[36:39], 0 offen offset:3072
    buffer_load_dwordx4 v[228:231], v49, s[36:39], 0 offen offset:1024
    v_exp_f32 v84, v84
    v_exp_f32 v85, v85
    v_exp_f32 v86, v86
    v_exp_f32 v87, v87
    v_smfmac_f32_32x32x32_bf16 v[108:123], v[236:239], v[76:83], v50
    v_exp_f32 v88, v88
    v_exp_f32 v89, v89
    v_exp_f32 v90, v90
    v_exp_f32 v91, v91
    v_mfma_f32_32x32x8_bf16 v[60:75], v[246:247], v[192:193], 0
    v_exp_f32 v92, v92
    v_exp_f32 v93, v93
    v_exp_f32 v94, v94
    v_exp_f32 v95, v95
    v_mfma_f32_32x32x16_bf16 v[60:75], v[208:211], v[180:183], v[60:75]
    buffer_load_dwordx4 v[232:235], v49, s[36:39], 0 offen offset:2048
    buffer_load_dwordx4 a[164:167], v53, s[40:43], 0 offen sc1
    v_exp_f32 v96, v96
    v_exp_f32 v97, v97
    v_exp_f32 v98, v98
    v_exp_f32 v99, v99
    v_smfmac_f32_32x32x32_bf16 v[108:123], v[240:243], v[84:91], v50
    s_add_u32 s40, s40, 98304
    v_exp_f32 v100, v100
    v_exp_f32 v101, v101
    v_exp_f32 v102, v102
    v_exp_f32 v103, v103
    v_smfmac_f32_32x32x32_bf16 v[124:139], v[236:239], v[92:99], v50
    v_exp_f32 v104, v104
    v_exp_f32 v105, v105
    v_exp_f32 v106, v106
    v_exp_f32 v107, v107
    v_mfma_f32_32x32x8_bf16 v[76:91], v[246:247], v[194:195], 0
    v_exp_f32 v60, v60
    v_exp_f32 v61, v61
    v_exp_f32 v62, v62
    v_exp_f32 v63, v63
    v_mfma_f32_32x32x16_bf16 v[76:91], v[208:211], v[184:187], v[76:91]
    s_waitcnt vmcnt(13)
    v_xor_b32 v26, s60, v26
    v_xor_b32 v27, s13, v27
    v_or_b32 v26, v26, v27
    v_cmp_ne_u32 vcc, 0, v26
    v_exp_f32 v64, v64
    v_exp_f32 v65, v65
    v_exp_f32 v66, v66
    v_exp_f32 v67, v67
    v_smfmac_f32_32x32x32_bf16 v[124:139], v[240:243], v[100:107], v50
    buffer_load_dwordx4 a[168:171], v51, s[40:43], 0 offen sc1
    buffer_load_dwordx4 a[172:175], v52, s[40:43], 0 offen sc1
    v_exp_f32 v68, v68
    v_exp_f32 v69, v69
    v_exp_f32 v70, v70
    v_exp_f32 v71, v71
    v_smfmac_f32_32x32x32_bf16 v[140:155], v[236:239], v[60:67], v50
    v_exp_f32 v72, v72
    v_exp_f32 v73, v73
    v_exp_f32 v74, v74
    v_exp_f32 v75, v75
    v_mfma_f32_32x32x8_bf16 v[92:107], v[248:249], v[188:189], 0
    v_exp_f32 v76, v76
    v_exp_f32 v77, v77
    v_exp_f32 v78, v78
    v_exp_f32 v79, v79
    v_mfma_f32_32x32x16_bf16 v[92:107], v[196:199], v[172:175], v[92:107]
    s_cbranch_vccnz L_rplate
L_rpok:
    ds_add_u32 v25, v19
    v_exp_f32 v80, v80
    v_exp_f32 v81, v81
    v_exp_f32 v82, v82
    v_exp_f32 v83, v83
    v_smfmac_f32_32x32x32_bf16 v[140:155], v[240:243], v[68:75], v50
    buffer_load_dwordx4 a[176:179], v53, s[40:43], 0 offen sc1
    v_exp_f32 v84, v84
    v_exp_f32 v85, v85
    v_exp_f32 v86, v86
    v_exp_f32 v87, v87
    v_smfmac_f32_32x32x32_bf16 v[156:171], v[236:239], v[76:83], v50
    s_add_u32 s40, s40, 98304
    v_exp_f32 v88, v88
    v_exp_f32 v89, v89
    v_exp_f32 v90, v90
    v_exp_f32 v91, v91
    v_mfma_f32_32x32x8_bf16 v[60:75], v[248:249], v[190:191], 0
    v_exp_f32 v92, v92
    v_exp_f32 v93, v93
    v_exp_f32 v94, v94
    v_exp_f32 v95, v95
    v_mfma_f32_32x32x16_bf16 v[60:75], v[196:199], v[176:179], v[60:75]
    ds_read_b32 v5, v25
    v_exp_f32 v96, v96
    v_exp_f32 v97, v97
    v_exp_f32 v98, v98
    v_exp_f32 v99, v99
    v_smfmac_f32_32x32x32_bf16 v[156:171], v[240:243], v[84:91], v50
    buffer_load_dwordx4 a[180:183], v51, s[40:43], 0 offen sc1
    v_exp_f32 v100, v100
    v_exp_f32 v101, v101
    v_exp_f32 v102, v102
    v_exp_f32 v103, v103
    v_smfmac_f32_32x32x32_bf16 v[108:123], v[212:215], v[92:99], v50
    s_waitcnt lgkmcnt(0)
    v_cmp_gt_u32 vcc, 12, v5
    v_exp_f32 v104, v104
    v_exp_f32 v105, v105
    v_exp_f32 v106, v106
    v_exp_f32 v107, v107
    v_mfma_f32_32x32x8_bf16 v[76:91], v[248:249], v[192:193], 0
    v_exp_f32 v60, v60
    v_exp_f32 v61, v61
    v_exp_f32 v62, v62
    v_exp_f32 v63, v63
    v_mfma_f32_32x32x16_bf16 v[76:91], v[196:199], v[180:183], v[76:91]
    s_cbranch_vccnz L_bl3
L_bk3:
    v_exp_f32 v64, v64
    v_exp_f32 v65, v65
    v_exp_f32 v66, v66
    v_exp_f32 v67, v67
    v_smfmac_f32_32x32x32_bf16 v[108:123], v[216:219], v[100:107], v50
    s_xor_b32 s36, s36, 4096
    v_exp_f32 v68, v68
    v_exp_f32 v69, v69
    v_exp_f32 v70, v70
    v_exp_f32 v71, v71
    v_smfmac_f32_32x32x32_bf16 v[124:139], v[212:215], v[60:67], v50
    buffer_load_dwordx4 v[208:211], v1, s[36:39], 0 offen
    buffer_load_dwordx4 v[236:239], v49, s[36:39], 0 offen offset:1024
    v_exp_f32 v72, v72
    v_exp_f32 v73, v73
    v_exp_f32 v74, v74
    v_exp_f32 v75, v75
    v_mfma_f32_32x32x8_bf16 v[92:107], v[248:249], v[194:195], 0
    v_exp_f32 v76, v76
    v_exp_f32 v77, v77
    v_exp_f32 v78, v78
    v_exp_f32 v79, v79
    v_mfma_f32_32x32x16_bf16 v[92:107], v[196:199], v[184:187], v[92:107]
    buffer_load_dwordx4 v[240:243], v49, s[36:39], 0 offen offset:2048
    buffer_load_dwordx4 a[184:187], v52, s[40:43], 0 offen sc1
    v_exp_f32 v80, v80
    v_exp_f32 v81, v81
    v_exp_f32 v82, v82
    v_exp_f32 v83, v83
    v_smfmac_f32_32x32x32_bf16 v[124:139], v[216:219], v[68:75], v50
    buffer_load_dwordx4 a[188:191], v53, s[40:43], 0 offen sc1
    v_exp_f32 v84, v84
    v_exp_f32 v85, v85
    v_exp_f32 v86, v86
    v_exp_f32 v87, v87
    v_smfmac_f32_32x32x32_bf16 v[140:155], v[212:215], v[76:83], v50
    s_waitcnt vmcnt(19)
    s_add_u32 s40, s40, 98304
    v_exp_f32 v88, v88
    v_exp_f32 v89, v89
    v_exp_f32 v90, v90
    v_exp_f32 v91, v91
    v_mfma_f32_32x32x8_bf16 v[60:75], v[250:251], v[188:189], 0
    v_exp_f32 v92, v92
    v_exp_f32 v93, v93
    v_exp_f32 v94, v94
    v_exp_f32 v95, v95
    v_mfma_f32_32x32x16_bf16 v[60:75], v[200:203], v[172:175], v[60:75]
    buffer_load_dwordx4 a[192:195], v51, s[40:43], 0 offen sc1
    buffer_load_dwordx4 a[196:199], v52, s[40:43], 0 offen sc1
    v_exp_f32 v96, v96
    v_exp_f32 v97, v97
    v_exp_f32 v98, v98
    v_exp_f32 v99, v99
    v_smfmac_f32_32x32x32_bf16 v[140:155], v[216:219], v[84:91], v50
    buffer_load_dwordx4 a[200:203], v53, s[40:43], 0 offen sc1
    v_exp_f32 v100, v100
    v_exp_f32 v101, v101
    v_exp_f32 v102, v102
    v_exp_f32 v103, v103
    v_smfmac_f32_32x32x32_bf16 v[156:171], v[212:215], v[92:99], v50
    s_add_u32 s40, s40, 98304
    v_exp_f32 v104, v104
    v_exp_f32 v105, v105
    v_exp_f32 v106, v106
    v_exp_f32 v107, v107
    v_mfma_f32_32x32x8_bf16 v[76:91], v[250:251], v[190:191], 0
    v_exp_f32 v60, v60
    v_exp_f32 v61, v61
    v_exp_f32 v62, v62
    v_exp_f32 v63, v63
    v_mfma_f32_32x32x16_bf16 v[76:91], v[200:203], v[176:179], v[76:91]
    buffer_load_dwordx4 a[204:207], v51, s[40:43], 0 offen sc1
    v_exp_f32 v64, v64
    v_exp_f32 v65, v65
    v_exp_f32 v66, v66
    v_exp_f32 v67, v67
    v_smfmac_f32_32x32x32_bf16 v[156:171], v[216:219], v[100:107], v50
    s_xor_b32 s36, s36, 110592
    v_exp_f32 v68, v68
    v_exp_f32 v69, v69
    v_exp_f32 v70, v70
    v_exp_f32 v71, v71
    v_smfmac_f32_32x32x32_bf16 v[108:123], v[220:223], v[60:67], v50
    buffer_load_dwordx4 v[196:199], v1, s[36:39], 0 offen
    buffer_load_dwordx4 v[244:247], v1, s[36:39], 0 offen offset:3072
    v_exp_f32 v72, v72
    v_exp_f32 v73, v73
    v_exp_f32 v74, v74
    v_exp_f32 v75, v75
    v_mfma_f32_32x32x8_bf16 v[92:107], v[250:251], v[192:193], 0
    v_exp_f32 v76, v76
    v_exp_f32 v77, v77
    v_exp_f32 v78, v78
    v_exp_f32 v79, v79
    v_mfma_f32_32x32x16_bf16 v[92:107], v[200:203], v[180:183], v[92:107]
    buffer_load_dwordx4 v[212:215], v49, s[36:39], 0 offen offset:1024
    buffer_load_dwordx4 v[216:219], v49, s[36:39], 0 offen offset:2048
    v_exp_f32 v80, v80
    v_exp_f32 v81, v81
    v_exp_f32 v82, v82
    v_exp_f32 v83, v83
    v_smfmac_f32_32x32x32_bf16 v[108:123], v[224:227], v[68:75], v50
    buffer_load_dwordx4 a[208:211], v52, s[40:43], 0 offen sc1
    v_exp_f32 v84, v84
    v_exp_f32 v85, v85
    v_exp_f32 v86, v86
    v_exp_f32 v87, v87
    v_smfmac_f32_32x32x32_bf16 v[124:139], v[220:223], v[76:83], v50
    v_exp_f32 v88, v88
    v_exp_f32 v89, v89
    v_exp_f32 v90, v90
    v_exp_f32 v91, v91
    v_mfma_f32_32x32x8_bf16 v[60:75], v[250:251], v[194:195], 0
    v_exp_f32 v92, v92
    v_exp_f32 v93, v93
    v_exp_f32 v94, v94
    v_exp_f32 v95, v95
    v_mfma_f32_32x32x16_bf16 v[60:75], v[200:203], v[184:187], v[60:75]
    buffer_load_dwordx4 a[212:215], v53, s[40:43], 0 offen sc1
    v_exp_f32 v96, v96
    v_exp_f32 v97, v97
    v_exp_f32 v98, v98
    v_exp_f32 v99, v99
    v_smfmac_f32_32x32x32_bf16 v[124:139], v[224:227], v[84:91], v50
    s_add_u32 s40, s40, 98304
    v_exp_f32 v100, v100
    v_exp_f32 v101, v101
    v_exp_f32 v102, v102
    v_exp_f32 v103, v103
    v_smfmac_f32_32x32x32_bf16 v[140:155], v[220:223], v[92:99], v50
    s_waitcnt vmcnt(20)
    v_exp_f32 v104, v104
    v_exp_f32 v105, v105
    v_exp_f32 v106, v106
    v_exp_f32 v107, v107
    v_mfma_f32_32x32x8_bf16 v[76:91], v[252:253], v[188:189], 0
    v_exp_f32 v60, v60
    v_exp_f32 v61, v61
    v_exp_f32 v62, v62
    v_exp_f32 v63, v63
    v_mfma_f32_32x32x16_bf16 v[76:91], v[204:207], v[172:175], v[76:91]
    buffer_load_dwordx4 a[216:219], v51, s[40:43], 0 offen sc1
    buffer_load_dwordx4 a[220:223], v52, s[40:43], 0 offen sc1
    v_exp_f32 v64, v64
    v_exp_f32 v65, v65
    v_exp_f32 v66, v66
    v_exp_f32 v67, v67
    v_smfmac_f32_32x32x32_bf16 v[140:155], v[224:227], v[100:107], v50
    buffer_load_dwordx4 a[224:227], v53, s[40:43], 0 offen sc1
    v_exp_f32 v68, v68
    v_exp_f32 v69, v69
    v_exp_f32 v70, v70
    v_exp_f32 v71, v71
    v_smfmac_f32_32x32x32_bf16 v[156:171], v[220:223], v[60:67], v50
    s_xor_b32 s36, s36, 4096
    v_exp_f32 v72, v72
    v_exp_f32 v73, v73
    v_exp_f32 v74, v74
    v_exp_f32 v75, v75
    v_mfma_f32_32x32x8_bf16 v[92:107], v[252:253], v[190:191], 0
    v_exp_f32 v76, v76
    v_exp_f32 v77, v77
    v_exp_f32 v78, v78
    v_exp_f32 v79, v79
    v_mfma_f32_32x32x16_bf16 v[92:107], v[204:207], v[176:179], v[92:107]
    buffer_load_dwordx4 v[200:203], v1, s[36:39], 0 offen
    v_exp_f32 v80, v80
    v_exp_f32 v81, v81
    v_exp_f32 v82, v82
    v_exp_f32 v83, v83
    v_smfmac_f32_32x32x32_bf16 v[156:171], v[224:227], v[68:75], v50
    buffer_load_dwordx4 v[220:223], v49, s[36:39], 0 offen offset:1024
    v_exp_f32 v84, v84
    v_exp_f32 v85, v85
    v_exp_f32 v86, v86
    v_exp_f32 v87, v87
    v_smfmac_f32_32x32x32_bf16 v[108:123], v[228:231], v[76:83], v50
L_wp4:
    s_cbranch_execz L_wret0
    v_exp_f32 v88, v88
    v_exp_f32 v89, v89
    v_exp_f32 v90, v90
    v_exp_f32 v91, v91
    v_mfma_f32_32x32x8_bf16 v[60:75], v[252:253], v[192:193], 0
    v_exp_f32 v92, v92
    v_exp_f32 v93, v93
    v_exp_f32 v94, v94
    v_exp_f32 v95, v95
    v_mfma_f32_32x32x16_bf16 v[60:75], v[204:207], v[180:183], v[60:75]
    buffer_load_dwordx4 v[224:227], v49, s[36:39], 0 offen offset:2048
    v_exp_f32 v96, v96
    v_exp_f32 v97, v97
    v_exp_f32 v98, v98
    v_exp_f32 v99, v99
    v_smfmac_f32_32x32x32_bf16 v[108:123], v[232:235], v[84:91], v50
    s_add_u32 s40, s40, 98304
    v_exp_f32 v100, v100
    v_exp_f32 v101, v101
    v_exp_f32 v102, v102
    v_exp_f32 v103, v103
    v_smfmac_f32_32x32x32_bf16 v[124:139], v[228:231], v[92:99], v50
    buffer_load_dwordx4 a[228:231], v51, s[40:43], 0 offen sc1
    v_exp_f32 v104, v104
    v_exp_f32 v105, v105
    v_exp_f32 v106, v106
    v_exp_f32 v107, v107
    v_mfma_f32_32x32x8_bf16 v[76:91], v[252:253], v[194:195], 0
    v_exp_f32 v60, v60
    v_exp_f32 v61, v61
    v_exp_f32 v62, v62
    v_exp_f32 v63, v63
    v_mfma_f32_32x32x16_bf16 v[76:91], v[204:207], v[184:187], v[76:91]
    buffer_load_dwordx4 a[232:235], v52, s[40:43], 0 offen sc1
    buffer_load_dwordx4 a[236:239], v53, s[40:43], 0 offen sc1
    v_exp_f32 v64, v64
    v_exp_f32 v65, v65
    v_exp_f32 v66, v66
    v_exp_f32 v67, v67
    v_smfmac_f32_32x32x32_bf16 v[124:139], v[232:235], v[100:107], v50
    s_add_u32 m0, s7, 0
    v_exp_f32 v68, v68
    v_exp_f32 v69, v69
    v_exp_f32 v70, v70
    v_exp_f32 v71, v71
    v_smfmac_f32_32x32x32_bf16 v[140:155], v[228:231], v[60:67], v50
    s_waitcnt vmcnt(21)
    v_exp_f32 v72, v72
    v_exp_f32 v73, v73
    v_exp_f32 v74, v74
    v_exp_f32 v75, v75
    v_mfma_f32_32x32x8_bf16 v[92:107], v[254:255], v[188:189], 0
    v_exp_f32 v76, v76
    v_exp_f32 v77, v77
    v_exp_f32 v78, v78
    v_exp_f32 v79, v79
    v_mfma_f32_32x32x16_bf16 v[92:107], v[208:211], v[172:175], v[92:107]
    buffer_load_dwordx4 v1, s[64:67], 0 offen sc1 lds
    buffer_load_dwordx4 v1, s[64:67], 0 offen offset:1024 sc1 lds
    v_exp_f32 v80, v80
    v_exp_f32 v81, v81
    v_exp_f32 v82, v82
    v_exp_f32 v83, v83
    v_smfmac_f32_32x32x32_bf16 v[140:155], v[232:235], v[68:75], v50
    s_xor_b32 s36, s36, 12288
    v_exp_f32 v84, v84
    v_exp_f32 v85, v85
    v_exp_f32 v86, v86
    v_exp_f32 v87, v87
    v_smfmac_f32_32x32x32_bf16 v[156:171], v[228:231], v[76:83], v50
    v_exp_f32 v88, v88
    v_exp_f32 v89, v89
    v_exp_f32 v90, v90
    v_exp_f32 v91, v91
    v_mfma_f32_32x32x8_bf16 v[60:75], v[254:255], v[190:191], 0
    v_exp_f32 v92, v92
    v_exp_f32 v93, v93
    v_exp_f32 v94, v94
    v_exp_f32 v95, v95
    v_mfma_f32_32x32x16_bf16 v[60:75], v[208:211], v[176:179], v[60:75]
    buffer_load_dwordx4 v[204:207], v1, s[36:39], 0 offen
    v_exp_f32 v96, v96
    v_exp_f32 v97, v97
    v_exp_f32 v98, v98
    v_exp_f32 v99, v99
    v_smfmac_f32_32x32x32_bf16 v[156:171], v[232:235], v[84:91], v50
    buffer_load_dwordx4 v[248:251], v1, s[36:39], 0 offen offset:3072
    v_exp_f32 v100, v100
    v_exp_f32 v101, v101
    v_exp_f32 v102, v102
    v_exp_f32 v103, v103
    v_smfmac_f32_32x32x32_bf16 v[108:123], v[236:239], v[92:99], v50
    v_exp_f32 v104, v104
    v_exp_f32 v105, v105
    v_exp_f32 v106, v106
    v_exp_f32 v107, v107
    v_mfma_f32_32x32x8_bf16 v[76:91], v[254:255], v[192:193], 0
    v_exp_f32 v60, v60
    v_exp_f32 v61, v61
    v_exp_f32 v62, v62
    v_exp_f32 v63, v63
    v_mfma_f32_32x32x16_bf16 v[76:91], v[208:211], v[180:183], v[76:91]
    buffer_load_dwordx4 v[228:231], v49, s[36:39], 0 offen offset:1024
    buffer_load_dwordx4 v[232:235], v49, s[36:39], 0 offen offset:2048
    v_exp_f32 v64, v64
    v_exp_f32 v65, v65
    v_exp_f32 v66, v66
    v_exp_f32 v67, v67
    v_smfmac_f32_32x32x32_bf16 v[108:123], v[240:243], v[100:107], v50
    v_exp_f32 v68, v68
    v_exp_f32 v69, v69
    v_exp_f32 v70, v70
    v_exp_f32 v71, v71
    v_smfmac_f32_32x32x32_bf16 v[124:139], v[236:239], v[60:67], v50
    v_exp_f32 v72, v72
    v_exp_f32 v73, v73
    v_exp_f32 v74, v74
    v_exp_f32 v75, v75
    v_mfma_f32_32x32x8_bf16 v[92:107], v[254:255], v[194:195], 0
    v_exp_f32 v76, v76
    v_exp_f32 v77, v77
    v_exp_f32 v78, v78
    v_exp_f32 v79, v79
    v_mfma_f32_32x32x16_bf16 v[92:107], v[208:211], v[184:187], v[92:107]
    buffer_load_dwordx4 v1, s[64:67], 0 offen offset:2048 sc1 lds
    buffer_load_dwordx4 v1, s[64:67], 0 offen offset:3072 sc1 lds
    v_exp_f32 v80, v80
    v_exp_f32 v81, v81
    v_exp_f32 v82, v82
    v_exp_f32 v83, v83
    v_smfmac_f32_32x32x32_bf16 v[124:139], v[240:243], v[68:75], v50
    s_addk_i32 m0, 4096
    v_exp_f32 v84, v84
    v_exp_f32 v85, v85
    v_exp_f32 v86, v86
    v_exp_f32 v87, v87
    v_smfmac_f32_32x32x32_bf16 v[140:155], v[236:239], v[76:83], v50
    s_waitcnt vmcnt(19)
    v_exp_f32 v88, v88
    v_exp_f32 v89, v89
    v_exp_f32 v90, v90
    v_exp_f32 v91, v91
    v_mfma_f32_32x32x8_bf16 v[60:75], v[244:245], v[188:189], 0
    v_exp_f32 v92, v92
    v_exp_f32 v93, v93
    v_exp_f32 v94, v94
    v_exp_f32 v95, v95
    v_mfma_f32_32x32x16_bf16 v[60:75], v[196:199], v[172:175], v[60:75]
    buffer_load_dwordx4 v2, s[64:67], 0 offen sc1 lds
    v_exp_f32 v96, v96
    v_exp_f32 v97, v97
    v_exp_f32 v98, v98
    v_exp_f32 v99, v99
    v_smfmac_f32_32x32x32_bf16 v[140:155], v[240:243], v[84:91], v50
    s_add_u32 m0, s7, 10240
    s_add_u32 s64, s64, 81920
    v_exp_f32 v100, v100
    v_exp_f32 v101, v101
    v_exp_f32 v102, v102
    v_exp_f32 v103, v103
    v_smfmac_f32_32x32x32_bf16 v[156:171], v[236:239], v[92:99], v50
    buffer_load_dwordx4 v1, s[64:67], 0 offen offset:1024 sc1 lds
    v_exp_f32 v104, v104
    v_exp_f32 v105, v105
    v_exp_f32 v106, v106
    v_exp_f32 v107, v107
    v_mfma_f32_32x32x8_bf16 v[76:91], v[244:245], v[190:191], 0
    v_exp_f32 v60, v60
    v_exp_f32 v61, v61
    v_exp_f32 v62, v62
    v_exp_f32 v63, v63
    v_mfma_f32_32x32x16_bf16 v[76:91], v[196:199], v[176:179], v[76:91]
    s_xor_b32 s36, s36, 4096
    v_exp_f32 v64, v64
    v_exp_f32 v65, v65
    v_exp_f32 v66, v66
    v_exp_f32 v67, v67
    v_smfmac_f32_32x32x32_bf16 v[156:171], v[240:243], v[100:107], v50
    buffer_load_dwordx4 v[208:211], v1, s[36:39], 0 offen
    buffer_load_dwordx4 v[236:239], v49, s[36:39], 0 offen offset:1024
    v_exp_f32 v68, v68
    v_exp_f32 v69, v69
    v_exp_f32 v70, v70
    v_exp_f32 v71, v71
    v_smfmac_f32_32x32x32_bf16 v[108:123], v[212:215], v[60:67], v50
    buffer_load_dwordx4 v[240:243], v49, s[36:39], 0 offen offset:2048
    v_exp_f32 v72, v72
    v_exp_f32 v73, v73
    v_exp_f32 v74, v74
    v_exp_f32 v75, v75
    v_mfma_f32_32x32x8_bf16 v[92:107], v[244:245], v[192:193], 0
    v_exp_f32 v76, v76
    v_exp_f32 v77, v77
    v_exp_f32 v78, v78
    v_exp_f32 v79, v79
    v_mfma_f32_32x32x16_bf16 v[92:107], v[196:199], v[180:183], v[92:107]
    s_mul_i32 s19, s16, 1664
    v_exp_f32 v80, v80
    v_exp_f32 v81, v81
    v_exp_f32 v82, v82
    v_exp_f32 v83, v83
    v_smfmac_f32_32x32x32_bf16 v[108:123], v[216:219], v[68:75], v50
    buffer_load_dword v42, v8, s[48:51], s19 offen sc1
    buffer_load_dwordx4 v1, s[64:67], 0 offen offset:2048 sc1 lds
    v_exp_f32 v84, v84
    v_exp_f32 v85, v85
    v_exp_f32 v86, v86
    v_exp_f32 v87, v87
    v_smfmac_f32_32x32x32_bf16 v[124:139], v[212:215], v[76:83], v50
    v_exp_f32 v88, v88
    v_exp_f32 v89, v89
    v_exp_f32 v90, v90
    v_exp_f32 v91, v91
    v_mfma_f32_32x32x8_bf16 v[60:75], v[244:245], v[194:195], 0
    v_exp_f32 v92, v92
    v_exp_f32 v93, v93
    v_exp_f32 v94, v94
    v_exp_f32 v95, v95
    v_mfma_f32_32x32x16_bf16 v[60:75], v[196:199], v[184:187], v[60:75]
    buffer_load_dwordx4 v1, s[64:67], 0 offen offset:3072 sc1 lds
    v_exp_f32 v96, v96
    v_exp_f32 v97, v97
    v_exp_f32 v98, v98
    v_exp_f32 v99, v99
    v_smfmac_f32_32x32x32_bf16 v[124:139], v[216:219], v[84:91], v50
    s_addk_i32 m0, 4096
    v_exp_f32 v100, v100
    v_exp_f32 v101, v101
    v_exp_f32 v102, v102
    v_exp_f32 v103, v103
    v_smfmac_f32_32x32x32_bf16 v[140:155], v[212:215], v[92:99], v50
    s_waitcnt vmcnt(19)
    v_exp_f32 v104, v104
    v_exp_f32 v105, v105
    v_exp_f32 v106, v106
    v_exp_f32 v107, v107
    v_mfma_f32_32x32x8_bf16 v[76:91], v[246:247], v[188:189], 0
    v_exp_f32 v60, v60
    v_exp_f32 v61, v61
    v_exp_f32 v62, v62
    v_exp_f32 v63, v63
    v_mfma_f32_32x32x16_bf16 v[76:91], v[200:203], v[172:175], v[76:91]
    buffer_load_dwordx4 v2, s[64:67], 0 offen sc1 lds
    v_exp_f32 v64, v64
    v_exp_f32 v65, v65
    v_exp_f32 v66, v66
    v_exp_f32 v67, v67
    v_smfmac_f32_32x32x32_bf16 v[140:155], v[216:219], v[100:107], v50
    s_add_u32 m0, s9, 102400
    v_exp_f32 v68, v68
    v_exp_f32 v69, v69
    v_exp_f32 v70, v70
    v_exp_f32 v71, v71
    v_smfmac_f32_32x32x32_bf16 v[156:171], v[212:215], v[60:67], v50
    buffer_load_dwordx4 v1, s[32:35], 0 offen sc1 lds
    buffer_load_dwordx4 v1, s[32:35], 0 offen offset:1024 sc1 lds
    v_exp_f32 v72, v72
    v_exp_f32 v73, v73
    v_exp_f32 v74, v74
    v_exp_f32 v75, v75
    v_mfma_f32_32x32x8_bf16 v[92:107], v[246:247], v[190:191], 0
    v_exp_f32 v76, v76
    v_exp_f32 v77, v77
    v_exp_f32 v78, v78
    v_exp_f32 v79, v79
    v_mfma_f32_32x32x16_bf16 v[92:107], v[200:203], v[176:179], v[92:107]
    s_xor_b32 s36, s36, 45056
    v_exp_f32 v80, v80
    v_exp_f32 v81, v81
    v_exp_f32 v82, v82
    v_exp_f32 v83, v83
    v_smfmac_f32_32x32x32_bf16 v[156:171], v[216:219], v[68:75], v50
    buffer_load_dwordx4 v[196:199], v1, s[36:39], 0 offen
    buffer_load_dwordx4 v[252:255], v1, s[36:39], 0 offen offset:3072
    v_exp_f32 v84, v84
    v_exp_f32 v85, v85
    v_exp_f32 v86, v86
    v_exp_f32 v87, v87
    v_smfmac_f32_32x32x32_bf16 v[108:123], v[220:223], v[76:83], v50
    buffer_load_dwordx4 v[212:215], v49, s[36:39], 0 offen offset:1024
    v_exp_f32 v88, v88
    v_exp_f32 v89, v89
    v_exp_f32 v90, v90
    v_exp_f32 v91, v91
    v_mfma_f32_32x32x8_bf16 v[60:75], v[246:247], v[192:193], 0
    v_exp_f32 v92, v92
    v_exp_f32 v93, v93
    v_exp_f32 v94, v94
    v_exp_f32 v95, v95
    v_mfma_f32_32x32x16_bf16 v[60:75], v[200:203], v[180:183], v[60:75]
    buffer_load_dwordx4 v[216:219], v49, s[36:39], 0 offen offset:2048
    v_exp_f32 v96, v96
    v_exp_f32 v97, v97
    v_exp_f32 v98, v98
    v_exp_f32 v99, v99
    v_smfmac_f32_32x32x32_bf16 v[108:123], v[224:227], v[84:91], v50
    s_add_u32 s19, s19, 106496
    v_exp_f32 v100, v100
    v_exp_f32 v101, v101
    v_exp_f32 v102, v102
    v_exp_f32 v103, v103
    v_smfmac_f32_32x32x32_bf16 v[124:139], v[220:223], v[92:99], v50
    buffer_load_dword v42, v8, s[48:51], s19 offen sc1
    v_exp_f32 v104, v104
    v_exp_f32 v105, v105
    v_exp_f32 v106, v106
    v_exp_f32 v107, v107
    v_mfma_f32_32x32x8_bf16 v[76:91], v[246:247], v[194:195], 0
    v_exp_f32 v60, v60
    v_exp_f32 v61, v61
    v_exp_f32 v62, v62
    v_exp_f32 v63, v63
    v_mfma_f32_32x32x16_bf16 v[76:91], v[200:203], v[184:187], v[76:91]
    buffer_load_dwordx4 v1, s[32:35], 0 offen offset:2048 sc1 lds
    buffer_load_dwordx4 v1, s[32:35], 0 offen offset:3072 sc1 lds
    v_exp_f32 v64, v64
    v_exp_f32 v65, v65
    v_exp_f32 v66, v66
    v_exp_f32 v67, v67
    v_smfmac_f32_32x32x32_bf16 v[124:139], v[224:227], v[100:107], v50
    s_addk_i32 m0, 4096
    v_exp_f32 v68, v68
    v_exp_f32 v69, v69
    v_exp_f32 v70, v70
    v_exp_f32 v71, v71
    v_smfmac_f32_32x32x32_bf16 v[140:155], v[220:223], v[60:67], v50
    s_waitcnt vmcnt(20)
    v_exp_f32 v72, v72
    v_exp_f32 v73, v73
    v_exp_f32 v74, v74
    v_exp_f32 v75, v75
    v_mfma_f32_32x32x8_bf16 v[92:107], v[248:249], v[188:189], 0
    v_exp_f32 v76, v76
    v_exp_f32 v77, v77
    v_exp_f32 v78, v78
    v_exp_f32 v79, v79
    v_mfma_f32_32x32x16_bf16 v[92:107], v[204:207], v[172:175], v[92:107]
    buffer_load_dwordx4 v2, s[32:35], 0 offen sc1 lds
    v_exp_f32 v80, v80
    v_exp_f32 v81, v81
    v_exp_f32 v82, v82
    v_exp_f32 v83, v83
    v_smfmac_f32_32x32x32_bf16 v[140:155], v[224:227], v[68:75], v50
    s_add_u32 m0, s9, 122880
    s_add_u32 s32, s32, 163840
    v_exp_f32 v84, v84
    v_exp_f32 v85, v85
    v_exp_f32 v86, v86
    v_exp_f32 v87, v87
    v_smfmac_f32_32x32x32_bf16 v[156:171], v[220:223], v[76:83], v50
    buffer_load_dwordx4 v1, s[32:35], 0 offen sc1 lds
    v_exp_f32 v88, v88
    v_exp_f32 v89, v89
    v_exp_f32 v90, v90
    v_exp_f32 v91, v91
    v_mfma_f32_32x32x8_bf16 v[60:75], v[248:249], v[190:191], 0
    v_exp_f32 v92, v92
    v_exp_f32 v93, v93
    v_exp_f32 v94, v94
    v_exp_f32 v95, v95
    v_mfma_f32_32x32x16_bf16 v[60:75], v[204:207], v[176:179], v[60:75]
    s_xor_b32 s36, s36, 4096
    v_exp_f32 v96, v96
    v_exp_f32 v97, v97
    v_exp_f32 v98, v98
    v_exp_f32 v99, v99
    v_smfmac_f32_32x32x32_bf16 v[156:171], v[224:227], v[84:91], v50
    buffer_load_dwordx4 v[200:203], v1, s[36:39], 0 offen
    buffer_load_dwordx4 v[220:223], v49, s[36:39], 0 offen offset:1024
    v_exp_f32 v100, v100
    v_exp_f32 v101, v101
    v_exp_f32 v102, v102
    v_exp_f32 v103, v103
    v_smfmac_f32_32x32x32_bf16 v[108:123], v[228:231], v[92:99], v50
    buffer_load_dwordx4 v[224:227], v49, s[36:39], 0 offen offset:2048
    v_exp_f32 v104, v104
    v_exp_f32 v105, v105
    v_exp_f32 v106, v106
    v_exp_f32 v107, v107
    v_mfma_f32_32x32x8_bf16 v[76:91], v[248:249], v[192:193], 0
    v_exp_f32 v60, v60
    v_exp_f32 v61, v61
    v_exp_f32 v62, v62
    v_exp_f32 v63, v63
    v_mfma_f32_32x32x16_bf16 v[76:91], v[204:207], v[180:183], v[76:91]
    s_mul_i32 s19, s16, 1280
    v_exp_f32 v64, v64
    v_exp_f32 v65, v65
    v_exp_f32 v66, v66
    v_exp_f32 v67, v67
    v_smfmac_f32_32x32x32_bf16 v[108:123], v[232:235], v[100:107], v50
    buffer_load_dword v42, v8, s[52:55], s19 offen sc1
    buffer_load_dwordx4 v1, s[32:35], 0 offen offset:1024 sc1 lds
    v_exp_f32 v68, v68
    v_exp_f32 v69, v69
    v_exp_f32 v70, v70
    v_exp_f32 v71, v71
    v_smfmac_f32_32x32x32_bf16 v[124:139], v[228:231], v[60:67], v50
    v_exp_f32 v72, v72
    v_exp_f32 v73, v73
    v_exp_f32 v74, v74
    v_exp_f32 v75, v75
    v_mfma_f32_32x32x8_bf16 v[92:107], v[248:249], v[194:195], 0
    v_exp_f32 v76, v76
    v_exp_f32 v77, v77
    v_exp_f32 v78, v78
    v_exp_f32 v79, v79
    v_mfma_f32_32x32x16_bf16 v[92:107], v[204:207], v[184:187], v[92:107]
    buffer_load_dwordx4 v1, s[32:35], 0 offen offset:2048 sc1 lds
    buffer_load_dwordx4 v1, s[32:35], 0 offen offset:3072 sc1 lds
    v_exp_f32 v80, v80
    v_exp_f32 v81, v81
    v_exp_f32 v82, v82
    v_exp_f32 v83, v83
    v_smfmac_f32_32x32x32_bf16 v[124:139], v[232:235], v[68:75], v50
    s_addk_i32 m0, 4096
    v_exp_f32 v84, v84
    v_exp_f32 v85, v85
    v_exp_f32 v86, v86
    v_exp_f32 v87, v87
    v_smfmac_f32_32x32x32_bf16 v[140:155], v[228:231], v[76:83], v50
    s_waitcnt vmcnt(22)
    v_exp_f32 v88, v88
    v_exp_f32 v89, v89
    v_exp_f32 v90, v90
    v_exp_f32 v91, v91
    v_mfma_f32_32x32x8_bf16 v[60:75], v[250:251], v[188:189], 0
    v_exp_f32 v92, v92
    v_exp_f32 v93, v93
    v_exp_f32 v94, v94
    v_exp_f32 v95, v95
    v_mfma_f32_32x32x16_bf16 v[60:75], v[208:211], v[172:175], v[60:75]
    buffer_load_dwordx4 v2, s[32:35], 0 offen sc1 lds
    v_exp_f32 v96, v96
    v_exp_f32 v97, v97
    v_exp_f32 v98, v98
    v_exp_f32 v99, v99
    v_smfmac_f32_32x32x32_bf16 v[140:155], v[232:235], v[84:91], v50
    s_add_u32 m0, s9, 143360
    s_add_u32 s32, s32, 163840
    v_exp_f32 v100, v100
    v_exp_f32 v101, v101
    v_exp_f32 v102, v102
    v_exp_f32 v103, v103
    v_smfmac_f32_32x32x32_bf16 v[156:171], v[228:231], v[92:99], v50
    buffer_load_dwordx4 v1, s[32:35], 0 offen sc1 lds
    v_exp_f32 v104, v104
    v_exp_f32 v105, v105
    v_exp_f32 v106, v106
    v_exp_f32 v107, v107
    v_mfma_f32_32x32x8_bf16 v[76:91], v[250:251], v[190:191], 0
    v_exp_f32 v60, v60
    v_exp_f32 v61, v61
    v_exp_f32 v62, v62
    v_exp_f32 v63, v63
    v_mfma_f32_32x32x16_bf16 v[76:91], v[208:211], v[176:179], v[76:91]
    s_xor_b32 s36, s36, 12288
    v_exp_f32 v64, v64
    v_exp_f32 v65, v65
    v_exp_f32 v66, v66
    v_exp_f32 v67, v67
    v_smfmac_f32_32x32x32_bf16 v[156:171], v[232:235], v[100:107], v50
    buffer_load_dwordx4 v[204:207], v1, s[36:39], 0 offen
    buffer_load_dwordx4 v[244:247], v1, s[36:39], 0 offen offset:3072
    v_exp_f32 v68, v68
    v_exp_f32 v69, v69
    v_exp_f32 v70, v70
    v_exp_f32 v71, v71
    v_smfmac_f32_32x32x32_bf16 v[108:123], v[236:239], v[60:67], v50
    buffer_load_dwordx4 v[228:231], v49, s[36:39], 0 offen offset:1024
    v_exp_f32 v72, v72
    v_exp_f32 v73, v73
    v_exp_f32 v74, v74
    v_exp_f32 v75, v75
    v_mfma_f32_32x32x8_bf16 v[92:107], v[250:251], v[192:193], 0
    v_exp_f32 v76, v76
    v_exp_f32 v77, v77
    v_exp_f32 v78, v78
    v_exp_f32 v79, v79
    v_mfma_f32_32x32x16_bf16 v[92:107], v[208:211], v[180:183], v[92:107]
    buffer_load_dwordx4 v[232:235], v49, s[36:39], 0 offen offset:2048
    v_exp_f32 v80, v80
    v_exp_f32 v81, v81
    v_exp_f32 v82, v82
    v_exp_f32 v83, v83
    v_smfmac_f32_32x32x32_bf16 v[108:123], v[240:243], v[68:75], v50
    s_add_u32 s19, s19, 81920
    v_exp_f32 v84, v84
    v_exp_f32 v85, v85
    v_exp_f32 v86, v86
    v_exp_f32 v87, v87
    v_smfmac_f32_32x32x32_bf16 v[124:139], v[236:239], v[76:83], v50
    buffer_load_dword v42, v8, s[52:55], s19 offen sc1
    v_exp_f32 v88, v88
    v_exp_f32 v89, v89
    v_exp_f32 v90, v90
    v_exp_f32 v91, v91
    v_mfma_f32_32x32x8_bf16 v[60:75], v[250:251], v[194:195], 0
    v_exp_f32 v92, v92
    v_exp_f32 v93, v93
    v_exp_f32 v94, v94
    v_exp_f32 v95, v95
    v_mfma_f32_32x32x16_bf16 v[60:75], v[208:211], v[184:187], v[60:75]
    buffer_load_dwordx4 v1, s[32:35], 0 offen offset:1024 sc1 lds
    buffer_load_dwordx4 v1, s[32:35], 0 offen offset:2048 sc1 lds
    v_exp_f32 v96, v96
    v_exp_f32 v97, v97
    v_exp_f32 v98, v98
    v_exp_f32 v99, v99
    v_smfmac_f32_32x32x32_bf16 v[124:139], v[240:243], v[84:91], v50
    v_exp_f32 v100, v100
    v_exp_f32 v101, v101
    v_exp_f32 v102, v102
    v_exp_f32 v103, v103
    v_smfmac_f32_32x32x32_bf16 v[140:155], v[236:239], v[92:99], v50
    s_waitcnt vmcnt(21)
    v_exp_f32 v104, v104
    v_exp_f32 v105, v105
    v_exp_f32 v106, v106
    v_exp_f32 v107, v107
    v_mfma_f32_32x32x8_bf16 v[76:91], v[252:253], v[188:189], 0
    v_exp_f32 v60, v60
    v_exp_f32 v61, v61
    v_exp_f32 v62, v62
    v_exp_f32 v63, v63
    v_mfma_f32_32x32x16_bf16 v[76:91], v[196:199], v[172:175], v[76:91]
    buffer_load_dwordx4 v1, s[32:35], 0 offen offset:3072 sc1 lds
    v_exp_f32 v64, v64
    v_exp_f32 v65, v65
    v_exp_f32 v66, v66
    v_exp_f32 v67, v67
    v_smfmac_f32_32x32x32_bf16 v[140:155], v[240:243], v[100:107], v50
    s_addk_i32 m0, 4096
    v_exp_f32 v68, v68
    v_exp_f32 v69, v69
    v_exp_f32 v70, v70
    v_exp_f32 v71, v71
    v_smfmac_f32_32x32x32_bf16 v[156:171], v[236:239], v[60:67], v50
    buffer_load_dwordx4 v2, s[32:35], 0 offen sc1 lds
    v_exp_f32 v72, v72
    v_exp_f32 v73, v73
    v_exp_f32 v74, v74
    v_exp_f32 v75, v75
    v_mfma_f32_32x32x8_bf16 v[92:107], v[252:253], v[190:191], 0
    v_exp_f32 v76, v76
    v_exp_f32 v77, v77
    v_exp_f32 v78, v78
    v_exp_f32 v79, v79
    v_mfma_f32_32x32x16_bf16 v[92:107], v[196:199], v[176:179], v[92:107]
    s_getpc_b64 s[78:79]
L_pc1:
    s_lshr_b32 s77, s2, 3
    v_exp_f32 v80, v80
    v_exp_f32 v81, v81
    v_exp_f32 v82, v82
    v_exp_f32 v83, v83
    v_smfmac_f32_32x32x32_bf16 v[156:171], v[240:243], v[68:75], v50
    s_xor_b32 s36, s36, 4096
    v_exp_f32 v84, v84
    v_exp_f32 v85, v85
    v_exp_f32 v86, v86
    v_exp_f32 v87, v87
    v_smfmac_f32_32x32x32_bf16 v[108:123], v[212:215], v[76:83], v50
    buffer_load_dwordx4 v[208:211], v1, s[36:39], 0 offen
    buffer_load_dwordx4 v[236:239], v49, s[36:39], 0 offen offset:1024
    v_exp_f32 v88, v88
    v_exp_f32 v89, v89
    v_exp_f32 v90, v90
    v_exp_f32 v91, v91
    v_mfma_f32_32x32x8_bf16 v[60:75], v[252:253], v[192:193], 0
    v_exp_f32 v92, v92
    v_exp_f32 v93, v93
    v_exp_f32 v94, v94
    v_exp_f32 v95, v95
    v_mfma_f32_32x32x16_bf16 v[60:75], v[196:199], v[180:183], v[60:75]
    s_mulk_i32 s77, 896
    v_min_u32 v44, 6, v0
    v_exp_f32 v96, v96
    v_exp_f32 v97, v97
    v_exp_f32 v98, v98
    v_exp_f32 v99, v99
    v_smfmac_f32_32x32x32_bf16 v[108:123], v[216:219], v[84:91], v50
    buffer_load_dwordx4 v[240:243], v49, s[36:39], 0 offen offset:2048
    buffer_load_dword v42, v57, s[68:71], s17 offen sc1
    v_exp_f32 v100, v100
    v_exp_f32 v101, v101
    v_exp_f32 v102, v102
    v_exp_f32 v103, v103
    v_smfmac_f32_32x32x32_bf16 v[124:139], v[212:215], v[92:99], v50
    s_add_u32 m0, s9, 0
    s_add_u32 s32, s32, 163840
    v_exp_f32 v104, v104
    v_exp_f32 v105, v105
    v_exp_f32 v106, v106
    v_exp_f32 v107, v107
    v_mfma_f32_32x32x8_bf16 v[76:91], v[252:253], v[194:195], 0
    v_exp_f32 v60, v60
    v_exp_f32 v61, v61
    v_exp_f32 v62, v62
    v_exp_f32 v63, v63
    v_mfma_f32_32x32x16_bf16 v[76:91], v[196:199], v[184:187], v[76:91]
    v_lshl_add_u32 v44, v44, 7, s77
    v_min_u32 v44, L_codeend-L_pc1-4, v44
    v_exp_f32 v64, v64
    v_exp_f32 v65, v65
    v_exp_f32 v66, v66
    v_exp_f32 v67, v67
    v_smfmac_f32_32x32x32_bf16 v[124:139], v[216:219], v[100:107], v50
    buffer_load_dwordx4 v1, s[32:35], 0 offen sc1 lds
    buffer_load_dwordx4 v1, s[32:35], 0 offen offset:1024 sc1 lds
    v_exp_f32 v68, v68
    v_exp_f32 v69, v69
    v_exp_f32 v70, v70
    v_exp_f32 v71, v71
    v_smfmac_f32_32x32x32_bf16 v[140:155], v[212:215], v[60:67], v50
    s_waitcnt vmcnt(21)
    v_exp_f32 v72, v72
    v_exp_f32 v73, v73
    v_exp_f32 v74, v74
    v_exp_f32 v75, v75
    v_mfma_f32_32x32x8_bf16 v[92:107], v[254:255], v[188:189], 0
    v_exp_f32 v76, v76
    v_exp_f32 v77, v77
    v_exp_f32 v78, v78
    v_exp_f32 v79, v79
    v_mfma_f32_32x32x16_bf16 v[92:107], v[200:203], v[172:175], v[92:107]
    v_add_u32 v3, s10, v1
    v_add_u32 v4, s7, v1
    v_exp_f32 v80, v80
    v_exp_f32 v81, v81
    v_exp_f32 v82, v82
    v_exp_f32 v83, v83
    v_smfmac_f32_32x32x32_bf16 v[140:155], v[216:219], v[68:75], v50
    buffer_load_dwordx4 v1, s[32:35], 0 offen offset:2048 sc1 lds
    buffer_load_dwordx4 v1, s[32:35], 0 offen offset:3072 sc1 lds
    v_exp_f32 v84, v84
    v_exp_f32 v85, v85
    v_exp_f32 v86, v86
    v_exp_f32 v87, v87
    v_smfmac_f32_32x32x32_bf16 v[156:171], v[212:215], v[76:83], v50
    s_addk_i32 m0, 4096
    v_exp_f32 v88, v88
    v_exp_f32 v89, v89
    v_exp_f32 v90, v90
    v_exp_f32 v91, v91
    v_mfma_f32_32x32x8_bf16 v[60:75], v[254:255], v[190:191], 0
    v_exp_f32 v92, v92
    v_exp_f32 v93, v93
    v_exp_f32 v94, v94
    v_exp_f32 v95, v95
    v_mfma_f32_32x32x16_bf16 v[60:75], v[200:203], v[176:179], v[60:75]
    v_add_u32 v38, s18, v38
    v_exp_f32 v96, v96
    v_exp_f32 v97, v97
    v_exp_f32 v98, v98
    v_exp_f32 v99, v99
    v_smfmac_f32_32x32x32_bf16 v[156:171], v[216:219], v[84:91], v50
    buffer_load_dwordx4 v2, s[32:35], 0 offen sc1 lds
    v_exp_f32 v100, v100
    v_exp_f32 v101, v101
    v_exp_f32 v102, v102
    v_exp_f32 v103, v103
    v_smfmac_f32_32x32x32_bf16 v[108:123], v[220:223], v[92:99], v50
    s_add_u32 s17, s17, 81920
    v_exp_f32 v104, v104
    v_exp_f32 v105, v105
    v_exp_f32 v106, v106
    v_exp_f32 v107, v107
    v_mfma_f32_32x32x8_bf16 v[76:91], v[254:255], v[192:193], 0
    v_exp_f32 v60, v60
    v_exp_f32 v61, v61
    v_exp_f32 v62, v62
    v_exp_f32 v63, v63
    v_mfma_f32_32x32x16_bf16 v[76:91], v[200:203], v[180:183], v[76:91]
    v_add_u32 v39, s18, v39
    v_exp_f32 v64, v64
    v_exp_f32 v65, v65
    v_exp_f32 v66, v66
    v_exp_f32 v67, v67
    v_smfmac_f32_32x32x32_bf16 v[108:123], v[224:227], v[100:107], v50
    buffer_load_dword v42, v57, s[68:71], s17 offen sc1
    buffer_load_dwordx4 v[196:199], v1, s[28:31], 0 offen sc1
    v_exp_f32 v68, v68
    v_exp_f32 v69, v69
    v_exp_f32 v70, v70
    v_exp_f32 v71, v71
    v_smfmac_f32_32x32x32_bf16 v[124:139], v[220:223], v[60:67], v50
    s_add_u32 s64, s64, 81920
    v_exp_f32 v72, v72
    v_exp_f32 v73, v73
    v_exp_f32 v74, v74
    v_exp_f32 v75, v75
    v_mfma_f32_32x32x8_bf16 v[92:107], v[254:255], v[194:195], 0
    v_exp_f32 v76, v76
    v_exp_f32 v77, v77
    v_exp_f32 v78, v78
    v_exp_f32 v79, v79
    v_mfma_f32_32x32x16_bf16 v[92:107], v[200:203], v[184:187], v[92:107]
    buffer_load_dwordx4 v[216:219], v1, s[64:67], 0 offen sc1
    buffer_load_dwordx4 v[212:215], v2, s[28:31], 0 offen sc1
    v_exp_f32 v80, v80
    v_exp_f32 v81, v81
    v_exp_f32 v82, v82
    v_exp_f32 v83, v83
    v_smfmac_f32_32x32x32_bf16 v[124:139], v[224:227], v[68:75], v50
    global_load_dword v44, v44, s[78:79]
    v_exp_f32 v84, v84
    v_exp_f32 v85, v85
    v_exp_f32 v86, v86
    v_exp_f32 v87, v87
    v_smfmac_f32_32x32x32_bf16 v[140:155], v[220:223], v[76:83], v50
    s_waitcnt vmcnt(19)
    s_add_u32 m0, s9, 20480
    v_exp_f32 v88, v88
    v_exp_f32 v89, v89
    v_exp_f32 v90, v90
    v_exp_f32 v91, v91
    v_mfma_f32_32x32x8_bf16 v[60:75], v[244:245], v[188:189], 0
    v_exp_f32 v92, v92
    v_exp_f32 v93, v93
    v_exp_f32 v94, v94
    v_exp_f32 v95, v95
    v_mfma_f32_32x32x16_bf16 v[60:75], v[204:207], v[172:175], v[60:75]
    s_add_u32 s32, s32, 163840
    v_exp_f32 v96, v96
    v_exp_f32 v97, v97
    v_exp_f32 v98, v98
    v_exp_f32 v99, v99
    v_smfmac_f32_32x32x32_bf16 v[140:155], v[224:227], v[84:91], v50
    buffer_load_dwordx4 v1, s[32:35], 0 offen sc1 lds
    buffer_load_dwordx4 v1, s[32:35], 0 offen offset:1024 sc1 lds
    v_exp_f32 v100, v100
    v_exp_f32 v101, v101
    v_exp_f32 v102, v102
    v_exp_f32 v103, v103
    v_smfmac_f32_32x32x32_bf16 v[156:171], v[220:223], v[92:99], v50
    buffer_load_dwordx4 v1, s[32:35], 0 offen offset:2048 sc1 lds
    buffer_load_dwordx4 v1, s[32:35], 0 offen offset:3072 sc1 lds
    v_exp_f32 v104, v104
    v_exp_f32 v105, v105
    v_exp_f32 v106, v106
    v_exp_f32 v107, v107
    v_mfma_f32_32x32x8_bf16 v[76:91], v[244:245], v[190:191], 0
    v_exp_f32 v60, v60
    v_exp_f32 v61, v61
    v_exp_f32 v62, v62
    v_exp_f32 v63, v63
    v_mfma_f32_32x32x16_bf16 v[76:91], v[204:207], v[176:179], v[76:91]
    s_add_u32 s17, s17, 81920
    v_exp_f32 v64, v64
    v_exp_f32 v65, v65
    v_exp_f32 v66, v66
    v_exp_f32 v67, v67
    v_smfmac_f32_32x32x32_bf16 v[156:171], v[224:227], v[100:107], v50
    buffer_load_dword v42, v57, s[68:71], s17 offen sc1
    buffer_load_dwordx4 v[200:203], v1, s[28:31], 0 offen offset:1024 sc1
    v_exp_f32 v68, v68
    v_exp_f32 v69, v69
    v_exp_f32 v70, v70
    v_exp_f32 v71, v71
    v_smfmac_f32_32x32x32_bf16 v[108:123], v[228:231], v[60:67], v50
    v_exp_f32 v72, v72
    v_exp_f32 v73, v73
    v_exp_f32 v74, v74
    v_exp_f32 v75, v75
    v_mfma_f32_32x32x8_bf16 v[92:107], v[244:245], v[192:193], 0
    v_exp_f32 v76, v76
    v_exp_f32 v77, v77
    v_exp_f32 v78, v78
    v_exp_f32 v79, v79
    v_mfma_f32_32x32x16_bf16 v[92:107], v[204:207], v[180:183], v[92:107]
    buffer_load_dwordx4 v[220:223], v1, s[64:67], 0 offen offset:1024 sc1
    buffer_load_dwordx4 v[224:227], v1, s[64:67], 0 offen offset:2048 sc1
    v_exp_f32 v80, v80
    v_exp_f32 v81, v81
    v_exp_f32 v82, v82
    v_exp_f32 v83, v83
    v_smfmac_f32_32x32x32_bf16 v[108:123], v[232:235], v[68:75], v50
    s_addk_i32 m0, 4096
    v_exp_f32 v84, v84
    v_exp_f32 v85, v85
    v_exp_f32 v86, v86
    v_exp_f32 v87, v87
    v_smfmac_f32_32x32x32_bf16 v[124:139], v[228:231], v[76:83], v50
    v_exp_f32 v88, v88
    v_exp_f32 v89, v89
    v_exp_f32 v90, v90
    v_exp_f32 v91, v91
    v_mfma_f32_32x32x8_bf16 v[60:75], v[244:245], v[194:195], 0
    v_exp_f32 v92, v92
    v_exp_f32 v93, v93
    v_exp_f32 v94, v94
    v_exp_f32 v95, v95
    v_mfma_f32_32x32x16_bf16 v[60:75], v[204:207], v[184:187], v[60:75]
L_wp5:
    s_cbranch_execz L_wret0
    buffer_load_dwordx4 v2, s[32:35], 0 offen sc1 lds
    v_exp_f32 v96, v96
    v_exp_f32 v97, v97
    v_exp_f32 v98, v98
    v_exp_f32 v99, v99
    v_smfmac_f32_32x32x32_bf16 v[124:139], v[232:235], v[84:91], v50
    v_exp_f32 v100, v100
    v_exp_f32 v101, v101
    v_exp_f32 v102, v102
    v_exp_f32 v103, v103
    v_smfmac_f32_32x32x32_bf16 v[140:155], v[228:231], v[92:99], v50
    s_waitcnt vmcnt(20)
    v_exp_f32 v104, v104
    v_exp_f32 v105, v105
    v_exp_f32 v106, v106
    v_exp_f32 v107, v107
    v_mfma_f32_32x32x8_bf16 v[76:91], v[246:247], v[188:189], 0
    v_exp_f32 v60, v60
    v_exp_f32 v61, v61
    v_exp_f32 v62, v62
    v_exp_f32 v63, v63
    v_mfma_f32_32x32x16_bf16 v[76:91], v[208:211], v[172:175], v[76:91]
    v_exp_f32 v64, v64
    v_exp_f32 v65, v65
    v_exp_f32 v66, v66
    v_exp_f32 v67, v67
    v_smfmac_f32_32x32x32_bf16 v[140:155], v[232:235], v[100:107], v50
    v_exp_f32 v68, v68
    v_exp_f32 v69, v69
    v_exp_f32 v70, v70
    v_exp_f32 v71, v71
    v_smfmac_f32_32x32x32_bf16 v[156:171], v[228:231], v[60:67], v50
    v_exp_f32 v72, v72
    v_exp_f32 v73, v73
    v_exp_f32 v74, v74
    v_exp_f32 v75, v75
    v_mfma_f32_32x32x8_bf16 v[92:107], v[246:247], v[190:191], 0
    v_exp_f32 v76, v76
    v_exp_f32 v77, v77
    v_exp_f32 v78, v78
    v_exp_f32 v79, v79
    v_mfma_f32_32x32x16_bf16 v[92:107], v[208:211], v[176:179], v[92:107]
    buffer_load_dwordx4 v[204:207], v1, s[28:31], 0 offen offset:2048 sc1
    v_exp_f32 v80, v80
    v_exp_f32 v81, v81
    v_exp_f32 v82, v82
    v_exp_f32 v83, v83
    v_smfmac_f32_32x32x32_bf16 v[156:171], v[232:235], v[68:75], v50
    buffer_load_dwordx4 v[228:231], v1, s[64:67], 0 offen offset:3072 sc1
    v_exp_f32 v84, v84
    v_exp_f32 v85, v85
    v_exp_f32 v86, v86
    v_exp_f32 v87, v87
    v_smfmac_f32_32x32x32_bf16 v[108:123], v[236:239], v[76:83], v50
    v_exp_f32 v88, v88
    v_exp_f32 v89, v89
    v_exp_f32 v90, v90
    v_exp_f32 v91, v91
    v_mfma_f32_32x32x8_bf16 v[60:75], v[246:247], v[192:193], 0
    v_exp_f32 v92, v92
    v_exp_f32 v93, v93
    v_exp_f32 v94, v94
    v_exp_f32 v95, v95
    v_mfma_f32_32x32x16_bf16 v[60:75], v[208:211], v[180:183], v[60:75]
    buffer_load_dwordx4 v[232:235], v2, s[64:67], 0 offen sc1
    v_exp_f32 v96, v96
    v_exp_f32 v97, v97
    v_exp_f32 v98, v98
    v_exp_f32 v99, v99
    v_smfmac_f32_32x32x32_bf16 v[108:123], v[240:243], v[84:91], v50
    v_exp_f32 v100, v100
    v_exp_f32 v101, v101
    v_exp_f32 v102, v102
    v_exp_f32 v103, v103
    v_smfmac_f32_32x32x32_bf16 v[124:139], v[236:239], v[92:99], v50
    v_exp_f32 v104, v104
    v_exp_f32 v105, v105
    v_exp_f32 v106, v106
    v_exp_f32 v107, v107
    v_mfma_f32_32x32x8_bf16 v[76:91], v[246:247], v[194:195], 0
    v_exp_f32 v60, v60
    v_exp_f32 v61, v61
    v_exp_f32 v62, v62
    v_exp_f32 v63, v63
    v_mfma_f32_32x32x16_bf16 v[76:91], v[208:211], v[184:187], v[76:91]
    ds_write_b128 v3, v[108:111] offset:5120
    v_exp_f32 v64, v64
    v_exp_f32 v65, v65
    v_exp_f32 v66, v66
    v_exp_f32 v67, v67
    v_smfmac_f32_32x32x32_bf16 v[124:139], v[240:243], v[100:107], v50
    ds_write_b128 v3, v[112:115] offset:6144
    v_exp_f32 v68, v68
    v_exp_f32 v69, v69
    v_exp_f32 v70, v70
    v_exp_f32 v71, v71
    v_smfmac_f32_32x32x32_bf16 v[140:155], v[236:239], v[60:67], v50
    ds_write_b128 v3, v[116:119] offset:7168
    v_exp_f32 v72, v72
    v_exp_f32 v73, v73
    v_exp_f32 v74, v74
    v_exp_f32 v75, v75
    v_exp_f32 v76, v76
    v_exp_f32 v77, v77
    v_exp_f32 v78, v78
    v_exp_f32 v79, v79
    buffer_load_dwordx4 v[208:211], v1, s[28:31], 0 offen offset:3072 sc1
    ds_write_b128 v3, v[124:127] offset:8192
    v_exp_f32 v80, v80
    v_exp_f32 v81, v81
    v_exp_f32 v82, v82
    v_exp_f32 v83, v83
    v_smfmac_f32_32x32x32_bf16 v[140:155], v[240:243], v[68:75], v50
    ds_write_b128 v3, v[128:131] offset:9216
    v_exp_f32 v84, v84
    v_exp_f32 v85, v85
    v_exp_f32 v86, v86
    v_exp_f32 v87, v87
    v_smfmac_f32_32x32x32_bf16 v[156:171], v[236:239], v[76:83], v50
    ds_write_b128 v3, v[132:135] offset:10240
    v_exp_f32 v88, v88
    v_exp_f32 v89, v89
    v_exp_f32 v90, v90
    v_exp_f32 v91, v91
    s_waitcnt vmcnt(4) lgkmcnt(0)
    s_barrier
    v_smfmac_f32_32x32x32_bf16 v[156:171], v[240:243], v[84:91], v50
    ds_read_b128 v[180:183], v4 offset:7168
    ds_read_b128 v[172:175], v4 offset:5120
    ds_read_b128 v[176:179], v4 offset:6144
    ds_read_b128 v[192:195], v4 offset:10240
    ds_read_b128 v[184:187], v4 offset:8192
    ds_read_b128 v[188:191], v4 offset:9216
    v_mfma_f32_16x16x32_bf16 v[44:47], a[0:3], v[12:15], 0
    v_mfma_f32_16x16x32_bf16 v[44:47], a[12:15], v[12:15], v[44:47]
    v_mfma_f32_16x16x32_bf16 v[44:47], a[24:27], v[12:15], v[44:47]
    s_waitcnt lgkmcnt(3)
    v_pk_add_f32 v[148:149], v[148:149], v[180:181]
    v_pk_add_f32 v[150:151], v[150:151], v[182:183]
    v_mov_b32 v152, v148
    v_pk_add_f32 v[140:141], v[140:141], v[172:173]
    v_pk_add_f32 v[142:143], v[142:143], v[174:175]
    v_permlane32_swap_b32 v148, v152
    v_pk_add_f32 v[144:145], v[144:145], v[176:177]
    v_rcp_f32 v152, v152
    v_pk_add_f32 v[146:147], v[146:147], v[178:179]
    v_pk_mul_f32 v[140:141], v[140:141], v[152:153] op_sel_hi:[1,0]
    v_pk_mul_f32 v[142:143], v[142:143], v[152:153] op_sel_hi:[1,0]
    v_cvt_pk_bf16_f32 v140, v140, v141
    v_cvt_pk_bf16_f32 v141, v142, v143
    buffer_store_dwordx2 v[140:141], v38, s[48:51], 0 offen nt
    v_pk_mul_f32 v[144:145], v[144:145], v[152:153] op_sel_hi:[1,0]
    v_pk_mul_f32 v[146:147], v[146:147], v[152:153] op_sel_hi:[1,0]
    v_cvt_pk_bf16_f32 v144, v144, v145
    v_cvt_pk_bf16_f32 v145, v146, v147
    buffer_store_dwordx2 v[144:145], v38, s[48:51], 0 offen offset:256 nt
    v_pk_mul_f32 v[148:149], v[148:149], v[152:153] op_sel_hi:[1,0]
    v_pk_mul_f32 v[150:151], v[150:151], v[152:153] op_sel_hi:[1,0]
    v_cvt_pk_bf16_f32 v148, v148, v149
    v_cvt_pk_bf16_f32 v149, v150, v151
    s_mov_b32 exec_hi, 0
    buffer_store_dwordx2 v[148:149], v38, s[48:51], 0 offen offset:512 nt
    s_mov_b32 exec_hi, -1
    s_waitcnt lgkmcnt(0)
    v_pk_add_f32 v[164:165], v[164:165], v[192:193]
    v_pk_add_f32 v[166:167], v[166:167], v[194:195]
    v_mov_b32 v168, v164
    v_pk_add_f32 v[156:157], v[156:157], v[184:185]
    v_pk_add_f32 v[158:159], v[158:159], v[186:187]
    v_permlane32_swap_b32 v164, v168
    v_pk_add_f32 v[160:161], v[160:161], v[188:189]
    v_rcp_f32 v168, v168
    v_pk_add_f32 v[162:163], v[162:163], v[190:191]
    v_pk_mul_f32 v[156:157], v[156:157], v[168:169] op_sel_hi:[1,0]
    v_pk_mul_f32 v[158:159], v[158:159], v[168:169] op_sel_hi:[1,0]
    v_cvt_pk_bf16_f32 v156, v156, v157
    v_cvt_pk_bf16_f32 v157, v158, v159
    buffer_store_dwordx2 v[156:157], v39, s[48:51], 0 offen offset:520 nt
    v_pk_mul_f32 v[160:161], v[160:161], v[168:169] op_sel_hi:[1,0]
    v_pk_mul_f32 v[162:163], v[162:163], v[168:169] op_sel_hi:[1,0]
    v_cvt_pk_bf16_f32 v160, v160, v161
    v_cvt_pk_bf16_f32 v161, v162, v163
    buffer_store_dwordx2 v[160:161], v39, s[48:51], 0 offen offset:776 nt
    v_pk_mul_f32 v[164:165], v[164:165], v[168:169] op_sel_hi:[1,0]
    v_pk_mul_f32 v[166:167], v[166:167], v[168:169] op_sel_hi:[1,0]
    v_cvt_pk_bf16_f32 v164, v164, v165
    v_cvt_pk_bf16_f32 v165, v166, v167
    s_mov_b32 exec_hi, 0
    buffer_store_dwordx2 v[164:165], v39, s[48:51], 0 offen offset:1032 nt
    s_mov_b32 exec_hi, -1
    v_mfma_f32_16x16x32_bf16 v[44:47], a[36:39], v[12:15], v[44:47]
    s_add_u32 s79, s6, 8192
    v_mfma_f32_16x16x32_bf16 v[44:47], a[48:51], v[12:15], v[44:47]
    s_add_u32 s36, s48, s79
    s_addc_u32 s37, s49, 0
    v_mfma_f32_16x16x32_bf16 v[44:47], a[60:63], v[12:15], v[44:47]
    s_mov_b32 s38, 8192
    v_add_u32 v56, 102400, v1
    v_mfma_f32_16x16x32_bf16 v[44:47], a[72:75], v[12:15], v[44:47]
    s_lshl_b32 s76, 0x55555555, s4
    v_mfma_f32_16x16x32_bf16 v[44:47], a[84:87], v[12:15], v[44:47]
    s_cmp_eq_u32 s58, 0
    s_cselect_b32 s86, s76, 0
    s_cselect_b32 s87, 0, s76
    v_mfma_f32_16x16x32_bf16 v[44:47], a[96:99], v[12:15], v[44:47]
    s_mul_i32 s77, s57, 2560
    v_mfma_f32_16x16x32_bf16 v[44:47], a[108:111], v[12:15], v[44:47]
    s_add_u32 s77, s6, s77
    s_add_u32 s28, s52, s77
    s_addc_u32 s29, s53, 0
    v_mfma_f32_16x16x32_bf16 v[44:47], a[120:123], v[12:15], v[44:47]
    s_mov_b32 s30, 20480
    v_mfma_f32_16x16x32_bf16 v[44:47], a[132:135], v[12:15], v[44:47]
    v_lshrrev_b32 v59, 1, v17
    v_mfma_f32_16x16x32_bf16 v[44:47], a[144:147], v[12:15], v[44:47]
    v_lshlrev_b32 v57, 4, v16
    v_mfma_f32_16x16x32_bf16 v[44:47], a[156:159], v[12:15], v[44:47]
    v_lshl_add_u32 v57, v59, 8, v57
    v_mfma_f32_16x16x32_bf16 v[44:47], a[168:171], v[12:15], v[44:47]
    v_and_b32 v59, 1, v17
    v_mfma_f32_16x16x32_bf16 v[44:47], a[180:183], v[12:15], v[44:47]
    v_lshl_add_u32 v57, v59, 3, v57
    v_mfma_f32_16x16x32_bf16 v[44:47], a[192:195], v[12:15], v[44:47]
    v_lshlrev_b32 v58, 4, v16
    v_mfma_f32_16x16x32_bf16 v[44:47], a[204:207], v[12:15], v[44:47]
    s_lshl_b32 s78, s58, 2
    s_add_u32 s78, s78, s56
    v_mfma_f32_16x16x32_bf16 v[44:47], a[216:219], v[12:15], v[44:47]
    s_lshl_b32 s78, s78, 3
    s_add_u32 s78, s78, s57
    v_mfma_f32_16x16x32_bf16 v[44:47], a[228:231], v[12:15], v[44:47]
    s_lshl_b32 s78, s78, 7
    s_and_b32 s75, s57, 1
    v_mfma_f32_16x16x32_bf16 v[48:51], a[4:7], v[12:15], 0
    s_mulk_i32 s75, 120
    s_sub_u32 s78, s78, s75
    v_mfma_f32_16x16x32_bf16 v[48:51], a[16:19], v[12:15], v[48:51]
    v_mfma_f32_16x16x32_bf16 v[48:51], a[28:31], v[12:15], v[48:51]
    v_mfma_f32_16x16x32_bf16 v[48:51], a[40:43], v[12:15], v[48:51]
    v_add_u32 v10, 1, v10
    v_mfma_f32_16x16x32_bf16 v[48:51], a[52:55], v[12:15], v[48:51]
    s_cmp_lg_u32 s62, 0
    s_waitcnt vmcnt(0)
    s_cbranch_scc1 L_slow0
    buffer_store_dword v10, v9, s[48:51], 0 offen
L_sigd0:
    v_mfma_f32_16x16x32_bf16 v[48:51], a[64:67], v[12:15], v[48:51]
    ds_read_b128 v[164:167], v56
    v_lshlrev_b32 v144, 16, v28
    v_mfma_f32_16x16x32_bf16 v[48:51], a[76:79], v[12:15], v[48:51]
    v_and_b32 v145, 0xffff0000, v28
    v_mfma_f32_16x16x32_bf16 v[48:51], a[88:91], v[12:15], v[48:51]
    ds_read_b128 v[168:171], v56 offset:5120
    v_lshlrev_b32 v146, 16, v29
    v_mfma_f32_16x16x32_bf16 v[48:51], a[100:103], v[12:15], v[48:51]
    v_and_b32 v147, 0xffff0000, v29
    v_mfma_f32_16x16x32_bf16 v[48:51], a[112:115], v[12:15], v[48:51]
    v_lshlrev_b32 v148, 16, v30
    v_and_b32 v149, 0xffff0000, v30
    v_mfma_f32_16x16x32_bf16 v[48:51], a[124:127], v[12:15], v[48:51]
    ds_read_b128 v[172:175], v56 offset:6144
    v_lshlrev_b32 v150, 16, v31
    v_mfma_f32_16x16x32_bf16 v[48:51], a[136:139], v[12:15], v[48:51]
    ds_read_b128 v[176:179], v56 offset:1024
    v_and_b32 v151, 0xffff0000, v31
    v_mfma_f32_16x16x32_bf16 v[48:51], a[148:151], v[12:15], v[48:51]
    v_lshlrev_b32 v152, 16, v32
    v_and_b32 v153, 0xffff0000, v32
    v_mfma_f32_16x16x32_bf16 v[48:51], a[160:163], v[12:15], v[48:51]
    ds_read_b128 v[180:183], v56 offset:2048
    v_lshlrev_b32 v154, 16, v33
    v_mfma_f32_16x16x32_bf16 v[48:51], a[172:175], v[12:15], v[48:51]
    ds_read_b128 v[184:187], v56 offset:7168
    v_and_b32 v155, 0xffff0000, v33
    v_mfma_f32_16x16x32_bf16 v[48:51], a[184:187], v[12:15], v[48:51]
    v_lshlrev_b32 v156, 16, v34
    v_and_b32 v157, 0xffff0000, v34
    v_mfma_f32_16x16x32_bf16 v[48:51], a[196:199], v[12:15], v[48:51]
    ds_read_b128 v[188:191], v56 offset:8192
    v_lshlrev_b32 v158, 16, v35
    v_mfma_f32_16x16x32_bf16 v[48:51], a[208:211], v[12:15], v[48:51]
    buffer_load_dword v59, v11, s[48:51], 0 offen sc1
    v_and_b32 v159, 0xffff0000, v35
    v_mfma_f32_16x16x32_bf16 v[48:51], a[220:223], v[12:15], v[48:51]
    ds_read_b128 v[192:195], v56 offset:3072
    v_lshlrev_b32 v160, 16, v36
    v_mfma_f32_16x16x32_bf16 v[48:51], a[232:235], v[12:15], v[48:51]
    v_and_b32 v161, 0xffff0000, v36
    v_lshlrev_b32 v162, 16, v37
    v_mfma_f32_16x16x32_bf16 v[52:55], a[8:11], v[12:15], 0
    ds_read_b128 a[240:243], v56 offset:4096
    v_and_b32 v163, 0xffff0000, v37
    v_mfma_f32_16x16x32_bf16 v[52:55], a[20:23], v[12:15], v[52:55]
    ds_read_b128 a[244:247], v56 offset:9216
    v_mfma_f32_16x16x32_bf16 v[52:55], a[32:35], v[12:15], v[52:55]
    s_mov_b64 exec, 0
    s_cmp_eq_u32 s56, 0
    s_cbranch_scc1 L_wp6
    s_cmp_eq_u32 s56, 1
    s_cbranch_scc1 L_wp7
    s_cmp_eq_u32 s56, 2
    s_cbranch_scc1 L_wp8
    s_cmp_eq_u32 s56, 3
    s_cbranch_scc1 L_wp9
L_wret1:
    s_mov_b64 exec, -1
    s_waitcnt vmcnt(0)
    v_subrev_u32 v59, s60, v59
    v_cmp_gt_u32 vcc, 1, v59
    s_nop 0
    s_and_b64 vcc, vcc, s[86:87]
    s_or_b64 vcc, vcc, s[62:63]
    s_cbranch_scc1 L_late0
L_go0:
    buffer_load_dwordx4 v[64:67], v1, s[36:39], 0 offen sc1
    buffer_load_dwordx4 v[68:71], v1, s[36:39], 0 offen offset:1024 sc1
    buffer_load_dwordx4 v[72:75], v1, s[36:39], 0 offen offset:2048 sc1
    buffer_load_dwordx4 v[76:79], v1, s[36:39], 0 offen offset:3072 sc1
    buffer_load_dwordx4 v[80:83], v2, s[36:39], 0 offen sc1
    buffer_load_dwordx4 v[84:87], v2, s[36:39], 0 offen offset:1024 sc1
    buffer_load_dwordx4 v[88:91], v2, s[36:39], 0 offen offset:2048 sc1
    buffer_load_dwordx4 v[92:95], v2, s[36:39], 0 offen offset:3072 sc1
    s_waitcnt vmcnt(6) lgkmcnt(5)
    v_mfma_f32_16x16x32_bf16 v[144:147], v[164:167], v[64:67], v[144:147]
    s_add_u32 s36, s36, 8192
    ds_read_b128 a[248:251], v56 offset:14336
    v_mov_b32 v38, 0
    v_mfma_f32_16x16x32_bf16 v[144:147], v[168:171], v[68:71], v[144:147]
    ds_read_b128 a[252:255], v56 offset:19456
    v_mfma_f32_16x16x32_bf16 v[148:151], v[172:175], v[68:71], v[148:151]
    ds_read_b128 v[164:167], v56 offset:18432
    buffer_load_dwordx4 v[96:99], v1, s[36:39], 0 offen sc1
    v_mfma_f32_16x16x32_bf16 v[148:151], v[176:179], v[64:67], v[148:151]
    ds_read_b128 v[168:171], v56 offset:13312
    v_mfma_f32_16x16x32_bf16 v[152:155], v[180:183], v[64:67], v[152:155]
    s_waitcnt lgkmcnt(4)
    ds_read_b128 v[172:175], v56 offset:12288
    v_mfma_f32_16x16x32_bf16 v[152:155], v[184:187], v[68:71], v[152:155]
    ds_read_b128 v[176:179], v56 offset:17408
    v_mov_b32 v39, 0
    v_mfma_f32_16x16x32_bf16 v[156:159], v[188:191], v[68:71], v[156:159]
    ds_read_b128 v[180:183], v56 offset:16384
    buffer_load_dwordx4 v[100:103], v1, s[36:39], 0 offen offset:1024 sc1
    v_mfma_f32_16x16x32_bf16 v[156:159], v[192:195], v[64:67], v[156:159]
    ds_read_b128 v[184:187], v56 offset:11264
    v_mfma_f32_16x16x32_bf16 v[160:163], a[240:243], v[64:67], v[160:163]
    ds_read_b128 v[188:191], v56 offset:10240
    v_mfma_f32_16x16x32_bf16 v[160:163], a[244:247], v[68:71], v[160:163]
    s_waitcnt vmcnt(6) lgkmcnt(4)
    ds_read_b128 v[192:195], v56 offset:15360
    v_mfma_f32_16x16x32_bf16 v[160:163], a[248:251], v[72:75], v[160:163]
    ds_read_b128 a[240:243], v56 offset:20480
    buffer_load_dwordx4 v[104:107], v1, s[36:39], 0 offen offset:2048 sc1
    v_mfma_f32_16x16x32_bf16 v[160:163], a[252:255], v[76:79], v[160:163]
    ds_read_b128 a[244:247], v56 offset:25600
    v_mfma_f32_16x16x32_bf16 v[156:159], v[164:167], v[76:79], v[156:159]
    ds_read_b128 a[248:251], v56 offset:26624
    v_mfma_f32_16x16x32_bf16 v[156:159], v[168:171], v[72:75], v[156:159]
    ds_read_b128 a[252:255], v56 offset:21504
    v_mfma_f32_16x16x32_bf16 v[152:155], v[172:175], v[72:75], v[152:155]
    s_waitcnt lgkmcnt(4)
    ds_read_b128 v[164:167], v56 offset:22528
    buffer_load_dwordx4 v[108:111], v1, s[36:39], 0 offen offset:3072 sc1
    v_mfma_f32_16x16x32_bf16 v[152:155], v[176:179], v[76:79], v[152:155]
    ds_read_b128 v[168:171], v56 offset:27648
    v_mfma_f32_16x16x32_bf16 v[148:151], v[180:183], v[76:79], v[148:151]
    ds_read_b128 v[172:175], v56 offset:28672
    v_mfma_f32_16x16x32_bf16 v[148:151], v[184:187], v[72:75], v[148:151]
    ds_read_b128 v[176:179], v56 offset:23552
    v_mfma_f32_16x16x32_bf16 v[144:147], v[188:191], v[72:75], v[144:147]
    ds_read_b128 v[180:183], v56 offset:24576
    buffer_load_dwordx4 v[112:115], v2, s[36:39], 0 offen sc1
    v_mfma_f32_16x16x32_bf16 v[144:147], v[192:195], v[76:79], v[144:147]
    s_waitcnt vmcnt(7) lgkmcnt(4)
    ds_read_b128 v[184:187], v56 offset:29696
    v_mfma_f32_16x16x32_bf16 v[144:147], a[240:243], v[80:83], v[144:147]
    ds_read_b128 v[188:191], v56 offset:34816
    v_mfma_f32_16x16x32_bf16 v[144:147], a[244:247], v[84:87], v[144:147]
    ds_read_b128 v[192:195], v56 offset:39936
    v_mfma_f32_16x16x32_bf16 v[148:151], a[248:251], v[84:87], v[148:151]
    ds_read_b128 a[240:243], v56 offset:38912
    buffer_load_dwordx4 v[116:119], v2, s[36:39], 0 offen offset:1024 sc1
    v_mfma_f32_16x16x32_bf16 v[148:151], a[252:255], v[80:83], v[148:151]
    ds_read_b128 a[244:247], v56 offset:33792
    v_mfma_f32_16x16x32_bf16 v[152:155], v[164:167], v[80:83], v[152:155]
    s_waitcnt lgkmcnt(4)
    ds_read_b128 a[248:251], v56 offset:32768
    v_mfma_f32_16x16x32_bf16 v[152:155], v[168:171], v[84:87], v[152:155]
    ds_read_b128 a[252:255], v56 offset:37888
    v_mfma_f32_16x16x32_bf16 v[156:159], v[172:175], v[84:87], v[156:159]
    ds_read_b128 v[164:167], v56 offset:36864
    buffer_load_dwordx4 v[120:123], v2, s[36:39], 0 offen offset:2048 sc1
    v_mfma_f32_16x16x32_bf16 v[156:159], v[176:179], v[80:83], v[156:159]
    ds_read_b128 v[168:171], v56 offset:31744
    v_mfma_f32_16x16x32_bf16 v[160:163], v[180:183], v[80:83], v[160:163]
    ds_read_b128 v[172:175], v56 offset:30720
    v_mfma_f32_16x16x32_bf16 v[160:163], v[184:187], v[84:87], v[160:163]
    s_waitcnt vmcnt(7) lgkmcnt(4)
    ds_read_b128 v[176:179], v56 offset:35840
    v_mfma_f32_16x16x32_bf16 v[160:163], v[188:191], v[88:91], v[160:163]
    ds_read_b128 v[180:183], v56 offset:40960
    buffer_load_dwordx4 v[124:127], v2, s[36:39], 0 offen offset:3072 sc1
    v_mfma_f32_16x16x32_bf16 v[160:163], v[192:195], v[92:95], v[160:163]
    ds_read_b128 v[184:187], v56 offset:46080
    v_mfma_f32_16x16x32_bf16 v[156:159], a[240:243], v[92:95], v[156:159]
    s_add_u32 s36, s36, 8192
    ds_read_b128 v[188:191], v56 offset:47104
    v_mfma_f32_16x16x32_bf16 v[156:159], a[244:247], v[88:91], v[156:159]
    ds_read_b128 v[192:195], v56 offset:41984
    v_mfma_f32_16x16x32_bf16 v[152:155], a[248:251], v[88:91], v[152:155]
    s_waitcnt lgkmcnt(4)
    ds_read_b128 a[240:243], v56 offset:43008
    buffer_load_dwordx4 v[128:131], v1, s[36:39], 0 offen sc1
    v_mfma_f32_16x16x32_bf16 v[152:155], a[252:255], v[92:95], v[152:155]
    ds_read_b128 a[244:247], v56 offset:48128
    v_mfma_f32_16x16x32_bf16 v[148:151], v[164:167], v[92:95], v[148:151]
    ds_read_b128 a[248:251], v56 offset:49152
    v_mfma_f32_16x16x32_bf16 v[148:151], v[168:171], v[88:91], v[148:151]
    ds_read_b128 a[252:255], v56 offset:44032
    v_mfma_f32_16x16x32_bf16 v[144:147], v[172:175], v[88:91], v[144:147]
    ds_read_b128 v[164:167], v56 offset:45056
    buffer_load_dwordx4 v[132:135], v1, s[36:39], 0 offen offset:1024 sc1
    v_mfma_f32_16x16x32_bf16 v[144:147], v[176:179], v[92:95], v[144:147]
    s_waitcnt vmcnt(8) lgkmcnt(4)
    ds_read_b128 v[168:171], v56 offset:50176
    v_mfma_f32_16x16x32_bf16 v[144:147], v[180:183], v[96:99], v[144:147]
    ds_read_b128 v[172:175], v56 offset:55296
    v_mfma_f32_16x16x32_bf16 v[144:147], v[184:187], v[100:103], v[144:147]
    ds_read_b128 v[176:179], v56 offset:60416
    v_mfma_f32_16x16x32_bf16 v[148:151], v[188:191], v[100:103], v[148:151]
    ds_read_b128 v[180:183], v56 offset:59392
    buffer_load_dwordx4 v[136:139], v1, s[36:39], 0 offen offset:2048 sc1
    v_mfma_f32_16x16x32_bf16 v[148:151], v[192:195], v[96:99], v[148:151]
    ds_read_b128 v[184:187], v56 offset:54272
    v_mfma_f32_16x16x32_bf16 v[152:155], a[240:243], v[96:99], v[152:155]
    s_waitcnt lgkmcnt(4)
    ds_read_b128 v[188:191], v56 offset:53248
    v_mfma_f32_16x16x32_bf16 v[152:155], a[244:247], v[100:103], v[152:155]
    ds_read_b128 v[192:195], v56 offset:58368
    v_mfma_f32_16x16x32_bf16 v[156:159], a[248:251], v[100:103], v[156:159]
    ds_read_b128 a[240:243], v56 offset:57344
    buffer_load_dwordx4 v[140:143], v1, s[36:39], 0 offen offset:3072 sc1
    v_mfma_f32_16x16x32_bf16 v[156:159], a[252:255], v[96:99], v[156:159]
    s_add_u32 m0, s7, 5120
    ds_read_b128 a[244:247], v56 offset:52224
    v_mfma_f32_16x16x32_bf16 v[160:163], v[164:167], v[96:99], v[160:163]
    s_sub_u32 s64, s64, 122880
    ds_read_b128 a[248:251], v56 offset:51200
    v_mfma_f32_16x16x32_bf16 v[160:163], v[168:171], v[100:103], v[160:163]
    s_waitcnt vmcnt(8) lgkmcnt(4)
    ds_read_b128 a[252:255], v56 offset:56320
    v_mfma_f32_16x16x32_bf16 v[160:163], v[172:175], v[104:107], v[160:163]
    ds_read_b128 v[164:167], v1
    buffer_load_dwordx4 v1, s[64:67], 0 offen sc1 lds
    v_mfma_f32_16x16x32_bf16 v[160:163], v[176:179], v[108:111], v[160:163]
    ds_read_b128 v[168:171], v1 offset:5120
    v_mfma_f32_16x16x32_bf16 v[156:159], v[180:183], v[108:111], v[156:159]
    ds_read_b128 v[172:175], v1 offset:6144
    v_mfma_f32_16x16x32_bf16 v[156:159], v[184:187], v[104:107], v[156:159]
    ds_read_b128 v[176:179], v1 offset:1024
    v_mfma_f32_16x16x32_bf16 v[152:155], v[188:191], v[104:107], v[152:155]
    s_waitcnt lgkmcnt(4)
    ds_read_b128 v[180:183], v1 offset:2048
    buffer_load_dwordx4 v1, s[64:67], 0 offen offset:1024 sc1 lds
    v_mfma_f32_16x16x32_bf16 v[152:155], v[192:195], v[108:111], v[152:155]
    ds_read_b128 v[184:187], v1 offset:7168
    v_mfma_f32_16x16x32_bf16 v[148:151], a[240:243], v[108:111], v[148:151]
    ds_read_b128 v[188:191], v1 offset:8192
    v_mfma_f32_16x16x32_bf16 v[148:151], a[244:247], v[104:107], v[148:151]
    ds_read_b128 v[192:195], v1 offset:3072
    v_mfma_f32_16x16x32_bf16 v[144:147], a[248:251], v[104:107], v[144:147]
    ds_read_b128 a[240:243], v1 offset:4096
    buffer_load_dwordx4 v1, s[64:67], 0 offen offset:2048 sc1 lds
    v_mfma_f32_16x16x32_bf16 v[144:147], a[252:255], v[108:111], v[144:147]
    s_waitcnt vmcnt(9) lgkmcnt(4)
    ds_read_b128 a[244:247], v1 offset:9216
    v_mfma_f32_16x16x32_bf16 v[144:147], v[164:167], v[112:115], v[144:147]
    ds_read_b128 a[248:251], v1 offset:14336
    v_mfma_f32_16x16x32_bf16 v[144:147], v[168:171], v[116:119], v[144:147]
    ds_read_b128 a[252:255], v1 offset:19456
    v_mfma_f32_16x16x32_bf16 v[148:151], v[172:175], v[116:119], v[148:151]
    ds_read_b128 v[164:167], v1 offset:18432
    buffer_load_dwordx4 v1, s[64:67], 0 offen offset:3072 sc1 lds
    v_mfma_f32_16x16x32_bf16 v[148:151], v[176:179], v[112:115], v[148:151]
    ds_read_b128 v[168:171], v1 offset:13312
    v_mfma_f32_16x16x32_bf16 v[152:155], v[180:183], v[112:115], v[152:155]
    s_waitcnt lgkmcnt(4)
    s_addk_i32 m0, 4096
    ds_read_b128 v[172:175], v1 offset:12288
    v_mfma_f32_16x16x32_bf16 v[152:155], v[184:187], v[116:119], v[152:155]
    ds_read_b128 v[176:179], v1 offset:17408
    v_mfma_f32_16x16x32_bf16 v[156:159], v[188:191], v[116:119], v[156:159]
    ds_read_b128 v[180:183], v1 offset:16384
    buffer_load_dwordx4 v2, s[64:67], 0 offen sc1 lds
    v_mfma_f32_16x16x32_bf16 v[156:159], v[192:195], v[112:115], v[156:159]
    s_add_u32 m0, s7, 10240
    ds_read_b128 v[184:187], v1 offset:11264
    v_mfma_f32_16x16x32_bf16 v[160:163], a[240:243], v[112:115], v[160:163]
    s_add_u32 s64, s64, 40960
    ds_read_b128 v[188:191], v1 offset:10240
    v_mfma_f32_16x16x32_bf16 v[160:163], a[244:247], v[116:119], v[160:163]
    s_waitcnt vmcnt(9) lgkmcnt(4)
    ds_read_b128 v[192:195], v1 offset:15360
    v_mfma_f32_16x16x32_bf16 v[160:163], a[248:251], v[120:123], v[160:163]
    ds_read_b128 a[240:243], v1 offset:20480
    buffer_load_dwordx4 v1, s[64:67], 0 offen sc1 lds
    v_mfma_f32_16x16x32_bf16 v[160:163], a[252:255], v[124:127], v[160:163]
    ds_read_b128 a[244:247], v1 offset:25600
    v_mfma_f32_16x16x32_bf16 v[156:159], v[164:167], v[124:127], v[156:159]
    s_add_u32 s64, s64, 40960
    ds_read_b128 a[248:251], v1 offset:30720
    v_mfma_f32_16x16x32_bf16 v[156:159], v[168:171], v[120:123], v[156:159]
    ds_read_b128 a[252:255], v1 offset:35840
    v_mfma_f32_16x16x32_bf16 v[152:155], v[172:175], v[120:123], v[152:155]
    s_waitcnt lgkmcnt(4)
    ds_read_b128 v[164:167], v1 offset:36864
    buffer_load_dwordx4 v[236:239], v1, s[64:67], 0 offen sc1
    v_mfma_f32_16x16x32_bf16 v[152:155], v[176:179], v[124:127], v[152:155]
    ds_read_b128 v[168:171], v1 offset:31744
    v_mfma_f32_16x16x32_bf16 v[148:151], v[180:183], v[124:127], v[148:151]
    ds_read_b128 v[172:175], v1 offset:26624
    v_mfma_f32_16x16x32_bf16 v[148:151], v[184:187], v[120:123], v[148:151]
    ds_read_b128 v[176:179], v1 offset:21504
    v_mfma_f32_16x16x32_bf16 v[144:147], v[188:191], v[120:123], v[144:147]
    ds_read_b128 v[180:183], v1 offset:22528
    buffer_load_dwordx4 v[240:243], v1, s[64:67], 0 offen offset:1024 sc1
    v_mfma_f32_16x16x32_bf16 v[144:147], v[192:195], v[124:127], v[144:147]
    s_waitcnt vmcnt(8) lgkmcnt(4)
    ds_read_b128 v[184:187], v1 offset:27648
    v_mfma_f32_16x16x32_bf16 v[144:147], a[240:243], v[128:131], v[144:147]
    ds_read_b128 v[188:191], v1 offset:32768
    v_mfma_f32_16x16x32_bf16 v[144:147], a[244:247], v[132:135], v[144:147]
    ds_read_b128 v[192:195], v1 offset:37888
    v_mfma_f32_16x16x32_bf16 v[144:147], a[248:251], v[136:139], v[144:147]
    ds_read_b128 a[240:243], v1 offset:38912
    buffer_load_dwordx4 v[244:247], v1, s[64:67], 0 offen offset:2048 sc1
    v_mfma_f32_16x16x32_bf16 v[144:147], a[252:255], v[140:143], v[144:147]
    ds_read_b128 a[244:247], v1 offset:33792
    v_mfma_f32_16x16x32_bf16 v[148:151], v[164:167], v[140:143], v[148:151]
    s_waitcnt lgkmcnt(4)
    ds_read_b128 a[248:251], v1 offset:28672
    v_mfma_f32_16x16x32_bf16 v[148:151], v[168:171], v[136:139], v[148:151]
    ds_read_b128 a[252:255], v1 offset:23552
    v_mfma_f32_16x16x32_bf16 v[148:151], v[172:175], v[132:135], v[148:151]
    ds_read_b128 v[164:167], v1 offset:24576
    buffer_load_dwordx4 v[248:251], v1, s[64:67], 0 offen offset:3072 sc1
    v_mfma_f32_16x16x32_bf16 v[148:151], v[176:179], v[128:131], v[148:151]
    ds_read_b128 v[168:171], v1 offset:29696
    v_cvt_pk_bf16_f32 v28, v144, v145
    v_mfma_f32_16x16x32_bf16 v[152:155], v[180:183], v[128:131], v[152:155]
    ds_read_b128 v[172:175], v1 offset:34816
    v_cvt_pk_bf16_f32 v29, v146, v147
    buffer_store_dwordx2 v[28:29], v57, s[28:31], 0 offen nt
    v_mfma_f32_16x16x32_bf16 v[152:155], v[184:187], v[132:135], v[152:155]
    s_waitcnt lgkmcnt(4)
    ds_read_b128 v[176:179], v1 offset:39936
    v_mfma_f32_16x16x32_bf16 v[152:155], v[188:191], v[136:139], v[152:155]
    buffer_load_dwordx4 v[252:255], v2, s[64:67], 0 offen sc1
    v_mfma_f32_16x16x32_bf16 v[152:155], v[192:195], v[140:143], v[152:155]
    v_cvt_pk_bf16_f32 v30, v148, v149
    v_mfma_f32_16x16x32_bf16 v[156:159], a[240:243], v[140:143], v[156:159]
    v_cvt_pk_bf16_f32 v31, v150, v151
    buffer_store_dwordx2 v[30:31], v57, s[28:31], 0 offen offset:512 nt
    v_mfma_f32_16x16x32_bf16 v[156:159], a[244:247], v[136:139], v[156:159]
    v_mfma_f32_16x16x32_bf16 v[156:159], a[248:251], v[132:135], v[156:159]
    s_waitcnt lgkmcnt(0)
    s_barrier
    v_mfma_f32_16x16x32_bf16 v[156:159], a[252:255], v[128:131], v[156:159]
    v_cvt_pk_bf16_f32 v32, v152, v153
    v_mfma_f32_16x16x32_bf16 v[160:163], v[164:167], v[128:131], v[160:163]
    v_cvt_pk_bf16_f32 v33, v154, v155
    buffer_store_dwordx2 v[32:33], v57, s[28:31], 0 offen offset:1024 nt
    v_mfma_f32_16x16x32_bf16 v[160:163], v[168:171], v[132:135], v[160:163]
    v_mfma_f32_16x16x32_bf16 v[160:163], v[172:175], v[136:139], v[160:163]
    v_mfma_f32_16x16x32_bf16 v[160:163], v[176:179], v[140:143], v[160:163]
    v_mfma_f32_16x16x32_bf16 v[80:83], v[28:31], v[28:31], 0
    v_mfma_f32_16x16x32_bf16 v[76:79], v[12:15], v[28:31], 0
    v_cvt_pk_bf16_f32 v34, v156, v157
    v_cvt_pk_bf16_f32 v35, v158, v159
    buffer_store_dwordx2 v[34:35], v57, s[28:31], 0 offen offset:1536 nt
    s_nop 0
    v_mfma_f32_16x16x32_bf16 v[80:83], v[32:35], v[32:35], v[80:83]
    v_mfma_f32_16x16x32_bf16 v[76:79], v[12:15], v[32:35], v[76:79]
    v_cvt_pk_bf16_f32 v36, v160, v161
    v_cvt_pk_bf16_f32 v37, v162, v163
    buffer_store_dwordx2 v[36:37], v57, s[28:31], 0 offen offset:2048 nt
    s_nop 0
    v_mfma_f32_16x16x32_bf16 v[80:83], v[36:39], v[36:39], v[80:83]
    v_mfma_f32_16x16x32_bf16 v[76:79], v[12:15], v[36:39], v[76:79]
    s_mul_i32 s76, s56, 2560
    s_add_u32 s76, s76, 22528
    v_mul_u32_u24 v84, 160, v16
    v_lshl_add_u32 v84, v17, 3, v84
    v_add_u32 v84, s76, v84
    s_mov_b64 s[86:87], -1
    s_nop 0
    v_cndmask_b32 v85, v80, v81, s[80:81]
    v_cndmask_b32 v85, v85, v82, s[82:83]
    v_cndmask_b32 v85, v85, v83, s[84:85]
    s_mov_b32 exec_lo, 0x00f0000f
    s_mov_b32 exec_hi, 0xf0000f00
    v_mov_b32 v77, v85
    buffer_store_dwordx2 v[76:77], v58, s[48:51], s78 offen
    s_mov_b64 exec, -1
    v_mfma_f32_16x16x32_bf16 v[52:55], a[44:47], v[12:15], v[52:55]
    ds_write_b64 v84, v[28:29]
    ds_write_b64 v84, v[30:31] offset:32
    ds_write_b64 v84, v[32:33] offset:64
    ds_write_b64 v84, v[34:35] offset:96
    ds_write_b64 v84, v[36:37] offset:128
    v_mfma_f32_16x16x32_bf16 v[52:55], a[56:59], v[12:15], v[52:55]
L_wp6:
    s_cbranch_execz L_wret1
    s_add_u32 s40, s52, s9
    s_addc_u32 s41, s53, 0
    s_mov_b32 s42, 8192
    s_add_u32 s12, s9, 102400
    v_add_u32 v3, s9, v1
    v_mfma_f32_16x16x32_bf16 v[52:55], a[68:71], v[12:15], v[52:55]
    s_mul_i32 s10, s61, 6
    s_add_u32 s10, s10, s56
    s_mul_i32 s10, s10, 512
    s_add_u32 s10, s10, 8192
    v_mfma_f32_16x16x32_bf16 v[52:55], a[80:83], v[12:15], v[52:55]
    s_add_u32 s32, s48, s10
    s_addc_u32 s33, s49, 0
    s_mov_b32 s34, 2304
    v_lshlrev_b32 v59, 4, v16
    v_and_b32 v85, 1, v17
    v_lshrrev_b32 v86, 1, v17
    v_mfma_f32_16x16x32_bf16 v[52:55], a[92:95], v[12:15], v[52:55]
    v_lshl_add_u32 v89, v85, 9, v58
    v_lshl_add_u32 v89, v86, 12, v89
    v_lshl_add_u32 v58, v85, 3, v59
    v_lshl_add_u32 v58, v86, 2, v58
    v_mfma_f32_16x16x32_bf16 v[52:55], a[104:107], v[12:15], v[52:55]
    s_lshl_b32 s76, s56, 8
    s_sub_u32 s75, 1536, s76
    v_add_u32 v58, s75, v58
    v_add_u32 v59, 20480, v59
    v_mfma_f32_16x16x32_bf16 v[52:55], a[116:119], v[12:15], v[52:55]
    v_add_u32 v90, s76, v59
    v_lshl_add_u32 v90, v86, 10, v90
    s_lshl_b32 s75, s56, 10
    s_add_u32 s75, s75, 0
    v_add_u32 v10, 1, v10
    s_cmp_lg_u32 s62, 0
    s_waitcnt vmcnt(0)
    s_cbranch_scc1 L_slow1
    buffer_store_dword v10, v9, s[48:51], 0 offen
L_sigd1:
    v_mfma_f32_16x16x32_bf16 v[52:55], a[128:131], v[12:15], v[52:55]
    s_mul_i32 s76, s56, 5248
    s_add_u32 s76, s76, 102400
    v_mul_u32_u24 v84, 160, v16
    v_lshrrev_b32 v85, 2, v16
    v_lshrrev_b32 v86, 1, v17
    v_add_u32 v85, v85, v86
    v_lshl_add_u32 v84, v85, 4, v84
    v_and_b32 v85, 1, v17
    v_mul_u32_u24 v85, 2624, v85
    v_add3_u32 v92, v84, v85, s76
    s_mul_i32 s76, s56, 656
    v_mfma_f32_16x16x32_bf16 v[52:55], a[140:143], v[12:15], v[52:55]
    s_add_u32 s76, s76, 102400
    v_min_u32 v84, 39, v0
    v_lshl_add_u32 v93, v84, 4, s76
    v_mul_u32_u24 v84, 6554, v0
    v_lshrrev_b32 v84, 16, v84
    v_mul_u32_u24 v85, 10, v84
    v_sub_u32 v85, v0, v85
    s_lshl_b32 s76, s56, 2
    v_and_b32 v84, 3, v84
    v_add_u32 v84, s76, v84
    v_mul_u32_u24 v86, 160, v84
    v_mfma_f32_16x16x32_bf16 v[52:55], a[152:155], v[12:15], v[52:55]
    v_lshl_add_u32 v94, v85, 4, v86
    v_add_u32 v94, 22528, v94
    v_mul_u32_u24 v86, 1280, v84
    v_lshl_add_u32 v86, v85, 4, v86
    v_cmp_gt_u32 vcc, 40, v0
    v_mov_b32 v87, 0x7ff00000
    s_nop 0
    v_cndmask_b32 v95, v87, v86, vcc
    s_mul_i32 s13, s58, 81920
    s_mul_i32 s76, s57, 160
    s_add_u32 s13, s13, s76
    s_add_u32 s28, s52, s13
    s_addc_u32 s29, s53, 0
    v_mfma_f32_16x16x32_bf16 v[52:55], a[164:167], v[12:15], v[52:55]
    s_mov_b32 s30, 19360
    s_mul_i32 s11, s58, -49152
    s_mul_i32 s76, s56, 12288
    s_add_u32 s11, s11, s76
    s_add_u32 s11, s11, 57344
    s_add_u32 s36, s48, s11
    s_addc_u32 s37, s49, 0
    s_mov_b32 s38, 8192
    s_mul_i32 s76, s57, 1536
    v_min_u32 v0, 11, v0
    v_lshl_add_u32 v0, v0, 7, s76
    s_waitcnt lgkmcnt(0)
    s_cmp_lg_u32 s56, 0
    s_cbranch_scc1 L_one2
    s_mov_b32 s3, 1048576
L_poll1:
    buffer_load_dword v91, v11, s[48:51], 0 offen sc1
    s_sub_u32 s3, s3, 1
    s_cbranch_scc1 L_pdone1
    s_waitcnt vmcnt(0)
    v_subrev_u32 v91, s60, v91
    v_cmp_gt_u32 vcc, 2, v91
    s_nop 0
    s_and_b64 vcc, vcc, s[86:87]
    s_cbranch_scc1 L_poll1
L_pdone1:
    s_cmp_eq_u32 s62, 0
    s_cbranch_scc1 L_pq1
    buffer_inv sc1
L_pq1:
    s_waitcnt vmcnt(0)
L_one2:
    s_barrier
    s_lshl_b32 s76, s56, 10
    s_add_u32 m0, s76, 102400
    s_nop 0
    buffer_load_dwordx4 v1, s[52:55], s76 offen sc1 lds
    s_addk_i32 m0, 4096
    s_addk_i32 s76, 4096
    buffer_load_dwordx4 v1, s[52:55], s76 offen sc1 lds
    s_addk_i32 m0, 4096
    s_addk_i32 s76, 4096
    buffer_load_dwordx4 v1, s[52:55], s76 offen sc1 lds
    s_addk_i32 m0, 4096
    s_addk_i32 s76, 4096
    buffer_load_dwordx4 v1, s[52:55], s76 offen sc1 lds
    s_addk_i32 m0, 4096
    s_addk_i32 s76, 4096
    buffer_load_dwordx4 v1, s[52:55], s76 offen sc1 lds
    buffer_load_dwordx4 v[76:79], v89, s[48:51], s75 offen sc1
    buffer_load_dwordx4 v[80:83], v89, s[48:51], s75 offen offset:256 sc1
    s_add_u32 m0, s12, 20480
    s_add_u32 s40, s40, 81920
    s_addc_u32 s41, s41, 0
    buffer_load_dwordx4 v1, s[40:43], 0 offen sc1 lds
    s_waitcnt vmcnt(6)
    s_barrier
    ds_read_b128 v[60:63], v56
    ds_read_b128 v[64:67], v56 offset:1024
    ds_read_b128 v[68:71], v56 offset:2048
    ds_read_b128 v[72:75], v56 offset:3072
    v_mfma_f32_16x16x32_bf16 v[52:55], a[176:179], v[12:15], v[52:55]
    v_mfma_f32_16x16x32_bf16 v[52:55], a[188:191], v[12:15], v[52:55]
    v_mfma_f32_16x16x32_bf16 v[52:55], a[200:203], v[12:15], v[52:55]
    v_mfma_f32_16x16x32_bf16 v[52:55], a[212:215], v[12:15], v[52:55]
    v_mfma_f32_16x16x32_bf16 v[52:55], a[224:227], v[12:15], v[52:55]
    v_mfma_f32_16x16x32_bf16 v[52:55], a[236:239], v[12:15], v[52:55]
    s_waitcnt lgkmcnt(0)
    v_mfma_f32_16x16x32_bf16 v[16:19], a[0:3], v[60:63], 0
    ds_read_b128 a[240:243], v56 offset:4096
    buffer_load_dwordx4 v1, s[40:43], 0 offen offset:1024 sc1 lds
    v_mfma_f32_16x16x32_bf16 v[16:19], a[12:15], v[64:67], v[16:19]
    v_mfma_f32_16x16x32_bf16 v[16:19], a[24:27], v[68:71], v[16:19]
    ds_read_b128 a[244:247], v56 offset:5120
    v_mfma_f32_16x16x32_bf16 v[16:19], a[36:39], v[72:75], v[16:19]
    ds_read_b128 a[248:251], v56 offset:6144
    v_mfma_f32_16x16x32_bf16 v[20:23], a[40:43], v[72:75], 0
    ds_read_b128 a[252:255], v56 offset:7168
    buffer_load_dwordx4 v1, s[40:43], 0 offen offset:2048 sc1 lds
    v_mfma_f32_16x16x32_bf16 v[20:23], a[28:31], v[68:71], v[20:23]
    v_mfma_f32_16x16x32_bf16 v[20:23], a[16:19], v[64:67], v[20:23]
    v_mfma_f32_16x16x32_bf16 v[20:23], a[4:7], v[60:63], v[20:23]
    buffer_load_dwordx4 v1, s[40:43], 0 offen offset:3072 sc1 lds
    v_mfma_f32_16x16x32_bf16 v[24:27], a[8:11], v[60:63], 0
    v_mfma_f32_16x16x32_bf16 v[24:27], a[20:23], v[64:67], v[24:27]
    v_mfma_f32_16x16x32_bf16 v[24:27], a[32:35], v[68:71], v[24:27]
    v_mfma_f32_16x16x32_bf16 v[24:27], a[44:47], v[72:75], v[24:27]
    s_waitcnt vmcnt(6) lgkmcnt(0)
    s_barrier
    s_addk_i32 m0, 4096
    v_mfma_f32_16x16x32_bf16 v[24:27], a[56:59], a[240:243], v[24:27]
    s_waitcnt vmcnt(4)
    ds_read_b128 v[60:63], v56 offset:8192
    v_mfma_f32_16x16x32_bf16 v[24:27], a[68:71], a[244:247], v[24:27]
    buffer_load_dwordx4 v2, s[40:43], 0 offen sc1 lds
    v_add_f32 v76, v76, v78
    v_mfma_f32_16x16x32_bf16 v[24:27], a[80:83], a[248:251], v[24:27]
    ds_read_b128 v[64:67], v56 offset:9216
    v_add_f32 v77, v77, v79
    v_mfma_f32_16x16x32_bf16 v[24:27], a[92:95], a[252:255], v[24:27]
    ds_read_b128 v[68:71], v56 offset:10240
    v_add_f32 v80, v80, v82
    v_mfma_f32_16x16x32_bf16 v[20:23], a[88:91], a[252:255], v[20:23]
    ds_read_b128 v[72:75], v56 offset:11264
    v_add_f32 v81, v81, v83
    v_mfma_f32_16x16x32_bf16 v[20:23], a[76:79], a[248:251], v[20:23]
    v_add_f32 v76, v76, v80
    v_mfma_f32_16x16x32_bf16 v[20:23], a[64:67], a[244:247], v[20:23]
    s_add_u32 m0, s12, 40960
    v_add_f32 v77, v77, v81
    v_mfma_f32_16x16x32_bf16 v[20:23], a[52:55], a[240:243], v[20:23]
    v_mov_b32 v78, v76
    v_mfma_f32_16x16x32_bf16 v[16:19], a[48:51], a[240:243], v[16:19]
    v_mov_b32 v79, v77
    v_mfma_f32_16x16x32_bf16 v[16:19], a[60:63], a[244:247], v[16:19]
    s_sub_u32 s40, s40, 61440
    s_subb_u32 s41, s41, 0
    v_mfma_f32_16x16x32_bf16 v[16:19], a[72:75], a[248:251], v[16:19]
    v_permlane16_swap_b32 v76, v78
    v_mfma_f32_16x16x32_bf16 v[16:19], a[84:87], a[252:255], v[16:19]
    s_waitcnt lgkmcnt(0)
    v_permlane16_swap_b32 v77, v79
    v_mfma_f32_16x16x32_bf16 v[16:19], a[96:99], v[60:63], v[16:19]
    ds_read_b128 a[240:243], v56 offset:12288
    v_mfma_f32_16x16x32_bf16 v[16:19], a[108:111], v[64:67], v[16:19]
    v_mfma_f32_16x16x32_bf16 v[16:19], a[120:123], v[68:71], v[16:19]
    ds_read_b128 a[244:247], v56 offset:13312
    buffer_load_dwordx4 v1, s[40:43], 0 offen sc1 lds
    v_mfma_f32_16x16x32_bf16 v[16:19], a[132:135], v[72:75], v[16:19]
    ds_read_b128 a[248:251], v56 offset:14336
    v_add_f32 v76, v76, v78
    v_mfma_f32_16x16x32_bf16 v[20:23], a[136:139], v[72:75], v[20:23]
    ds_read_b128 a[252:255], v56 offset:15360
    v_add_f32 v77, v77, v79
    v_mfma_f32_16x16x32_bf16 v[20:23], a[124:127], v[68:71], v[20:23]
    v_mul_f32 v76, 0xbacccccd, v76
    v_mul_f32 v78, 0x3acccccd, v77
    v_mfma_f32_16x16x32_bf16 v[20:23], a[112:115], v[64:67], v[20:23]
    v_fma_f32 v78, -v76, v76, v78
    v_mfma_f32_16x16x32_bf16 v[20:23], a[100:103], v[60:63], v[20:23]
    buffer_load_dwordx4 v1, s[40:43], 0 offen offset:1024 sc1 lds
    v_max_f32 v78, 0, v78
    v_mfma_f32_16x16x32_bf16 v[24:27], a[104:107], v[60:63], v[24:27]
    v_add_f32 v78, 0x3727c5ac, v78
    v_mfma_f32_16x16x32_bf16 v[24:27], a[116:119], v[64:67], v[24:27]
    v_rsq_f32 v77, v78
    v_mfma_f32_16x16x32_bf16 v[24:27], a[128:131], v[68:71], v[24:27]
    v_mfma_f32_16x16x32_bf16 v[24:27], a[140:143], v[72:75], v[24:27]
    s_waitcnt lgkmcnt(0)
    v_mul_f32 v77, 0xbfb8aa3b, v77
    v_mfma_f32_16x16x32_bf16 v[24:27], a[152:155], a[240:243], v[24:27]
    ds_read_b128 v[60:63], v56 offset:16384
    buffer_load_dwordx4 v1, s[40:43], 0 offen offset:2048 sc1 lds
    v_mfma_f32_16x16x32_bf16 v[24:27], a[164:167], a[244:247], v[24:27]
    ds_write_b128 v90, v[76:79]
    v_mfma_f32_16x16x32_bf16 v[24:27], a[176:179], a[248:251], v[24:27]
    ds_read_b128 v[64:67], v56 offset:17408
    v_mfma_f32_16x16x32_bf16 v[24:27], a[188:191], a[252:255], v[24:27]
    ds_read_b128 v[68:71], v56 offset:18432
    v_mfma_f32_16x16x32_bf16 v[20:23], a[184:187], a[252:255], v[20:23]
    ds_read_b128 v[72:75], v56 offset:19456
    v_mfma_f32_16x16x32_bf16 v[20:23], a[172:175], a[248:251], v[20:23]
    buffer_load_dwordx4 v1, s[40:43], 0 offen offset:3072 sc1 lds
    v_mfma_f32_16x16x32_bf16 v[20:23], a[160:163], a[244:247], v[20:23]
    v_mfma_f32_16x16x32_bf16 v[20:23], a[148:151], a[240:243], v[20:23]
    v_mfma_f32_16x16x32_bf16 v[16:19], a[144:147], a[240:243], v[16:19]
    v_mfma_f32_16x16x32_bf16 v[16:19], a[156:159], a[244:247], v[16:19]
    v_mfma_f32_16x16x32_bf16 v[16:19], a[168:171], a[248:251], v[16:19]
    v_mfma_f32_16x16x32_bf16 v[16:19], a[180:183], a[252:255], v[16:19]
    s_waitcnt vmcnt(4) lgkmcnt(0)
    s_barrier
    s_addk_i32 m0, 4096
    v_mfma_f32_16x16x32_bf16 v[16:19], a[192:195], v[60:63], v[16:19]
    ds_read_b128 a[240:243], v56 offset:20480
    v_mfma_f32_16x16x32_bf16 v[16:19], a[204:207], v[64:67], v[16:19]
    buffer_load_dwordx4 v2, s[40:43], 0 offen sc1 lds
    v_mfma_f32_16x16x32_bf16 v[16:19], a[216:219], v[68:71], v[16:19]
    ds_read_b128 a[244:247], v56 offset:21504
    v_mfma_f32_16x16x32_bf16 v[16:19], a[228:231], v[72:75], v[16:19]
    ds_read_b128 a[248:251], v56 offset:22528
    v_mfma_f32_16x16x32_bf16 v[20:23], a[232:235], v[72:75], v[20:23]
    ds_read_b128 a[252:255], v56 offset:23552
    v_mfma_f32_16x16x32_bf16 v[20:23], a[220:223], v[68:71], v[20:23]
    ds_read_b128 v[40:43], v59
    v_mfma_f32_16x16x32_bf16 v[20:23], a[208:211], v[64:67], v[20:23]
    v_mfma_f32_16x16x32_bf16 v[20:23], a[196:199], v[60:63], v[20:23]
    v_mfma_f32_16x16x32_bf16 v[24:27], a[200:203], v[60:63], v[24:27]
    v_mfma_f32_16x16x32_bf16 v[24:27], a[212:215], v[64:67], v[24:27]
    v_mfma_f32_16x16x32_bf16 v[24:27], a[224:227], v[68:71], v[24:27]
    v_mfma_f32_16x16x32_bf16 v[24:27], a[236:239], v[72:75], v[24:27]
    s_waitcnt lgkmcnt(0)
    v_mfma_f32_16x16x32_bf16 v[28:31], a[0:3], a[240:243], 0
    s_add_u32 m0, s12, 0
    ds_read_b128 v[60:63], v56 offset:24576
    v_mfma_f32_16x16x32_bf16 v[28:31], a[12:15], a[244:247], v[28:31]
    s_add_u32 s32, s32, 344064
    v_fmac_f32 v16, v40, v44
    v_fmac_f32 v17, v40, v45
    v_mfma_f32_16x16x32_bf16 v[28:31], a[24:27], a[248:251], v[28:31]
    ds_read_b128 v[64:67], v56 offset:25600
    v_fmac_f32 v18, v40, v46
    v_mfma_f32_16x16x32_bf16 v[28:31], a[36:39], a[252:255], v[28:31]
    s_add_u32 s40, s40, 81920
    s_addc_u32 s41, s41, 0
    ds_read_b128 v[68:71], v56 offset:26624
    v_mfma_f32_16x16x32_bf16 v[32:35], a[40:43], a[252:255], 0
    ds_read_b128 v[72:75], v56 offset:27648
    v_fmac_f32 v19, v40, v47
    v_mfma_f32_16x16x32_bf16 v[32:35], a[28:31], a[248:251], v[32:35]
    v_fmac_f32 v24, v40, v52
    v_fmac_f32 v25, v40, v53
    v_mfma_f32_16x16x32_bf16 v[32:35], a[16:19], a[244:247], v[32:35]
    v_fmac_f32 v26, v40, v54
    v_fmac_f32 v27, v40, v55
    v_mfma_f32_16x16x32_bf16 v[32:35], a[4:7], a[240:243], v[32:35]
    buffer_load_dwordx4 v1, s[40:43], 0 offen sc1 lds
    v_mul_f32 v76, v41, v16
    v_mfma_f32_16x16x32_bf16 v[36:39], a[8:11], a[240:243], 0
    v_permlane32_swap_b32 v24, v26
    v_mfma_f32_16x16x32_bf16 v[36:39], a[20:23], a[244:247], v[36:39]
    v_permlane32_swap_b32 v25, v27
    v_mfma_f32_16x16x32_bf16 v[36:39], a[32:35], a[248:251], v[36:39]
    v_exp_f32 v76, v76
    v_mfma_f32_16x16x32_bf16 v[36:39], a[44:47], a[252:255], v[36:39]
    s_waitcnt lgkmcnt(0)
    buffer_load_dwordx4 v1, s[40:43], 0 offen offset:1024 sc1 lds
    v_mul_f32 v77, v41, v17
    v_mfma_f32_16x16x32_bf16 v[36:39], a[56:59], v[60:63], v[36:39]
    ds_read_b128 a[240:243], v56 offset:28672
    v_mul_f32 v78, v41, v18
    v_mfma_f32_16x16x32_bf16 v[36:39], a[68:71], v[64:67], v[36:39]
    v_exp_f32 v77, v77
    v_mfma_f32_16x16x32_bf16 v[36:39], a[80:83], v[68:71], v[36:39]
    ds_read_b128 a[244:247], v56 offset:29696
    v_mul_f32 v79, v41, v19
    v_mfma_f32_16x16x32_bf16 v[36:39], a[92:95], v[72:75], v[36:39]
    ds_read_b128 a[248:251], v56 offset:30720
    buffer_load_dwordx4 v1, s[40:43], 0 offen offset:2048 sc1 lds
    v_mfma_f32_16x16x32_bf16 v[32:35], a[88:91], v[72:75], v[32:35]
    ds_read_b128 a[252:255], v56 offset:31744
    v_mul_f32 v80, v41, v24
    v_mfma_f32_16x16x32_bf16 v[32:35], a[76:79], v[68:71], v[32:35]
    v_exp_f32 v78, v78
    v_mfma_f32_16x16x32_bf16 v[32:35], a[64:67], v[64:67], v[32:35]
    v_exp_f32 v79, v79
    v_mfma_f32_16x16x32_bf16 v[32:35], a[52:55], v[60:63], v[32:35]
    buffer_load_dwordx4 v1, s[40:43], 0 offen offset:3072 sc1 lds
    v_mul_f32 v81, v41, v25
    v_mfma_f32_16x16x32_bf16 v[28:31], a[48:51], v[60:63], v[28:31]
    v_exp_f32 v80, v80
    v_mfma_f32_16x16x32_bf16 v[28:31], a[60:63], v[64:67], v[28:31]
    v_exp_f32 v81, v81
    v_mfma_f32_16x16x32_bf16 v[28:31], a[72:75], v[68:71], v[28:31]
    v_fma_f32 v76, v76, v42, v42
    v_fma_f32 v77, v77, v42, v42
    v_mfma_f32_16x16x32_bf16 v[28:31], a[84:87], v[72:75], v[28:31]
    s_waitcnt lgkmcnt(0)
    s_addk_i32 m0, 4096
    v_fma_f32 v78, v78, v42, v42
    v_mfma_f32_16x16x32_bf16 v[28:31], a[96:99], a[240:243], v[28:31]
    ds_read_b128 v[60:63], v56 offset:32768
    v_fma_f32 v79, v79, v42, v42
    v_mfma_f32_16x16x32_bf16 v[28:31], a[108:111], a[244:247], v[28:31]
    buffer_load_dwordx4 v2, s[40:43], 0 offen sc1 lds
    v_fmac_f32 v20, v40, v48
    v_mfma_f32_16x16x32_bf16 v[28:31], a[120:123], a[248:251], v[28:31]
    ds_read_b128 v[64:67], v56 offset:33792
    v_fmac_f32 v21, v40, v49
    v_mfma_f32_16x16x32_bf16 v[28:31], a[132:135], a[252:255], v[28:31]
    ds_read_b128 v[68:71], v56 offset:34816
    v_fmac_f32 v22, v40, v50
    v_mfma_f32_16x16x32_bf16 v[32:35], a[136:139], a[252:255], v[32:35]
    ds_read_b128 v[72:75], v56 offset:35840
    v_fmac_f32 v23, v40, v51
    v_mfma_f32_16x16x32_bf16 v[32:35], a[124:127], a[248:251], v[32:35]
    s_add_u32 s64, s64, 122880
    v_rcp_f32 v76, v76
    v_mfma_f32_16x16x32_bf16 v[32:35], a[112:115], a[244:247], v[32:35]
    v_rcp_f32 v77, v77
    v_mfma_f32_16x16x32_bf16 v[32:35], a[100:103], a[240:243], v[32:35]
    buffer_load_dwordx4 v[176:179], v1, s[64:67], 0 offen sc1
    v_mul_f32 v82, v16, v20
    v_mfma_f32_16x16x32_bf16 v[36:39], a[104:107], a[240:243], v[36:39]
    v_rcp_f32 v78, v78
    v_mfma_f32_16x16x32_bf16 v[36:39], a[116:119], a[244:247], v[36:39]
    v_rcp_f32 v79, v79
    v_mfma_f32_16x16x32_bf16 v[36:39], a[128:131], a[248:251], v[36:39]
    v_mul_f32 v83, v17, v21
    v_mul_f32 v84, v18, v22
    v_mfma_f32_16x16x32_bf16 v[36:39], a[140:143], a[252:255], v[36:39]
    s_waitcnt lgkmcnt(0)
    buffer_load_dwordx4 v[180:183], v1, s[64:67], 0 offen offset:1024 sc1
    v_mul_f32 v85, v19, v23
    v_mfma_f32_16x16x32_bf16 v[36:39], a[152:155], v[60:63], v[36:39]
    ds_read_b128 a[240:243], v56 offset:36864
    v_fma_f32 v80, v80, v42, v42
    v_mfma_f32_16x16x32_bf16 v[36:39], a[164:167], v[64:67], v[36:39]
    v_rcp_f32 v80, v80
    v_mfma_f32_16x16x32_bf16 v[36:39], a[176:179], v[68:71], v[36:39]
    ds_read_b128 a[244:247], v56 offset:37888
    v_fma_f32 v81, v81, v42, v42
    v_mfma_f32_16x16x32_bf16 v[36:39], a[188:191], v[72:75], v[36:39]
    ds_read_b128 a[248:251], v56 offset:38912
    buffer_load_dwordx4 v[184:187], v1, s[64:67], 0 offen offset:2048 sc1
    v_mfma_f32_16x16x32_bf16 v[32:35], a[184:187], v[72:75], v[32:35]
    ds_read_b128 a[252:255], v56 offset:39936
    v_mul_f32 v82, v82, v76
    v_mfma_f32_16x16x32_bf16 v[32:35], a[172:175], v[68:71], v[32:35]
    v_rcp_f32 v81, v81
    v_mfma_f32_16x16x32_bf16 v[32:35], a[160:163], v[64:67], v[32:35]
    v_mul_f32 v83, v83, v77
    v_mul_f32 v84, v84, v78
    v_mfma_f32_16x16x32_bf16 v[32:35], a[148:151], v[60:63], v[32:35]
    buffer_load_dwordx4 v[188:191], v1, s[64:67], 0 offen offset:3072 sc1
    v_mul_f32 v85, v85, v79
    v_mfma_f32_16x16x32_bf16 v[28:31], a[144:147], v[60:63], v[28:31]
    v_cvt_pk_bf16_f32 v88, v82, v83
    v_cvt_pk_bf16_f32 v89, v84, v85
    v_mfma_f32_16x16x32_bf16 v[28:31], a[156:159], v[64:67], v[28:31]
    buffer_store_dwordx2 v[88:89], v57, s[32:35], 0 offen sc1
    v_mfma_f32_16x16x32_bf16 v[28:31], a[168:171], v[68:71], v[28:31]
    v_mul_f32 v86, v24, v26
    v_mul_f32 v87, v25, v27
    v_mfma_f32_16x16x32_bf16 v[28:31], a[180:183], v[72:75], v[28:31]
    s_waitcnt vmcnt(10) lgkmcnt(0)
    s_barrier
    buffer_load_dwordx4 v[192:195], v2, s[64:67], 0 offen sc1
    v_mfma_f32_16x16x32_bf16 v[28:31], a[192:195], a[240:243], v[28:31]
    ds_read_b128 v[60:63], v56 offset:40960
    v_mul_f32 v86, v86, v80
    v_mfma_f32_16x16x32_bf16 v[28:31], a[204:207], a[244:247], v[28:31]
    v_mul_f32 v87, v87, v81
    v_cvt_pk_bf16_f32 v90, v86, v87
    v_mfma_f32_16x16x32_bf16 v[28:31], a[216:219], a[248:251], v[28:31]
    buffer_store_dword v90, v58, s[32:35], 0 offen offset:512 sc1
    v_mfma_f32_16x16x32_bf16 v[28:31], a[228:231], a[252:255], v[28:31]
    ds_read_b128 v[64:67], v56 offset:41984
    v_mfma_f32_16x16x32_bf16 v[32:35], a[232:235], a[252:255], v[32:35]
    ds_read_b128 v[68:71], v56 offset:43008
    v_mfma_f32_16x16x32_bf16 v[32:35], a[220:223], a[248:251], v[32:35]
    ds_read_b128 v[72:75], v56 offset:44032
    v_mfma_f32_16x16x32_bf16 v[32:35], a[208:211], a[244:247], v[32:35]
    ds_read_b128 v[12:15], v59 offset:1024
    v_mfma_f32_16x16x32_bf16 v[32:35], a[196:199], a[240:243], v[32:35]
    v_mfma_f32_16x16x32_bf16 v[36:39], a[200:203], a[240:243], v[36:39]
    v_mfma_f32_16x16x32_bf16 v[36:39], a[212:215], a[244:247], v[36:39]
    v_mfma_f32_16x16x32_bf16 v[36:39], a[224:227], a[248:251], v[36:39]
    v_mfma_f32_16x16x32_bf16 v[36:39], a[236:239], a[252:255], v[36:39]
    s_waitcnt lgkmcnt(0)
    v_mfma_f32_16x16x32_bf16 v[16:19], a[0:3], v[60:63], 0
    s_add_u32 m0, s12, 20480
    ds_read_b128 a[240:243], v56 offset:45056
    v_mfma_f32_16x16x32_bf16 v[16:19], a[12:15], v[64:67], v[16:19]
    s_sub_u32 s32, s32, 49152
    v_fmac_f32 v28, v12, v44
    v_fmac_f32 v29, v12, v45
    v_mfma_f32_16x16x32_bf16 v[16:19], a[24:27], v[68:71], v[16:19]
    ds_read_b128 a[244:247], v56 offset:46080
    v_fmac_f32 v30, v12, v46
    v_mfma_f32_16x16x32_bf16 v[16:19], a[36:39], v[72:75], v[16:19]
    s_sub_u32 s40, s40, 61440
    s_subb_u32 s41, s41, 0
    ds_read_b128 a[248:251], v56 offset:47104
    v_mfma_f32_16x16x32_bf16 v[20:23], a[40:43], v[72:75], 0
    ds_read_b128 a[252:255], v56 offset:48128
    v_fmac_f32 v31, v12, v47
    v_mfma_f32_16x16x32_bf16 v[20:23], a[28:31], v[68:71], v[20:23]
    v_fmac_f32 v36, v12, v52
    v_fmac_f32 v37, v12, v53
    v_mfma_f32_16x16x32_bf16 v[20:23], a[16:19], v[64:67], v[20:23]
    v_fmac_f32 v38, v12, v54
    v_fmac_f32 v39, v12, v55
    v_mfma_f32_16x16x32_bf16 v[20:23], a[4:7], v[60:63], v[20:23]
    buffer_load_dwordx4 v1, s[40:43], 0 offen sc1 lds
    v_mul_f32 v76, v13, v28
    v_mfma_f32_16x16x32_bf16 v[24:27], a[8:11], v[60:63], 0
    v_permlane32_swap_b32 v36, v38
    v_mfma_f32_16x16x32_bf16 v[24:27], a[20:23], v[64:67], v[24:27]
    v_permlane32_swap_b32 v37, v39
    v_mfma_f32_16x16x32_bf16 v[24:27], a[32:35], v[68:71], v[24:27]
    v_exp_f32 v76, v76
    v_mfma_f32_16x16x32_bf16 v[24:27], a[44:47], v[72:75], v[24:27]
    s_waitcnt lgkmcnt(0)
    buffer_load_dwordx4 v1, s[40:43], 0 offen offset:1024 sc1 lds
    v_mul_f32 v77, v13, v29
    v_mfma_f32_16x16x32_bf16 v[24:27], a[56:59], a[240:243], v[24:27]
    ds_read_b128 v[60:63], v56 offset:49152
    v_mul_f32 v78, v13, v30
    v_mfma_f32_16x16x32_bf16 v[24:27], a[68:71], a[244:247], v[24:27]
    v_exp_f32 v77, v77
    v_mfma_f32_16x16x32_bf16 v[24:27], a[80:83], a[248:251], v[24:27]
    ds_read_b128 v[64:67], v56 offset:50176
    v_mul_f32 v79, v13, v31
    v_mfma_f32_16x16x32_bf16 v[24:27], a[92:95], a[252:255], v[24:27]
    ds_read_b128 v[68:71], v56 offset:51200
    buffer_load_dwordx4 v1, s[40:43], 0 offen offset:2048 sc1 lds
    v_mfma_f32_16x16x32_bf16 v[20:23], a[88:91], a[252:255], v[20:23]
    ds_read_b128 v[72:75], v56 offset:52224
    v_mul_f32 v80, v13, v36
    v_mfma_f32_16x16x32_bf16 v[20:23], a[76:79], a[248:251], v[20:23]
    v_exp_f32 v78, v78
    v_mfma_f32_16x16x32_bf16 v[20:23], a[64:67], a[244:247], v[20:23]
    v_exp_f32 v79, v79
    v_mfma_f32_16x16x32_bf16 v[20:23], a[52:55], a[240:243], v[20:23]
    buffer_load_dwordx4 v1, s[40:43], 0 offen offset:3072 sc1 lds
    v_mul_f32 v81, v13, v37
    v_mfma_f32_16x16x32_bf16 v[16:19], a[48:51], a[240:243], v[16:19]
    v_exp_f32 v80, v80
    v_mfma_f32_16x16x32_bf16 v[16:19], a[60:63], a[244:247], v[16:19]
    v_exp_f32 v81, v81
    v_mfma_f32_16x16x32_bf16 v[16:19], a[72:75], a[248:251], v[16:19]
    v_fma_f32 v76, v76, v14, v14
    v_fma_f32 v77, v77, v14, v14
    v_mfma_f32_16x16x32_bf16 v[16:19], a[84:87], a[252:255], v[16:19]
    s_waitcnt lgkmcnt(0)
    s_addk_i32 m0, 4096
    v_fma_f32 v78, v78, v14, v14
    v_mfma_f32_16x16x32_bf16 v[16:19], a[96:99], v[60:63], v[16:19]
    ds_read_b128 a[240:243], v56 offset:53248
    v_fma_f32 v79, v79, v14, v14
    v_mfma_f32_16x16x32_bf16 v[16:19], a[108:111], v[64:67], v[16:19]
    buffer_load_dwordx4 v2, s[40:43], 0 offen sc1 lds
    v_fmac_f32 v32, v12, v48
    v_mfma_f32_16x16x32_bf16 v[16:19], a[120:123], v[68:71], v[16:19]
    ds_read_b128 a[244:247], v56 offset:54272
    v_fmac_f32 v33, v12, v49
    v_mfma_f32_16x16x32_bf16 v[16:19], a[132:135], v[72:75], v[16:19]
    ds_read_b128 a[248:251], v56 offset:55296
    v_fmac_f32 v34, v12, v50
    v_mfma_f32_16x16x32_bf16 v[20:23], a[136:139], v[72:75], v[20:23]
    ds_read_b128 a[252:255], v56 offset:56320
    v_fmac_f32 v35, v12, v51
    v_mfma_f32_16x16x32_bf16 v[20:23], a[124:127], v[68:71], v[20:23]
    s_add_u32 s64, s64, 40960
    v_rcp_f32 v76, v76
    v_mfma_f32_16x16x32_bf16 v[20:23], a[112:115], v[64:67], v[20:23]
    v_rcp_f32 v77, v77
    v_mfma_f32_16x16x32_bf16 v[20:23], a[100:103], v[60:63], v[20:23]
    buffer_load_dwordx4 v[156:159], v1, s[64:67], 0 offen sc1
    v_mul_f32 v82, v28, v32
    v_mfma_f32_16x16x32_bf16 v[24:27], a[104:107], v[60:63], v[24:27]
    v_rcp_f32 v78, v78
    v_mfma_f32_16x16x32_bf16 v[24:27], a[116:119], v[64:67], v[24:27]
    v_rcp_f32 v79, v79
    v_mfma_f32_16x16x32_bf16 v[24:27], a[128:131], v[68:71], v[24:27]
    v_mul_f32 v83, v29, v33
    v_mul_f32 v84, v30, v34
    v_mfma_f32_16x16x32_bf16 v[24:27], a[140:143], v[72:75], v[24:27]
    s_waitcnt lgkmcnt(0)
    buffer_load_dwordx4 v[160:163], v1, s[64:67], 0 offen offset:1024 sc1
    v_mul_f32 v85, v31, v35
    v_mfma_f32_16x16x32_bf16 v[24:27], a[152:155], a[240:243], v[24:27]
    ds_read_b128 v[60:63], v56 offset:57344
    v_fma_f32 v80, v80, v14, v14
    v_mfma_f32_16x16x32_bf16 v[24:27], a[164:167], a[244:247], v[24:27]
    v_rcp_f32 v80, v80
    v_mfma_f32_16x16x32_bf16 v[24:27], a[176:179], a[248:251], v[24:27]
    ds_read_b128 v[64:67], v56 offset:58368
    v_fma_f32 v81, v81, v14, v14
    v_mfma_f32_16x16x32_bf16 v[24:27], a[188:191], a[252:255], v[24:27]
    ds_read_b128 v[68:71], v56 offset:59392
    buffer_load_dwordx4 v[164:167], v1, s[64:67], 0 offen offset:2048 sc1
    v_mfma_f32_16x16x32_bf16 v[20:23], a[184:187], a[252:255], v[20:23]
    ds_read_b128 v[72:75], v56 offset:60416
    v_mul_f32 v82, v82, v76
    v_mfma_f32_16x16x32_bf16 v[20:23], a[172:175], a[248:251], v[20:23]
    v_rcp_f32 v81, v81
    v_mfma_f32_16x16x32_bf16 v[20:23], a[160:163], a[244:247], v[20:23]
    v_mul_f32 v83, v83, v77
    v_mul_f32 v84, v84, v78
    v_mfma_f32_16x16x32_bf16 v[20:23], a[148:151], a[240:243], v[20:23]
    buffer_load_dwordx4 v[168:171], v1, s[64:67], 0 offen offset:3072 sc1
    v_mul_f32 v85, v85, v79
    v_mfma_f32_16x16x32_bf16 v[16:19], a[144:147], a[240:243], v[16:19]
    v_cvt_pk_bf16_f32 v88, v82, v83
    v_cvt_pk_bf16_f32 v89, v84, v85
    v_mfma_f32_16x16x32_bf16 v[16:19], a[156:159], a[244:247], v[16:19]
    buffer_store_dwordx2 v[88:89], v57, s[32:35], 0 offen sc1
    v_mfma_f32_16x16x32_bf16 v[16:19], a[168:171], a[248:251], v[16:19]
    v_mul_f32 v86, v36, v38
    v_mul_f32 v87, v37, v39
    v_mfma_f32_16x16x32_bf16 v[16:19], a[180:183], a[252:255], v[16:19]
    s_waitcnt vmcnt(17) lgkmcnt(0)
    s_barrier
    buffer_load_dwordx4 v[172:175], v2, s[64:67], 0 offen sc1
    v_mfma_f32_16x16x32_bf16 v[16:19], a[192:195], v[60:63], v[16:19]
    ds_read_b128 a[240:243], v56
    v_mul_f32 v86, v86, v80
    v_mfma_f32_16x16x32_bf16 v[16:19], a[204:207], v[64:67], v[16:19]
    v_mul_f32 v87, v87, v81
    v_cvt_pk_bf16_f32 v90, v86, v87
    v_mfma_f32_16x16x32_bf16 v[16:19], a[216:219], v[68:71], v[16:19]
    buffer_store_dword v90, v58, s[32:35], 0 offen offset:512 sc1
    v_mfma_f32_16x16x32_bf16 v[16:19], a[228:231], v[72:75], v[16:19]
    ds_read_b128 a[244:247], v56 offset:1024
    v_mfma_f32_16x16x32_bf16 v[20:23], a[232:235], v[72:75], v[20:23]
    ds_read_b128 a[248:251], v56 offset:2048
    v_mfma_f32_16x16x32_bf16 v[20:23], a[220:223], v[68:71], v[20:23]
    ds_read_b128 a[252:255], v56 offset:3072
    v_mfma_f32_16x16x32_bf16 v[20:23], a[208:211], v[64:67], v[20:23]
    ds_read_b128 v[40:43], v59 offset:256
    v_mfma_f32_16x16x32_bf16 v[20:23], a[196:199], v[60:63], v[20:23]
    v_mfma_f32_16x16x32_bf16 v[24:27], a[200:203], v[60:63], v[24:27]
    v_mfma_f32_16x16x32_bf16 v[24:27], a[212:215], v[64:67], v[24:27]
    v_mfma_f32_16x16x32_bf16 v[24:27], a[224:227], v[68:71], v[24:27]
    v_mfma_f32_16x16x32_bf16 v[24:27], a[236:239], v[72:75], v[24:27]
    s_waitcnt lgkmcnt(0)
    v_mfma_f32_16x16x32_bf16 v[28:31], a[0:3], a[240:243], 0
    s_add_u32 m0, s12, 40960
    ds_read_b128 v[60:63], v56 offset:4096
    v_mfma_f32_16x16x32_bf16 v[28:31], a[12:15], a[244:247], v[28:31]
    s_sub_u32 s32, s32, 49152
    v_fmac_f32 v16, v40, v44
    v_fmac_f32 v17, v40, v45
    v_mfma_f32_16x16x32_bf16 v[28:31], a[24:27], a[248:251], v[28:31]
    ds_read_b128 v[64:67], v56 offset:5120
    v_fmac_f32 v18, v40, v46
    v_mfma_f32_16x16x32_bf16 v[28:31], a[36:39], a[252:255], v[28:31]
    s_add_u32 s40, s40, 81920
    s_addc_u32 s41, s41, 0
    ds_read_b128 v[68:71], v56 offset:6144
    v_mfma_f32_16x16x32_bf16 v[32:35], a[40:43], a[252:255], 0
    ds_read_b128 v[72:75], v56 offset:7168
    v_fmac_f32 v19, v40, v47
    v_mfma_f32_16x16x32_bf16 v[32:35], a[28:31], a[248:251], v[32:35]
    v_fmac_f32 v24, v40, v52
    v_fmac_f32 v25, v40, v53
    v_mfma_f32_16x16x32_bf16 v[32:35], a[16:19], a[244:247], v[32:35]
    v_fmac_f32 v26, v40, v54
    v_fmac_f32 v27, v40, v55
    v_mfma_f32_16x16x32_bf16 v[32:35], a[4:7], a[240:243], v[32:35]
    buffer_load_dwordx4 v1, s[40:43], 0 offen sc1 lds
    v_mul_f32 v76, v41, v16
    v_mfma_f32_16x16x32_bf16 v[36:39], a[8:11], a[240:243], 0
    v_permlane32_swap_b32 v24, v26
    v_mfma_f32_16x16x32_bf16 v[36:39], a[20:23], a[244:247], v[36:39]
    v_permlane32_swap_b32 v25, v27
    v_mfma_f32_16x16x32_bf16 v[36:39], a[32:35], a[248:251], v[36:39]
    v_exp_f32 v76, v76
    v_mfma_f32_16x16x32_bf16 v[36:39], a[44:47], a[252:255], v[36:39]
    s_waitcnt lgkmcnt(0)
    buffer_load_dwordx4 v1, s[40:43], 0 offen offset:1024 sc1 lds
    v_mul_f32 v77, v41, v17
    v_mfma_f32_16x16x32_bf16 v[36:39], a[56:59], v[60:63], v[36:39]
L_wp7:
    s_cbranch_execz L_wret1
    ds_read_b128 a[240:243], v56 offset:8192
    v_mul_f32 v78, v41, v18
    v_mfma_f32_16x16x32_bf16 v[36:39], a[68:71], v[64:67], v[36:39]
    v_exp_f32 v77, v77
    v_mfma_f32_16x16x32_bf16 v[36:39], a[80:83], v[68:71], v[36:39]
    ds_read_b128 a[244:247], v56 offset:9216
    v_mul_f32 v79, v41, v19
    v_mfma_f32_16x16x32_bf16 v[36:39], a[92:95], v[72:75], v[36:39]
    ds_read_b128 a[248:251], v56 offset:10240
    buffer_load_dwordx4 v1, s[40:43], 0 offen offset:2048 sc1 lds
    v_mfma_f32_16x16x32_bf16 v[32:35], a[88:91], v[72:75], v[32:35]
    ds_read_b128 a[252:255], v56 offset:11264
    v_mul_f32 v80, v41, v24
    v_mfma_f32_16x16x32_bf16 v[32:35], a[76:79], v[68:71], v[32:35]
    v_exp_f32 v78, v78
    v_mfma_f32_16x16x32_bf16 v[32:35], a[64:67], v[64:67], v[32:35]
    v_exp_f32 v79, v79
    v_mfma_f32_16x16x32_bf16 v[32:35], a[52:55], v[60:63], v[32:35]
    buffer_load_dwordx4 v1, s[40:43], 0 offen offset:3072 sc1 lds
    v_mul_f32 v81, v41, v25
    v_mfma_f32_16x16x32_bf16 v[28:31], a[48:51], v[60:63], v[28:31]
    v_exp_f32 v80, v80
    v_mfma_f32_16x16x32_bf16 v[28:31], a[60:63], v[64:67], v[28:31]
    v_exp_f32 v81, v81
    v_mfma_f32_16x16x32_bf16 v[28:31], a[72:75], v[68:71], v[28:31]
    v_fma_f32 v76, v76, v42, v42
    v_fma_f32 v77, v77, v42, v42
    v_mfma_f32_16x16x32_bf16 v[28:31], a[84:87], v[72:75], v[28:31]
    s_waitcnt lgkmcnt(0)
    s_addk_i32 m0, 4096
    v_fma_f32 v78, v78, v42, v42
    v_mfma_f32_16x16x32_bf16 v[28:31], a[96:99], a[240:243], v[28:31]
    ds_read_b128 v[60:63], v56 offset:12288
    v_fma_f32 v79, v79, v42, v42
    v_mfma_f32_16x16x32_bf16 v[28:31], a[108:111], a[244:247], v[28:31]
    buffer_load_dwordx4 v2, s[40:43], 0 offen sc1 lds
    v_fmac_f32 v20, v40, v48
    v_mfma_f32_16x16x32_bf16 v[28:31], a[120:123], a[248:251], v[28:31]
    ds_read_b128 v[64:67], v56 offset:13312
    v_fmac_f32 v21, v40, v49
    v_mfma_f32_16x16x32_bf16 v[28:31], a[132:135], a[252:255], v[28:31]
    ds_read_b128 v[68:71], v56 offset:14336
    v_fmac_f32 v22, v40, v50
    v_mfma_f32_16x16x32_bf16 v[32:35], a[136:139], a[252:255], v[32:35]
    ds_read_b128 v[72:75], v56 offset:15360
    v_fmac_f32 v23, v40, v51
    v_mfma_f32_16x16x32_bf16 v[32:35], a[124:127], a[248:251], v[32:35]
    s_add_u32 s64, s64, 40960
    v_rcp_f32 v76, v76
    v_mfma_f32_16x16x32_bf16 v[32:35], a[112:115], a[244:247], v[32:35]
    v_rcp_f32 v77, v77
    v_mfma_f32_16x16x32_bf16 v[32:35], a[100:103], a[240:243], v[32:35]
    buffer_load_dwordx4 v[136:139], v1, s[64:67], 0 offen sc1
    v_mul_f32 v82, v16, v20
    v_mfma_f32_16x16x32_bf16 v[36:39], a[104:107], a[240:243], v[36:39]
    v_rcp_f32 v78, v78
    v_mfma_f32_16x16x32_bf16 v[36:39], a[116:119], a[244:247], v[36:39]
    v_rcp_f32 v79, v79
    v_mfma_f32_16x16x32_bf16 v[36:39], a[128:131], a[248:251], v[36:39]
    v_mul_f32 v83, v17, v21
    v_mul_f32 v84, v18, v22
    v_mfma_f32_16x16x32_bf16 v[36:39], a[140:143], a[252:255], v[36:39]
    s_waitcnt lgkmcnt(0)
    buffer_load_dwordx4 v[140:143], v1, s[64:67], 0 offen offset:1024 sc1
    v_mul_f32 v85, v19, v23
    v_mfma_f32_16x16x32_bf16 v[36:39], a[152:155], v[60:63], v[36:39]
    ds_read_b128 a[240:243], v56 offset:16384
    v_fma_f32 v80, v80, v42, v42
    v_mfma_f32_16x16x32_bf16 v[36:39], a[164:167], v[64:67], v[36:39]
    v_rcp_f32 v80, v80
    v_mfma_f32_16x16x32_bf16 v[36:39], a[176:179], v[68:71], v[36:39]
    ds_read_b128 a[244:247], v56 offset:17408
    v_fma_f32 v81, v81, v42, v42
    v_mfma_f32_16x16x32_bf16 v[36:39], a[188:191], v[72:75], v[36:39]
    ds_read_b128 a[248:251], v56 offset:18432
    buffer_load_dwordx4 v[144:147], v1, s[64:67], 0 offen offset:2048 sc1
    v_mfma_f32_16x16x32_bf16 v[32:35], a[184:187], v[72:75], v[32:35]
    ds_read_b128 a[252:255], v56 offset:19456
    v_mul_f32 v82, v82, v76
    v_mfma_f32_16x16x32_bf16 v[32:35], a[172:175], v[68:71], v[32:35]
    v_rcp_f32 v81, v81
    v_mfma_f32_16x16x32_bf16 v[32:35], a[160:163], v[64:67], v[32:35]
    v_mul_f32 v83, v83, v77
    v_mul_f32 v84, v84, v78
    v_mfma_f32_16x16x32_bf16 v[32:35], a[148:151], v[60:63], v[32:35]
    buffer_load_dwordx4 v[148:151], v1, s[64:67], 0 offen offset:3072 sc1
    v_mul_f32 v85, v85, v79
    v_mfma_f32_16x16x32_bf16 v[28:31], a[144:147], v[60:63], v[28:31]
    v_cvt_pk_bf16_f32 v88, v82, v83
    v_cvt_pk_bf16_f32 v89, v84, v85
    v_mfma_f32_16x16x32_bf16 v[28:31], a[156:159], v[64:67], v[28:31]
    buffer_store_dwordx2 v[88:89], v57, s[32:35], 0 offen sc1
    v_mfma_f32_16x16x32_bf16 v[28:31], a[168:171], v[68:71], v[28:31]
    v_mul_f32 v86, v24, v26
    v_mul_f32 v87, v25, v27
    v_mfma_f32_16x16x32_bf16 v[28:31], a[180:183], v[72:75], v[28:31]
    s_waitcnt vmcnt(17) lgkmcnt(0)
    s_barrier
    buffer_load_dwordx4 v[152:155], v2, s[64:67], 0 offen sc1
    v_mfma_f32_16x16x32_bf16 v[28:31], a[192:195], a[240:243], v[28:31]
    ds_read_b128 v[60:63], v56 offset:20480
    v_mul_f32 v86, v86, v80
    v_mfma_f32_16x16x32_bf16 v[28:31], a[204:207], a[244:247], v[28:31]
    v_mul_f32 v87, v87, v81
    v_cvt_pk_bf16_f32 v90, v86, v87
    v_mfma_f32_16x16x32_bf16 v[28:31], a[216:219], a[248:251], v[28:31]
    buffer_store_dword v90, v58, s[32:35], 0 offen offset:512 sc1
    v_mfma_f32_16x16x32_bf16 v[28:31], a[228:231], a[252:255], v[28:31]
    ds_read_b128 v[64:67], v56 offset:21504
    v_mfma_f32_16x16x32_bf16 v[32:35], a[232:235], a[252:255], v[32:35]
    ds_read_b128 v[68:71], v56 offset:22528
    v_mfma_f32_16x16x32_bf16 v[32:35], a[220:223], a[248:251], v[32:35]
    ds_read_b128 v[72:75], v56 offset:23552
    v_mfma_f32_16x16x32_bf16 v[32:35], a[208:211], a[244:247], v[32:35]
    ds_read_b128 v[12:15], v59 offset:1280
    v_mfma_f32_16x16x32_bf16 v[32:35], a[196:199], a[240:243], v[32:35]
    v_mfma_f32_16x16x32_bf16 v[36:39], a[200:203], a[240:243], v[36:39]
    v_mfma_f32_16x16x32_bf16 v[36:39], a[212:215], a[244:247], v[36:39]
    v_mfma_f32_16x16x32_bf16 v[36:39], a[224:227], a[248:251], v[36:39]
    v_mfma_f32_16x16x32_bf16 v[36:39], a[236:239], a[252:255], v[36:39]
    s_waitcnt lgkmcnt(0)
    v_mfma_f32_16x16x32_bf16 v[16:19], a[0:3], v[60:63], 0
    s_add_u32 m0, s12, 0
    ds_read_b128 a[240:243], v56 offset:24576
    v_mfma_f32_16x16x32_bf16 v[16:19], a[12:15], v[64:67], v[16:19]
    s_sub_u32 s32, s32, 49152
    v_fmac_f32 v28, v12, v44
    v_fmac_f32 v29, v12, v45
    v_mfma_f32_16x16x32_bf16 v[16:19], a[24:27], v[68:71], v[16:19]
    ds_read_b128 a[244:247], v56 offset:25600
    v_fmac_f32 v30, v12, v46
    v_mfma_f32_16x16x32_bf16 v[16:19], a[36:39], v[72:75], v[16:19]
    s_sub_u32 s40, s40, 61440
    s_subb_u32 s41, s41, 0
    ds_read_b128 a[248:251], v56 offset:26624
    v_mfma_f32_16x16x32_bf16 v[20:23], a[40:43], v[72:75], 0
    ds_read_b128 a[252:255], v56 offset:27648
    v_fmac_f32 v31, v12, v47
    v_mfma_f32_16x16x32_bf16 v[20:23], a[28:31], v[68:71], v[20:23]
    v_fmac_f32 v36, v12, v52
    v_fmac_f32 v37, v12, v53
    v_mfma_f32_16x16x32_bf16 v[20:23], a[16:19], v[64:67], v[20:23]
    v_fmac_f32 v38, v12, v54
    v_fmac_f32 v39, v12, v55
    v_mfma_f32_16x16x32_bf16 v[20:23], a[4:7], v[60:63], v[20:23]
    buffer_load_dwordx4 v1, s[40:43], 0 offen sc1 lds
    v_mul_f32 v76, v13, v28
    v_mfma_f32_16x16x32_bf16 v[24:27], a[8:11], v[60:63], 0
    v_add_u32 v10, 1, v10
    v_mul_f32 v77, v13, v29
    v_mfma_f32_16x16x32_bf16 v[24:27], a[20:23], v[64:67], v[24:27]
    s_cmp_lg_u32 s62, 0
    s_waitcnt vmcnt(13)
    s_cbranch_scc1 L_slow2
    buffer_store_dword v10, v9, s[48:51], 0 offen
L_sigd2:
    v_mfma_f32_16x16x32_bf16 v[24:27], a[32:35], v[68:71], v[24:27]
    v_permlane32_swap_b32 v36, v38
    v_mfma_f32_16x16x32_bf16 v[24:27], a[44:47], v[72:75], v[24:27]
    s_waitcnt lgkmcnt(0)
    buffer_load_dwordx4 v1, s[40:43], 0 offen offset:1024 sc1 lds
    v_mul_f32 v78, v13, v30
    v_mfma_f32_16x16x32_bf16 v[24:27], a[56:59], a[240:243], v[24:27]
    ds_read_b128 v[60:63], v56 offset:28672
    v_mul_f32 v79, v13, v31
    v_mfma_f32_16x16x32_bf16 v[24:27], a[68:71], a[244:247], v[24:27]
    v_permlane32_swap_b32 v37, v39
    v_mfma_f32_16x16x32_bf16 v[24:27], a[80:83], a[248:251], v[24:27]
    ds_read_b128 v[64:67], v56 offset:29696
    v_mul_f32 v80, v13, v36
    v_mfma_f32_16x16x32_bf16 v[24:27], a[92:95], a[252:255], v[24:27]
    ds_read_b128 v[68:71], v56 offset:30720
    buffer_load_dwordx4 v1, s[40:43], 0 offen offset:2048 sc1 lds
    v_mfma_f32_16x16x32_bf16 v[20:23], a[88:91], a[252:255], v[20:23]
    ds_read_b128 v[72:75], v56 offset:31744
    v_mul_f32 v81, v13, v37
    v_mfma_f32_16x16x32_bf16 v[20:23], a[76:79], a[248:251], v[20:23]
    v_exp_f32 v76, v76
    v_mfma_f32_16x16x32_bf16 v[20:23], a[64:67], a[244:247], v[20:23]
    v_exp_f32 v77, v77
    v_mfma_f32_16x16x32_bf16 v[20:23], a[52:55], a[240:243], v[20:23]
    buffer_load_dwordx4 v1, s[40:43], 0 offen offset:3072 sc1 lds
    v_fma_f32 v76, v76, v14, v14
    v_mfma_f32_16x16x32_bf16 v[16:19], a[48:51], a[240:243], v[16:19]
    v_exp_f32 v78, v78
    v_mfma_f32_16x16x32_bf16 v[16:19], a[60:63], a[244:247], v[16:19]
    v_exp_f32 v79, v79
    v_mfma_f32_16x16x32_bf16 v[16:19], a[72:75], a[248:251], v[16:19]
    v_exp_f32 v80, v80
    v_mfma_f32_16x16x32_bf16 v[16:19], a[84:87], a[252:255], v[16:19]
    s_waitcnt lgkmcnt(0)
    s_addk_i32 m0, 4096
    v_fma_f32 v77, v77, v14, v14
    v_mfma_f32_16x16x32_bf16 v[16:19], a[96:99], v[60:63], v[16:19]
    ds_read_b128 a[240:243], v56 offset:32768
    v_fma_f32 v78, v78, v14, v14
    v_mfma_f32_16x16x32_bf16 v[16:19], a[108:111], v[64:67], v[16:19]
    buffer_load_dwordx4 v2, s[40:43], 0 offen sc1 lds
    v_fma_f32 v79, v79, v14, v14
    v_mfma_f32_16x16x32_bf16 v[16:19], a[120:123], v[68:71], v[16:19]
    ds_read_b128 a[244:247], v56 offset:33792
    v_fmac_f32 v32, v12, v48
    v_mfma_f32_16x16x32_bf16 v[16:19], a[132:135], v[72:75], v[16:19]
    ds_read_b128 a[248:251], v56 offset:34816
    v_fmac_f32 v33, v12, v49
    v_mfma_f32_16x16x32_bf16 v[20:23], a[136:139], v[72:75], v[20:23]
    ds_read_b128 a[252:255], v56 offset:35840
    v_fmac_f32 v34, v12, v50
    v_mfma_f32_16x16x32_bf16 v[20:23], a[124:127], v[68:71], v[20:23]
    s_add_u32 s64, s64, 40960
    v_exp_f32 v81, v81
    v_mfma_f32_16x16x32_bf16 v[20:23], a[112:115], v[64:67], v[20:23]
    s_lshl_b32 s75, s56, 4
    s_lshl_b64 s[86:87], 0xffff, s75
    v_fmac_f32 v35, v12, v51
    v_mfma_f32_16x16x32_bf16 v[20:23], a[100:103], v[60:63], v[20:23]
    buffer_load_dwordx4 v[116:119], v1, s[64:67], 0 offen sc1
    v_mul_f32 v82, v28, v32
    v_mfma_f32_16x16x32_bf16 v[24:27], a[104:107], v[60:63], v[24:27]
    v_rcp_f32 v76, v76
    v_mfma_f32_16x16x32_bf16 v[24:27], a[116:119], v[64:67], v[24:27]
    v_rcp_f32 v77, v77
    v_mfma_f32_16x16x32_bf16 v[24:27], a[128:131], v[68:71], v[24:27]
    v_rcp_f32 v78, v78
    v_mfma_f32_16x16x32_bf16 v[24:27], a[140:143], v[72:75], v[24:27]
    s_waitcnt lgkmcnt(0)
    buffer_load_dwordx4 v[120:123], v1, s[64:67], 0 offen offset:1024 sc1
    v_mul_f32 v83, v29, v33
    v_mfma_f32_16x16x32_bf16 v[24:27], a[152:155], a[240:243], v[24:27]
    ds_read_b128 v[60:63], v56 offset:36864
    v_mul_f32 v84, v30, v34
    v_mfma_f32_16x16x32_bf16 v[24:27], a[164:167], a[244:247], v[24:27]
    v_rcp_f32 v79, v79
    v_mfma_f32_16x16x32_bf16 v[24:27], a[176:179], a[248:251], v[24:27]
    ds_read_b128 v[64:67], v56 offset:37888
    v_mul_f32 v85, v31, v35
    v_mfma_f32_16x16x32_bf16 v[24:27], a[188:191], a[252:255], v[24:27]
    ds_read_b128 v[68:71], v56 offset:38912
    buffer_load_dwordx4 v[124:127], v1, s[64:67], 0 offen offset:2048 sc1
    v_mfma_f32_16x16x32_bf16 v[20:23], a[184:187], a[252:255], v[20:23]
    ds_read_b128 v[72:75], v56 offset:39936
    v_fma_f32 v80, v80, v14, v14
    v_mfma_f32_16x16x32_bf16 v[20:23], a[172:175], a[248:251], v[20:23]
    v_rcp_f32 v80, v80
    v_mfma_f32_16x16x32_bf16 v[20:23], a[160:163], a[244:247], v[20:23]
    v_fma_f32 v81, v81, v14, v14
    v_mul_f32 v82, v82, v76
    v_mfma_f32_16x16x32_bf16 v[20:23], a[148:151], a[240:243], v[20:23]
    buffer_load_dwordx4 v[128:131], v1, s[64:67], 0 offen offset:3072 sc1
    v_mul_f32 v83, v83, v77
    v_mfma_f32_16x16x32_bf16 v[16:19], a[144:147], a[240:243], v[16:19]
    v_rcp_f32 v81, v81
    v_mfma_f32_16x16x32_bf16 v[16:19], a[156:159], a[244:247], v[16:19]
    v_mul_f32 v84, v84, v78
    v_mul_f32 v85, v85, v79
    v_mfma_f32_16x16x32_bf16 v[16:19], a[168:171], a[248:251], v[16:19]
    v_cvt_pk_bf16_f32 v88, v82, v83
    v_cvt_pk_bf16_f32 v89, v84, v85
    v_mfma_f32_16x16x32_bf16 v[16:19], a[180:183], a[252:255], v[16:19]
    s_waitcnt vmcnt(17) lgkmcnt(0)
    s_barrier
    buffer_load_dwordx4 v[132:135], v2, s[64:67], 0 offen sc1
    v_mfma_f32_16x16x32_bf16 v[16:19], a[192:195], v[60:63], v[16:19]
    ds_read_b128 a[240:243], v56 offset:40960
    v_mul_f32 v86, v36, v38
    v_mfma_f32_16x16x32_bf16 v[16:19], a[204:207], v[64:67], v[16:19]
    buffer_store_dwordx2 v[88:89], v57, s[32:35], 0 offen sc1
    v_mfma_f32_16x16x32_bf16 v[16:19], a[216:219], v[68:71], v[16:19]
    ds_read_b128 a[244:247], v56 offset:41984
    v_mul_f32 v87, v37, v39
    v_mfma_f32_16x16x32_bf16 v[16:19], a[228:231], v[72:75], v[16:19]
    ds_read_b128 a[248:251], v56 offset:43008
    v_mul_f32 v86, v86, v80
    v_mfma_f32_16x16x32_bf16 v[20:23], a[232:235], v[72:75], v[20:23]
    ds_read_b128 a[252:255], v56 offset:44032
    v_mul_f32 v87, v87, v81
    v_mfma_f32_16x16x32_bf16 v[20:23], a[220:223], v[68:71], v[20:23]
    ds_read_b128 v[40:43], v59 offset:512
    v_cvt_pk_bf16_f32 v90, v86, v87
    v_mfma_f32_16x16x32_bf16 v[20:23], a[208:211], v[64:67], v[20:23]
    buffer_store_dword v90, v58, s[32:35], 0 offen offset:512 sc1
    v_mfma_f32_16x16x32_bf16 v[20:23], a[196:199], v[60:63], v[20:23]
    v_mfma_f32_16x16x32_bf16 v[24:27], a[200:203], v[60:63], v[24:27]
    v_mfma_f32_16x16x32_bf16 v[24:27], a[212:215], v[64:67], v[24:27]
    v_mfma_f32_16x16x32_bf16 v[24:27], a[224:227], v[68:71], v[24:27]
    v_mfma_f32_16x16x32_bf16 v[24:27], a[236:239], v[72:75], v[24:27]
    s_waitcnt lgkmcnt(0)
    v_mfma_f32_16x16x32_bf16 v[28:31], a[0:3], a[240:243], 0
    s_add_u32 m0, s12, 20480
    ds_read_b128 v[60:63], v56 offset:45056
    v_mfma_f32_16x16x32_bf16 v[28:31], a[12:15], a[244:247], v[28:31]
    s_sub_u32 s32, s32, 49152
    v_fmac_f32 v16, v40, v44
    v_fmac_f32 v17, v40, v45
    v_mfma_f32_16x16x32_bf16 v[28:31], a[24:27], a[248:251], v[28:31]
    ds_read_b128 v[64:67], v56 offset:46080
    v_fmac_f32 v18, v40, v46
    v_mfma_f32_16x16x32_bf16 v[28:31], a[36:39], a[252:255], v[28:31]
    s_add_u32 s40, s40, 81920
    s_addc_u32 s41, s41, 0
    ds_read_b128 v[68:71], v56 offset:47104
    v_mfma_f32_16x16x32_bf16 v[32:35], a[40:43], a[252:255], 0
    ds_read_b128 v[72:75], v56 offset:48128
    v_fmac_f32 v19, v40, v47
    v_mfma_f32_16x16x32_bf16 v[32:35], a[28:31], a[248:251], v[32:35]
    v_fmac_f32 v24, v40, v52
    v_fmac_f32 v25, v40, v53
    v_mfma_f32_16x16x32_bf16 v[32:35], a[16:19], a[244:247], v[32:35]
    v_fmac_f32 v26, v40, v54
    v_fmac_f32 v27, v40, v55
    v_mfma_f32_16x16x32_bf16 v[32:35], a[4:7], a[240:243], v[32:35]
    buffer_load_dwordx4 v1, s[40:43], 0 offen sc1 lds
    v_mul_f32 v76, v41, v16
    v_mfma_f32_16x16x32_bf16 v[36:39], a[8:11], a[240:243], 0
    v_permlane32_swap_b32 v24, v26
    v_mfma_f32_16x16x32_bf16 v[36:39], a[20:23], a[244:247], v[36:39]
    v_permlane32_swap_b32 v25, v27
    v_mfma_f32_16x16x32_bf16 v[36:39], a[32:35], a[248:251], v[36:39]
    v_exp_f32 v76, v76
    v_mfma_f32_16x16x32_bf16 v[36:39], a[44:47], a[252:255], v[36:39]
    s_waitcnt lgkmcnt(0)
    buffer_load_dwordx4 v1, s[40:43], 0 offen offset:1024 sc1 lds
    v_mul_f32 v77, v41, v17
    v_mfma_f32_16x16x32_bf16 v[36:39], a[56:59], v[60:63], v[36:39]
    ds_read_b128 a[240:243], v56 offset:49152
    v_mul_f32 v78, v41, v18
    v_mfma_f32_16x16x32_bf16 v[36:39], a[68:71], v[64:67], v[36:39]
    v_exp_f32 v77, v77
    v_mfma_f32_16x16x32_bf16 v[36:39], a[80:83], v[68:71], v[36:39]
    ds_read_b128 a[244:247], v56 offset:50176
    v_mul_f32 v79, v41, v19
    v_mfma_f32_16x16x32_bf16 v[36:39], a[92:95], v[72:75], v[36:39]
    ds_read_b128 a[248:251], v56 offset:51200
    buffer_load_dwordx4 v1, s[40:43], 0 offen offset:2048 sc1 lds
    v_mfma_f32_16x16x32_bf16 v[32:35], a[88:91], v[72:75], v[32:35]
    ds_read_b128 a[252:255], v56 offset:52224
    v_mul_f32 v80, v41, v24
    v_mfma_f32_16x16x32_bf16 v[32:35], a[76:79], v[68:71], v[32:35]
    v_exp_f32 v78, v78
    v_mfma_f32_16x16x32_bf16 v[32:35], a[64:67], v[64:67], v[32:35]
    v_exp_f32 v79, v79
    v_mfma_f32_16x16x32_bf16 v[32:35], a[52:55], v[60:63], v[32:35]
    buffer_load_dwordx4 v1, s[40:43], 0 offen offset:3072 sc1 lds
    v_mul_f32 v81, v41, v25
    v_mfma_f32_16x16x32_bf16 v[28:31], a[48:51], v[60:63], v[28:31]
    v_exp_f32 v80, v80
    v_mfma_f32_16x16x32_bf16 v[28:31], a[60:63], v[64:67], v[28:31]
    v_exp_f32 v81, v81
    v_mfma_f32_16x16x32_bf16 v[28:31], a[72:75], v[68:71], v[28:31]
    v_fma_f32 v76, v76, v42, v42
    v_fma_f32 v77, v77, v42, v42
    v_mfma_f32_16x16x32_bf16 v[28:31], a[84:87], v[72:75], v[28:31]
    s_waitcnt lgkmcnt(0)
    s_addk_i32 m0, 4096
    v_fma_f32 v78, v78, v42, v42
    v_mfma_f32_16x16x32_bf16 v[28:31], a[96:99], a[240:243], v[28:31]
    ds_read_b128 v[60:63], v56 offset:53248
    v_fma_f32 v79, v79, v42, v42
    v_mfma_f32_16x16x32_bf16 v[28:31], a[108:111], a[244:247], v[28:31]
    buffer_load_dwordx4 v2, s[40:43], 0 offen sc1 lds
    v_fmac_f32 v20, v40, v48
    v_mfma_f32_16x16x32_bf16 v[28:31], a[120:123], a[248:251], v[28:31]
    ds_read_b128 v[64:67], v56 offset:54272
    v_fmac_f32 v21, v40, v49
    v_mfma_f32_16x16x32_bf16 v[28:31], a[132:135], a[252:255], v[28:31]
    ds_read_b128 v[68:71], v56 offset:55296
    v_fmac_f32 v22, v40, v50
    v_mfma_f32_16x16x32_bf16 v[32:35], a[136:139], a[252:255], v[32:35]
    ds_read_b128 v[72:75], v56 offset:56320
    v_fmac_f32 v23, v40, v51
    v_mfma_f32_16x16x32_bf16 v[32:35], a[124:127], a[248:251], v[32:35]
    s_add_u32 s64, s64, 40960
    v_rcp_f32 v76, v76
    v_mfma_f32_16x16x32_bf16 v[32:35], a[112:115], a[244:247], v[32:35]
    buffer_load_dword v91, v11, s[48:51], 0 offen sc1
    v_mul_f32 v82, v16, v20
    v_mfma_f32_16x16x32_bf16 v[32:35], a[100:103], a[240:243], v[32:35]
    buffer_load_dwordx4 v[96:99], v1, s[64:67], 0 offen sc1
    v_mul_f32 v83, v17, v21
    v_mfma_f32_16x16x32_bf16 v[36:39], a[104:107], a[240:243], v[36:39]
    v_rcp_f32 v77, v77
    v_mfma_f32_16x16x32_bf16 v[36:39], a[116:119], a[244:247], v[36:39]
    v_rcp_f32 v78, v78
    v_mfma_f32_16x16x32_bf16 v[36:39], a[128:131], a[248:251], v[36:39]
    v_rcp_f32 v79, v79
    v_mfma_f32_16x16x32_bf16 v[36:39], a[140:143], a[252:255], v[36:39]
    s_waitcnt lgkmcnt(0)
    buffer_load_dwordx4 v[100:103], v1, s[64:67], 0 offen offset:1024 sc1
    v_mul_f32 v84, v18, v22
    v_mfma_f32_16x16x32_bf16 v[36:39], a[152:155], v[60:63], v[36:39]
    ds_read_b128 a[240:243], v56 offset:57344
    v_mul_f32 v85, v19, v23
    v_mfma_f32_16x16x32_bf16 v[36:39], a[164:167], v[64:67], v[36:39]
    v_fma_f32 v80, v80, v42, v42
    v_fma_f32 v81, v81, v42, v42
    v_mfma_f32_16x16x32_bf16 v[36:39], a[176:179], v[68:71], v[36:39]
    ds_read_b128 a[244:247], v56 offset:58368
    v_mul_f32 v82, v82, v76
    v_mfma_f32_16x16x32_bf16 v[36:39], a[188:191], v[72:75], v[36:39]
    ds_read_b128 a[248:251], v56 offset:59392
    buffer_load_dwordx4 v[104:107], v1, s[64:67], 0 offen offset:2048 sc1
    v_mfma_f32_16x16x32_bf16 v[32:35], a[184:187], v[72:75], v[32:35]
    ds_read_b128 a[252:255], v56 offset:60416
    v_mul_f32 v83, v83, v77
    v_mfma_f32_16x16x32_bf16 v[32:35], a[172:175], v[68:71], v[32:35]
    v_rcp_f32 v80, v80
    v_mfma_f32_16x16x32_bf16 v[32:35], a[160:163], v[64:67], v[32:35]
    v_rcp_f32 v81, v81
    v_mfma_f32_16x16x32_bf16 v[32:35], a[148:151], v[60:63], v[32:35]
    buffer_load_dwordx4 v[108:111], v1, s[64:67], 0 offen offset:3072 sc1
    v_mul_f32 v84, v84, v78
    v_mfma_f32_16x16x32_bf16 v[28:31], a[144:147], v[60:63], v[28:31]
    v_mul_f32 v85, v85, v79
    v_cvt_pk_bf16_f32 v88, v82, v83
    v_mfma_f32_16x16x32_bf16 v[28:31], a[156:159], v[64:67], v[28:31]
    v_cvt_pk_bf16_f32 v89, v84, v85
    v_mul_f32 v86, v24, v26
    v_mfma_f32_16x16x32_bf16 v[28:31], a[168:171], v[68:71], v[28:31]
    buffer_store_dwordx2 v[88:89], v57, s[32:35], 0 offen nt
    v_mfma_f32_16x16x32_bf16 v[28:31], a[180:183], v[72:75], v[28:31]
    s_waitcnt vmcnt(18) lgkmcnt(0)
    s_barrier
    buffer_load_dwordx4 v[112:115], v2, s[64:67], 0 offen sc1
    v_mfma_f32_16x16x32_bf16 v[28:31], a[192:195], a[240:243], v[28:31]
    ds_read_b128 v[60:63], v56
    v_mul_f32 v87, v25, v27
    v_mfma_f32_16x16x32_bf16 v[28:31], a[204:207], a[244:247], v[28:31]
    v_mul_f32 v86, v86, v80
    v_mul_f32 v87, v87, v81
    v_mfma_f32_16x16x32_bf16 v[28:31], a[216:219], a[248:251], v[28:31]
    ds_read_b128 v[64:67], v56 offset:1024
    v_cvt_pk_bf16_f32 v90, v86, v87
    v_mfma_f32_16x16x32_bf16 v[28:31], a[228:231], a[252:255], v[28:31]
    buffer_store_dword v90, v58, s[32:35], 0 offen offset:512 nt
    v_mfma_f32_16x16x32_bf16 v[32:35], a[232:235], a[252:255], v[32:35]
    ds_read_b128 v[68:71], v56 offset:2048
    v_mfma_f32_16x16x32_bf16 v[32:35], a[220:223], a[248:251], v[32:35]
    ds_read_b128 v[72:75], v56 offset:3072
    v_mfma_f32_16x16x32_bf16 v[32:35], a[208:211], a[244:247], v[32:35]
    ds_read_b128 v[12:15], v59 offset:1536
    v_mfma_f32_16x16x32_bf16 v[32:35], a[196:199], a[240:243], v[32:35]
    v_mfma_f32_16x16x32_bf16 v[36:39], a[200:203], a[240:243], v[36:39]
    v_mfma_f32_16x16x32_bf16 v[36:39], a[212:215], a[244:247], v[36:39]
    v_mfma_f32_16x16x32_bf16 v[36:39], a[224:227], a[248:251], v[36:39]
    v_mfma_f32_16x16x32_bf16 v[36:39], a[236:239], a[252:255], v[36:39]
    s_waitcnt lgkmcnt(0)
    v_mfma_f32_16x16x32_bf16 v[16:19], a[0:3], v[60:63], 0
    s_add_u32 m0, s9, 0
    ds_read_b128 a[240:243], v56 offset:4096
    v_mfma_f32_16x16x32_bf16 v[16:19], a[12:15], v[64:67], v[16:19]
    s_sub_u32 s32, s32, 49152
    v_fmac_f32 v28, v12, v44
    v_fmac_f32 v29, v12, v45
    v_mfma_f32_16x16x32_bf16 v[16:19], a[24:27], v[68:71], v[16:19]
    ds_read_b128 a[244:247], v56 offset:5120
    v_fmac_f32 v30, v12, v46
    v_mfma_f32_16x16x32_bf16 v[16:19], a[36:39], v[72:75], v[16:19]
    ds_read_b128 a[248:251], v56 offset:6144
    v_fmac_f32 v31, v12, v47
    v_mfma_f32_16x16x32_bf16 v[20:23], a[40:43], v[72:75], 0
    s_add_u32 s64, s64, 40960
    ds_read_b128 a[252:255], v56 offset:7168
    v_fmac_f32 v36, v12, v52
    v_mfma_f32_16x16x32_bf16 v[20:23], a[28:31], v[68:71], v[20:23]
    v_fmac_f32 v37, v12, v53
    v_fmac_f32 v38, v12, v54
    v_mfma_f32_16x16x32_bf16 v[20:23], a[16:19], v[64:67], v[20:23]
    v_fmac_f32 v39, v12, v55
    v_mul_f32 v76, v13, v28
    v_mfma_f32_16x16x32_bf16 v[20:23], a[4:7], v[60:63], v[20:23]
    v_permlane32_swap_b32 v36, v38
    v_mfma_f32_16x16x32_bf16 v[24:27], a[8:11], v[60:63], 0
    buffer_load_dwordx4 v1, s[64:67], 0 offen sc1 lds
    v_add_u32 v10, 1, v10
    v_mfma_f32_16x16x32_bf16 v[24:27], a[20:23], v[64:67], v[24:27]
    s_cmp_lg_u32 s62, 0
    s_waitcnt vmcnt(14)
    s_cbranch_scc1 L_slow3
    buffer_store_dword v10, v9, s[48:51], 0 offen
L_sigd3:
    v_mfma_f32_16x16x32_bf16 v[24:27], a[32:35], v[68:71], v[24:27]
    v_permlane32_swap_b32 v37, v39
    v_mfma_f32_16x16x32_bf16 v[24:27], a[44:47], v[72:75], v[24:27]
    s_waitcnt lgkmcnt(0)
    v_exp_f32 v76, v76
    v_mfma_f32_16x16x32_bf16 v[24:27], a[56:59], a[240:243], v[24:27]
    ds_read_b128 v[60:63], v56 offset:8192
    v_mul_f32 v77, v13, v29
    v_mfma_f32_16x16x32_bf16 v[24:27], a[68:71], a[244:247], v[24:27]
    v_exp_f32 v77, v77
    v_mfma_f32_16x16x32_bf16 v[24:27], a[80:83], a[248:251], v[24:27]
    ds_read_b128 v[64:67], v56 offset:9216
    v_mul_f32 v78, v13, v30
    v_mfma_f32_16x16x32_bf16 v[24:27], a[92:95], a[252:255], v[24:27]
    ds_read_b128 v[68:71], v56 offset:10240
    v_mul_f32 v79, v13, v31
    v_mfma_f32_16x16x32_bf16 v[20:23], a[88:91], a[252:255], v[20:23]
    ds_read_b128 v[72:75], v56 offset:11264
    buffer_load_dwordx4 v1, s[64:67], 0 offen offset:1024 sc1 lds
    v_mfma_f32_16x16x32_bf16 v[20:23], a[76:79], a[248:251], v[20:23]
    v_exp_f32 v78, v78
    v_mfma_f32_16x16x32_bf16 v[20:23], a[64:67], a[244:247], v[20:23]
    v_exp_f32 v79, v79
    v_mfma_f32_16x16x32_bf16 v[20:23], a[52:55], a[240:243], v[20:23]
    v_mul_f32 v80, v13, v36
    v_mul_f32 v81, v13, v37
    v_mfma_f32_16x16x32_bf16 v[16:19], a[48:51], a[240:243], v[16:19]
    s_waitcnt vmcnt(10)
    v_exp_f32 v80, v80
    v_mfma_f32_16x16x32_bf16 v[16:19], a[60:63], a[244:247], v[16:19]
    v_subrev_u32 v91, s60, v91
    v_fma_f32 v76, v76, v14, v14
    v_mfma_f32_16x16x32_bf16 v[16:19], a[72:75], a[248:251], v[16:19]
    v_cmp_gt_u32 vcc, 3, v91
    v_fma_f32 v77, v77, v14, v14
    v_mfma_f32_16x16x32_bf16 v[16:19], a[84:87], a[252:255], v[16:19]
    s_waitcnt lgkmcnt(0)
    v_exp_f32 v81, v81
    v_mfma_f32_16x16x32_bf16 v[16:19], a[96:99], v[60:63], v[16:19]
    s_and_b64 vcc, vcc, s[86:87]
    ds_read_b128 a[240:243], v56 offset:12288
    buffer_load_dwordx4 v1, s[64:67], 0 offen offset:2048 sc1 lds
    v_mfma_f32_16x16x32_bf16 v[16:19], a[108:111], v[64:67], v[16:19]
    s_or_b64 vcc, vcc, s[62:63]
    s_cbranch_scc1 L_late2
L_go2:
    v_mfma_f32_16x16x32_bf16 v[16:19], a[120:123], v[68:71], v[16:19]
    s_add_u32 s75, s11, 294912
    ds_read_b128 a[244:247], v56 offset:13312
    v_fma_f32 v78, v78, v14, v14
    v_mfma_f32_16x16x32_bf16 v[16:19], a[132:135], v[72:75], v[16:19]
    ds_read_b128 a[248:251], v56 offset:14336
    v_fma_f32 v79, v79, v14, v14
    v_mfma_f32_16x16x32_bf16 v[20:23], a[136:139], v[72:75], v[20:23]
    ds_read_b128 a[252:255], v56 offset:15360
    v_fmac_f32 v32, v12, v48
    v_mfma_f32_16x16x32_bf16 v[20:23], a[124:127], v[68:71], v[20:23]
    buffer_load_dword v91, v0, s[48:51], s75 offen sc1
    v_mfma_f32_16x16x32_bf16 v[20:23], a[112:115], v[64:67], v[20:23]
    v_rcp_f32 v76, v76
    v_mfma_f32_16x16x32_bf16 v[20:23], a[100:103], v[60:63], v[20:23]
    v_rcp_f32 v77, v77
    v_mfma_f32_16x16x32_bf16 v[24:27], a[104:107], v[60:63], v[24:27]
    buffer_load_dwordx4 v1, s[64:67], 0 offen offset:3072 sc1 lds
    v_fmac_f32 v33, v12, v49
    v_mfma_f32_16x16x32_bf16 v[24:27], a[116:119], v[64:67], v[24:27]
    v_rcp_f32 v78, v78
    v_mfma_f32_16x16x32_bf16 v[24:27], a[128:131], v[68:71], v[24:27]
    v_rcp_f32 v79, v79
    v_mfma_f32_16x16x32_bf16 v[24:27], a[140:143], v[72:75], v[24:27]
    s_waitcnt lgkmcnt(0)
    v_fmac_f32 v34, v12, v50
    v_fmac_f32 v35, v12, v51
    v_mfma_f32_16x16x32_bf16 v[24:27], a[152:155], a[240:243], v[24:27]
    ds_read_b128 v[60:63], v56 offset:16384
    v_mul_f32 v82, v28, v32
    v_mfma_f32_16x16x32_bf16 v[24:27], a[164:167], a[244:247], v[24:27]
    v_mul_f32 v83, v29, v33
    v_mul_f32 v84, v30, v34
    v_mfma_f32_16x16x32_bf16 v[24:27], a[176:179], a[248:251], v[24:27]
    ds_read_b128 v[64:67], v56 offset:17408
    v_mul_f32 v85, v31, v35
    v_mfma_f32_16x16x32_bf16 v[24:27], a[188:191], a[252:255], v[24:27]
    ds_read_b128 v[68:71], v56 offset:18432
    v_fma_f32 v80, v80, v14, v14
    v_mfma_f32_16x16x32_bf16 v[20:23], a[184:187], a[252:255], v[20:23]
    s_addk_i32 m0, 4096
    ds_read_b128 v[72:75], v56 offset:19456
    v_fma_f32 v81, v81, v14, v14
    v_mfma_f32_16x16x32_bf16 v[20:23], a[172:175], a[248:251], v[20:23]
    v_rcp_f32 v80, v80
    v_mfma_f32_16x16x32_bf16 v[20:23], a[160:163], a[244:247], v[20:23]
    v_rcp_f32 v81, v81
    v_mfma_f32_16x16x32_bf16 v[20:23], a[148:151], a[240:243], v[20:23]
    v_mul_f32 v82, v82, v76
    v_mul_f32 v83, v83, v77
    v_mfma_f32_16x16x32_bf16 v[16:19], a[144:147], a[240:243], v[16:19]
    buffer_load_dwordx4 v2, s[64:67], 0 offen sc1 lds
    v_mul_f32 v84, v84, v78
    v_mfma_f32_16x16x32_bf16 v[16:19], a[156:159], a[244:247], v[16:19]
    v_mul_f32 v85, v85, v79
    v_cvt_pk_bf16_f32 v88, v82, v83
    v_mfma_f32_16x16x32_bf16 v[16:19], a[168:171], a[248:251], v[16:19]
    v_cvt_pk_bf16_f32 v89, v84, v85
    v_mul_f32 v86, v36, v38
    v_mfma_f32_16x16x32_bf16 v[16:19], a[180:183], a[252:255], v[16:19]
    s_waitcnt lgkmcnt(0)
    s_barrier
    v_mul_f32 v87, v37, v39
    v_mfma_f32_16x16x32_bf16 v[16:19], a[192:195], v[60:63], v[16:19]
    ds_read_b128 a[240:243], v56 offset:20480
    v_mul_f32 v86, v86, v80
    v_mfma_f32_16x16x32_bf16 v[16:19], a[204:207], v[64:67], v[16:19]
    buffer_store_dwordx2 v[88:89], v57, s[32:35], 0 offen nt
    v_mfma_f32_16x16x32_bf16 v[16:19], a[216:219], v[68:71], v[16:19]
    ds_read_b128 a[244:247], v56 offset:21504
    v_mul_f32 v87, v87, v81
    v_mfma_f32_16x16x32_bf16 v[16:19], a[228:231], v[72:75], v[16:19]
    ds_read_b128 a[248:251], v56 offset:22528
    v_cvt_pk_bf16_f32 v90, v86, v87
    v_mfma_f32_16x16x32_bf16 v[20:23], a[232:235], v[72:75], v[20:23]
    buffer_store_dword v90, v58, s[32:35], 0 offen offset:512 nt
    v_mfma_f32_16x16x32_bf16 v[20:23], a[220:223], v[68:71], v[20:23]
    ds_read_b128 a[252:255], v56 offset:23552
    v_mfma_f32_16x16x32_bf16 v[20:23], a[208:211], v[64:67], v[20:23]
    ds_read_b128 v[40:43], v59 offset:768
    v_mfma_f32_16x16x32_bf16 v[20:23], a[196:199], v[60:63], v[20:23]
    v_mfma_f32_16x16x32_bf16 v[24:27], a[200:203], v[60:63], v[24:27]
    v_mfma_f32_16x16x32_bf16 v[24:27], a[212:215], v[64:67], v[24:27]
    v_mfma_f32_16x16x32_bf16 v[24:27], a[224:227], v[68:71], v[24:27]
    v_mfma_f32_16x16x32_bf16 v[24:27], a[236:239], v[72:75], v[24:27]
    s_waitcnt lgkmcnt(0)
    v_mfma_f32_16x16x32_bf16 v[28:31], a[0:3], a[240:243], 0
    ds_read_b128 v[60:63], v56 offset:24576
    buffer_load_dword v91, v11, s[48:51], 0 offen sc1
    v_mfma_f32_16x16x32_bf16 v[28:31], a[12:15], a[244:247], v[28:31]
    s_sub_u32 s32, s32, 49152
    v_fmac_f32 v16, v40, v44
    v_fmac_f32 v17, v40, v45
    v_mfma_f32_16x16x32_bf16 v[28:31], a[24:27], a[248:251], v[28:31]
L_wp8:
    s_cbranch_execz L_wret1
    ds_read_b128 v[64:67], v56 offset:25600
    v_fmac_f32 v18, v40, v46
    v_mfma_f32_16x16x32_bf16 v[28:31], a[36:39], a[252:255], v[28:31]
    ds_read_b128 v[68:71], v56 offset:26624
    v_fmac_f32 v19, v40, v47
    v_mfma_f32_16x16x32_bf16 v[32:35], a[40:43], a[252:255], 0
    ds_read_b128 v[72:75], v56 offset:27648
    v_fmac_f32 v24, v40, v52
    v_mfma_f32_16x16x32_bf16 v[32:35], a[28:31], a[248:251], v[32:35]
    v_fmac_f32 v25, v40, v53
    v_fmac_f32 v26, v40, v54
    v_mfma_f32_16x16x32_bf16 v[32:35], a[16:19], a[244:247], v[32:35]
    v_fmac_f32 v27, v40, v55
    v_mul_f32 v76, v41, v16
    v_mfma_f32_16x16x32_bf16 v[32:35], a[4:7], a[240:243], v[32:35]
    v_permlane32_swap_b32 v24, v26
    v_mfma_f32_16x16x32_bf16 v[36:39], a[8:11], a[240:243], 0
    v_permlane32_swap_b32 v25, v27
    v_mfma_f32_16x16x32_bf16 v[36:39], a[20:23], a[244:247], v[36:39]
    v_exp_f32 v76, v76
    v_mfma_f32_16x16x32_bf16 v[36:39], a[32:35], a[248:251], v[36:39]
    v_mul_f32 v77, v41, v17
    v_mul_f32 v78, v41, v18
    v_mfma_f32_16x16x32_bf16 v[36:39], a[44:47], a[252:255], v[36:39]
    s_waitcnt lgkmcnt(0)
    v_exp_f32 v77, v77
    v_mfma_f32_16x16x32_bf16 v[36:39], a[56:59], v[60:63], v[36:39]
    s_add_u32 s36, s36, 297984
    ds_read_b128 a[240:243], v56 offset:28672
    v_mul_f32 v79, v41, v19
    v_mfma_f32_16x16x32_bf16 v[36:39], a[68:71], v[64:67], v[36:39]
    v_exp_f32 v78, v78
    v_mfma_f32_16x16x32_bf16 v[36:39], a[80:83], v[68:71], v[36:39]
    ds_read_b128 a[244:247], v56 offset:29696
    buffer_load_dwordx4 a[0:3], v1, s[36:39], 0 offen sc1
    v_mfma_f32_16x16x32_bf16 v[36:39], a[92:95], v[72:75], v[36:39]
    ds_read_b128 a[248:251], v56 offset:30720
    v_mul_f32 v80, v41, v24
    v_mfma_f32_16x16x32_bf16 v[32:35], a[88:91], v[72:75], v[32:35]
    ds_read_b128 a[252:255], v56 offset:31744
    v_mul_f32 v81, v41, v25
    v_mfma_f32_16x16x32_bf16 v[32:35], a[76:79], v[68:71], v[32:35]
    v_exp_f32 v79, v79
    v_mfma_f32_16x16x32_bf16 v[32:35], a[64:67], v[64:67], v[32:35]
    v_exp_f32 v80, v80
    v_mfma_f32_16x16x32_bf16 v[32:35], a[52:55], v[60:63], v[32:35]
    buffer_load_dwordx4 a[4:7], v1, s[36:39], 0 offen offset:1024 sc1
    v_fma_f32 v76, v76, v42, v42
    v_mfma_f32_16x16x32_bf16 v[28:31], a[48:51], v[60:63], v[28:31]
    v_exp_f32 v81, v81
    v_mfma_f32_16x16x32_bf16 v[28:31], a[60:63], v[64:67], v[28:31]
    v_rcp_f32 v76, v76
    v_mfma_f32_16x16x32_bf16 v[28:31], a[72:75], v[68:71], v[28:31]
    v_fma_f32 v77, v77, v42, v42
    v_fma_f32 v78, v78, v42, v42
    v_mfma_f32_16x16x32_bf16 v[28:31], a[84:87], v[72:75], v[28:31]
    s_waitcnt lgkmcnt(0)
    v_rcp_f32 v77, v77
    v_mfma_f32_16x16x32_bf16 v[28:31], a[96:99], a[240:243], v[28:31]
    ds_read_b128 v[60:63], v56 offset:32768
    buffer_load_dwordx4 a[8:11], v1, s[36:39], 0 offen offset:2048 sc1
    v_mfma_f32_16x16x32_bf16 v[28:31], a[108:111], a[244:247], v[28:31]
    v_rcp_f32 v78, v78
    v_mfma_f32_16x16x32_bf16 v[28:31], a[120:123], a[248:251], v[28:31]
    ds_read_b128 v[64:67], v56 offset:33792
    v_fma_f32 v79, v79, v42, v42
    v_mfma_f32_16x16x32_bf16 v[28:31], a[132:135], a[252:255], v[28:31]
    ds_read_b128 v[68:71], v56 offset:34816
    v_fmac_f32 v20, v40, v48
    v_mfma_f32_16x16x32_bf16 v[32:35], a[136:139], a[252:255], v[32:35]
    ds_read_b128 v[72:75], v56 offset:35840
    v_add_u32 v10, 1, v10
    v_mfma_f32_16x16x32_bf16 v[32:35], a[124:127], a[248:251], v[32:35]
    buffer_load_dwordx4 a[12:15], v1, s[36:39], 0 offen offset:3072 sc1
    v_fmac_f32 v21, v40, v49
    v_mfma_f32_16x16x32_bf16 v[32:35], a[112:115], a[244:247], v[32:35]
    s_cmp_lg_u32 s62, 0
    s_waitcnt vmcnt(5)
    s_cbranch_scc1 L_slow4
    buffer_store_dword v10, v9, s[48:51], 0 offen
L_sigd4:
    v_mfma_f32_16x16x32_bf16 v[32:35], a[100:103], a[240:243], v[32:35]
    v_rcp_f32 v79, v79
    v_mfma_f32_16x16x32_bf16 v[36:39], a[104:107], a[240:243], v[36:39]
    v_fmac_f32 v22, v40, v50
    v_fmac_f32 v23, v40, v51
    v_mfma_f32_16x16x32_bf16 v[36:39], a[116:119], a[244:247], v[36:39]
    v_mul_f32 v82, v16, v20
    v_mul_f32 v83, v17, v21
    v_mfma_f32_16x16x32_bf16 v[36:39], a[128:131], a[248:251], v[36:39]
    s_waitcnt vmcnt(5)
    buffer_load_dwordx4 a[16:19], v2, s[36:39], 0 offen sc1
    v_mul_f32 v84, v18, v22
    v_mfma_f32_16x16x32_bf16 v[36:39], a[140:143], a[252:255], v[36:39]
    s_waitcnt lgkmcnt(0)
    v_subrev_u32 v91, s60, v91
    v_mul_f32 v85, v19, v23
    v_mfma_f32_16x16x32_bf16 v[36:39], a[152:155], v[60:63], v[36:39]
    ds_read_b128 a[240:243], v56 offset:36864
    v_cmp_gt_u32 vcc, 4, v91
    v_mfma_f32_16x16x32_bf16 v[36:39], a[164:167], v[64:67], v[36:39]
    v_fma_f32 v80, v80, v42, v42
    v_fma_f32 v81, v81, v42, v42
    v_mfma_f32_16x16x32_bf16 v[36:39], a[176:179], v[68:71], v[36:39]
    s_and_b64 vcc, vcc, s[86:87]
    ds_read_b128 a[244:247], v56 offset:37888
    v_mul_f32 v82, v82, v76
    v_mfma_f32_16x16x32_bf16 v[36:39], a[188:191], v[72:75], v[36:39]
    ds_read_b128 a[248:251], v56 offset:38912
    buffer_load_dwordx4 a[20:23], v2, s[36:39], 0 offen offset:1024 sc1
    v_mfma_f32_16x16x32_bf16 v[32:35], a[184:187], v[72:75], v[32:35]
    ds_read_b128 a[252:255], v56 offset:39936
    v_mul_f32 v83, v83, v77
    v_mfma_f32_16x16x32_bf16 v[32:35], a[172:175], v[68:71], v[32:35]
    s_or_b64 vcc, vcc, s[62:63]
    s_cbranch_scc1 L_late3
L_go3:
    v_mfma_f32_16x16x32_bf16 v[32:35], a[160:163], v[64:67], v[32:35]
    s_add_u32 s75, s11, 196608
    buffer_load_dword v91, v0, s[48:51], s75 offen sc1
    v_mfma_f32_16x16x32_bf16 v[32:35], a[148:151], v[60:63], v[32:35]
    ds_read_b128 a[96:99], v4
    v_mul_f32 v84, v84, v78
    v_mfma_f32_16x16x32_bf16 v[28:31], a[144:147], v[60:63], v[28:31]
    buffer_load_dwordx4 a[24:27], v2, s[36:39], 0 offen offset:2048 sc1
    ds_read_b128 a[100:103], v4 offset:1024
    v_mfma_f32_16x16x32_bf16 v[28:31], a[156:159], v[64:67], v[28:31]
    ds_read_b128 a[104:107], v4 offset:2048
    v_mul_f32 v85, v85, v79
    v_mfma_f32_16x16x32_bf16 v[28:31], a[168:171], v[68:71], v[28:31]
    ds_read_b128 a[108:111], v4 offset:3072
    v_cvt_pk_bf16_f32 v88, v82, v83
    v_mfma_f32_16x16x32_bf16 v[28:31], a[180:183], v[72:75], v[28:31]
    s_waitcnt lgkmcnt(4)
    s_barrier
    ds_read_b128 a[112:115], v4 offset:4096
    v_mfma_f32_16x16x32_bf16 v[28:31], a[192:195], a[240:243], v[28:31]
    ds_read_b128 a[116:119], v4 offset:5120
    v_cvt_pk_bf16_f32 v89, v84, v85
    v_mfma_f32_16x16x32_bf16 v[28:31], a[204:207], a[244:247], v[28:31]
    buffer_load_dwordx4 a[28:31], v2, s[36:39], 0 offen offset:3072 sc1
    v_mul_f32 v86, v24, v26
    v_mfma_f32_16x16x32_bf16 v[28:31], a[216:219], a[248:251], v[28:31]
    ds_read_b128 a[120:123], v4 offset:6144
    v_mul_f32 v87, v25, v27
    v_mfma_f32_16x16x32_bf16 v[28:31], a[228:231], a[252:255], v[28:31]
    v_rcp_f32 v80, v80
    v_mfma_f32_16x16x32_bf16 v[32:35], a[232:235], a[252:255], v[32:35]
    s_sub_u32 s36, s36, 3072
    ds_read_b128 a[124:127], v4 offset:7168
    v_mul_f32 v86, v86, v80
    v_mfma_f32_16x16x32_bf16 v[32:35], a[220:223], a[248:251], v[32:35]
    v_rcp_f32 v81, v81
    v_mfma_f32_16x16x32_bf16 v[32:35], a[208:211], a[244:247], v[32:35]
    ds_read_b128 v[12:15], v59 offset:1792
    buffer_load_dwordx4 a[32:35], v1, s[36:39], 0 offen sc1
    v_mfma_f32_16x16x32_bf16 v[32:35], a[196:199], a[240:243], v[32:35]
    ds_read_b128 a[128:131], v4 offset:8192
    v_mul_f32 v87, v87, v81
    v_mfma_f32_16x16x32_bf16 v[36:39], a[200:203], a[240:243], v[36:39]
    ds_read_b128 a[132:135], v4 offset:9216
    v_cvt_pk_bf16_f32 v90, v86, v87
    v_mfma_f32_16x16x32_bf16 v[36:39], a[212:215], a[244:247], v[36:39]
    buffer_store_dwordx2 v[88:89], v57, s[32:35], 0 offen nt
    v_mfma_f32_16x16x32_bf16 v[36:39], a[224:227], a[248:251], v[36:39]
    buffer_store_dword v90, v58, s[32:35], 0 offen offset:512 nt
    v_mfma_f32_16x16x32_bf16 v[36:39], a[236:239], a[252:255], v[36:39]
    buffer_load_dwordx4 a[36:39], v1, s[36:39], 0 offen offset:1024 sc1
    s_waitcnt vmcnt(12) lgkmcnt(2)
    v_mfma_f32_16x16x32_bf16 a[192:195], v[252:255], a[0:3], 0
    v_mfma_f32_16x16x32_bf16 a[192:195], v[232:235], a[4:7], a[192:195]
    s_sub_u32 s32, s32, 49152
    v_fmac_f32 v28, v12, v44
    v_fmac_f32 v29, v12, v45
    v_mfma_f32_16x16x32_bf16 a[188:191], v[228:231], a[4:7], 0
    v_fmac_f32 v30, v12, v46
    v_fmac_f32 v31, v12, v47
    v_mfma_f32_16x16x32_bf16 a[188:191], v[248:251], a[0:3], a[188:191]
    v_fmac_f32 v36, v12, v52
    v_fmac_f32 v37, v12, v53
    v_mfma_f32_16x16x32_bf16 a[184:187], v[244:247], a[0:3], 0
    buffer_load_dwordx4 a[40:43], v1, s[36:39], 0 offen offset:2048 sc1
    v_fmac_f32 v38, v12, v54
    v_mfma_f32_16x16x32_bf16 a[184:187], v[224:227], a[4:7], a[184:187]
    v_fmac_f32 v39, v12, v55
    v_mul_f32 v76, v13, v28
    v_mfma_f32_16x16x32_bf16 a[180:183], v[220:223], a[4:7], 0
    v_permlane32_swap_b32 v36, v38
    v_mfma_f32_16x16x32_bf16 a[180:183], v[240:243], a[0:3], a[180:183]
    s_add_u32 s36, s36, 11264
    v_permlane32_swap_b32 v37, v39
    v_mfma_f32_16x16x32_bf16 a[176:179], v[236:239], a[0:3], 0
    v_exp_f32 v76, v76
    v_mfma_f32_16x16x32_bf16 a[176:179], v[216:219], a[4:7], a[176:179]
    s_waitcnt vmcnt(11)
    buffer_load_dwordx4 a[44:47], v1, s[36:39], 0 offen sc1
    v_mul_f32 v77, v13, v29
    v_mfma_f32_16x16x32_bf16 a[176:179], v[196:199], a[8:11], a[176:179]
    v_exp_f32 v77, v77
    v_mfma_f32_16x16x32_bf16 a[176:179], v[176:179], a[12:15], a[176:179]
    v_mul_f32 v78, v13, v30
    v_mul_f32 v79, v13, v31
    v_mfma_f32_16x16x32_bf16 a[180:183], v[180:183], a[12:15], a[180:183]
    s_sub_u32 s36, s36, 106496
    v_exp_f32 v78, v78
    v_mfma_f32_16x16x32_bf16 a[180:183], v[200:203], a[8:11], a[180:183]
    v_exp_f32 v79, v79
    v_mfma_f32_16x16x32_bf16 a[184:187], v[204:207], a[8:11], a[184:187]
    buffer_load_dwordx4 a[48:51], v1, s[36:39], 0 offen sc1
    v_mul_f32 v80, v13, v36
    v_mfma_f32_16x16x32_bf16 a[184:187], v[184:187], a[12:15], a[184:187]
    v_exp_f32 v80, v80
    v_mfma_f32_16x16x32_bf16 a[188:191], v[188:191], a[12:15], a[188:191]
    v_mul_f32 v81, v13, v37
    v_fma_f32 v76, v76, v14, v14
    v_mfma_f32_16x16x32_bf16 a[188:191], v[208:211], a[8:11], a[188:191]
    v_exp_f32 v81, v81
    v_mfma_f32_16x16x32_bf16 a[192:195], v[212:215], a[8:11], a[192:195]
    v_rcp_f32 v76, v76
    v_mfma_f32_16x16x32_bf16 a[192:195], v[192:195], a[12:15], a[192:195]
    s_waitcnt vmcnt(10)
    buffer_load_dwordx4 a[52:55], v1, s[36:39], 0 offen offset:1024 sc1
    v_fma_f32 v77, v77, v14, v14
    v_mfma_f32_16x16x32_bf16 a[192:195], v[172:175], a[16:19], a[192:195]
    v_rcp_f32 v77, v77
    v_mfma_f32_16x16x32_bf16 a[192:195], v[152:155], a[20:23], a[192:195]
    v_fma_f32 v78, v78, v14, v14
    v_fma_f32 v79, v79, v14, v14
    v_mfma_f32_16x16x32_bf16 a[188:191], v[148:151], a[20:23], a[188:191]
    v_rcp_f32 v78, v78
    v_mfma_f32_16x16x32_bf16 a[188:191], v[168:171], a[16:19], a[188:191]
    v_rcp_f32 v79, v79
    v_mfma_f32_16x16x32_bf16 a[184:187], v[164:167], a[16:19], a[184:187]
    buffer_load_dwordx4 a[56:59], v1, s[36:39], 0 offen offset:2048 sc1
    v_fmac_f32 v32, v12, v48
    v_mfma_f32_16x16x32_bf16 a[184:187], v[144:147], a[20:23], a[184:187]
    v_fmac_f32 v33, v12, v49
    v_fmac_f32 v34, v12, v50
    v_mfma_f32_16x16x32_bf16 a[180:183], v[140:143], a[20:23], a[180:183]
    v_fmac_f32 v35, v12, v51
    v_mul_f32 v82, v28, v32
    v_mfma_f32_16x16x32_bf16 a[180:183], v[160:163], a[16:19], a[180:183]
    v_mul_f32 v83, v29, v33
    v_mul_f32 v84, v30, v34
    v_mfma_f32_16x16x32_bf16 a[176:179], v[156:159], a[16:19], a[176:179]
    v_mul_f32 v85, v31, v35
    v_fma_f32 v80, v80, v14, v14
    v_mfma_f32_16x16x32_bf16 a[176:179], v[136:139], a[20:23], a[176:179]
    s_waitcnt vmcnt(9)
    buffer_load_dwordx4 a[60:63], v1, s[36:39], 0 offen offset:3072 sc1
    v_fma_f32 v81, v81, v14, v14
    v_mfma_f32_16x16x32_bf16 a[176:179], v[116:119], a[24:27], a[176:179]
    buffer_load_dword v91, v11, s[48:51], 0 offen sc1
    v_mul_f32 v82, v82, v76
    v_mfma_f32_16x16x32_bf16 a[176:179], v[96:99], a[28:31], a[176:179]
    ds_read_b128 a[136:139], v4 offset:10240
    v_mul_f32 v83, v83, v77
    v_mfma_f32_16x16x32_bf16 a[180:183], v[100:103], a[28:31], a[180:183]
    ds_read_b128 a[140:143], v4 offset:11264
    v_mul_f32 v84, v84, v78
    v_mfma_f32_16x16x32_bf16 a[180:183], v[120:123], a[24:27], a[180:183]
    ds_read_b128 a[144:147], v4 offset:12288
    v_mul_f32 v85, v85, v79
    v_mfma_f32_16x16x32_bf16 a[184:187], v[124:127], a[24:27], a[184:187]
    buffer_load_dwordx4 a[64:67], v2, s[36:39], 0 offen sc1
    ds_read_b128 a[148:151], v4 offset:13312
    v_mfma_f32_16x16x32_bf16 a[184:187], v[104:107], a[28:31], a[184:187]
    ds_read_b128 a[152:155], v4 offset:14336
    v_cvt_pk_bf16_f32 v88, v82, v83
    v_mfma_f32_16x16x32_bf16 a[188:191], v[108:111], a[28:31], a[188:191]
    v_rcp_f32 v80, v80
    v_mfma_f32_16x16x32_bf16 a[188:191], v[128:131], a[24:27], a[188:191]
    ds_read_b128 a[156:159], v3
    v_cvt_pk_bf16_f32 v89, v84, v85
    v_mfma_f32_16x16x32_bf16 a[192:195], v[132:135], a[24:27], a[192:195]
    ds_read_b128 a[160:163], v3 offset:1024
    v_mul_f32 v86, v36, v38
    v_mfma_f32_16x16x32_bf16 a[192:195], v[112:115], a[28:31], a[192:195]
    s_waitcnt vmcnt(8) lgkmcnt(7)
    buffer_load_dwordx4 a[68:71], v2, s[36:39], 0 offen offset:1024 sc1
    ds_read_b128 a[164:167], v3 offset:2048
    v_mfma_f32_16x16x32_bf16 a[192:195], a[112:115], a[32:35], a[192:195]
    ds_read_b128 a[168:171], v3 offset:3072
    v_mul_f32 v87, v37, v39
    v_mfma_f32_16x16x32_bf16 a[192:195], a[132:135], a[36:39], a[192:195]
    ds_read_b128 a[172:175], v3 offset:4096
    v_mul_f32 v86, v86, v80
    v_mfma_f32_16x16x32_bf16 a[188:191], a[128:131], a[36:39], a[188:191]
    v_rcp_f32 v81, v81
    v_mfma_f32_16x16x32_bf16 a[188:191], a[108:111], a[32:35], a[188:191]
    buffer_store_dwordx2 v[88:89], v57, s[32:35], 0 offen nt
    v_mfma_f32_16x16x32_bf16 a[184:187], a[104:107], a[32:35], a[184:187]
    buffer_load_dwordx4 a[72:75], v2, s[36:39], 0 offen offset:2048 sc1
    v_mul_f32 v87, v87, v81
    v_mfma_f32_16x16x32_bf16 a[184:187], a[124:127], a[36:39], a[184:187]
    v_cvt_pk_bf16_f32 v90, v86, v87
    v_mfma_f32_16x16x32_bf16 a[180:183], a[120:123], a[36:39], a[180:183]
    buffer_store_dword v90, v58, s[32:35], 0 offen offset:512 nt
    v_mfma_f32_16x16x32_bf16 a[180:183], a[100:103], a[32:35], a[180:183]
    v_mfma_f32_16x16x32_bf16 a[176:179], a[96:99], a[32:35], a[176:179]
    v_mfma_f32_16x16x32_bf16 a[176:179], a[116:119], a[36:39], a[176:179]
    s_waitcnt vmcnt(10) lgkmcnt(0)
    buffer_load_dwordx4 a[76:79], v2, s[36:39], 0 offen offset:3072 sc1
    v_mfma_f32_16x16x32_bf16 a[176:179], a[136:139], a[40:43], a[176:179]
    v_mfma_f32_16x16x32_bf16 a[176:179], a[156:159], a[44:47], a[176:179]
    v_mfma_f32_16x16x32_bf16 a[180:183], a[160:163], a[44:47], a[180:183]
    s_sub_u32 s36, s36, 3072
    v_mfma_f32_16x16x32_bf16 a[180:183], a[140:143], a[40:43], a[180:183]
    v_mfma_f32_16x16x32_bf16 a[184:187], a[144:147], a[40:43], a[184:187]
    buffer_load_dwordx4 a[80:83], v1, s[36:39], 0 offen sc1
    v_mfma_f32_16x16x32_bf16 a[184:187], a[164:167], a[44:47], a[184:187]
    v_mfma_f32_16x16x32_bf16 a[188:191], a[168:171], a[44:47], a[188:191]
    v_mfma_f32_16x16x32_bf16 a[188:191], a[148:151], a[40:43], a[188:191]
    v_mfma_f32_16x16x32_bf16 a[192:195], a[152:155], a[40:43], a[192:195]
    v_mfma_f32_16x16x32_bf16 a[192:195], a[172:175], a[44:47], a[192:195]
    buffer_load_dwordx4 a[84:87], v1, s[36:39], 0 offen offset:1024 sc1
    s_waitcnt vmcnt(11)
    v_mfma_f32_16x16x32_bf16 a[212:215], v[252:255], a[48:51], 0
    v_mfma_f32_16x16x32_bf16 a[212:215], v[232:235], a[52:55], a[212:215]
    ds_read_b128 v[48:51], v94
    v_mfma_f32_16x16x32_bf16 a[208:211], v[228:231], a[52:55], 0
    v_mfma_f32_16x16x32_bf16 a[208:211], v[248:251], a[48:51], a[208:211]
    v_mfma_f32_16x16x32_bf16 a[204:207], v[244:247], a[48:51], 0
    buffer_load_dwordx4 a[88:91], v1, s[36:39], 0 offen offset:2048 sc1
    v_mfma_f32_16x16x32_bf16 a[204:207], v[224:227], a[52:55], a[204:207]
    ds_write_b128 v92, a[176:179]
    v_mfma_f32_16x16x32_bf16 a[200:203], v[220:223], a[52:55], 0
    v_mfma_f32_16x16x32_bf16 a[200:203], v[240:243], a[48:51], a[200:203]
    s_add_u32 s36, s36, 11264
    v_mfma_f32_16x16x32_bf16 a[196:199], v[236:239], a[48:51], 0
    s_waitcnt vmcnt(9)
    ds_write_b128 v92, a[180:183] offset:32
    v_mfma_f32_16x16x32_bf16 a[196:199], v[216:219], a[52:55], a[196:199]
    buffer_load_dwordx4 a[92:95], v1, s[36:39], 0 offen sc1
    v_subrev_u32 v91, s60, v91
    v_mfma_f32_16x16x32_bf16 a[196:199], v[196:199], a[56:59], a[196:199]
    v_cmp_gt_u32 vcc, 5, v91
    v_mfma_f32_16x16x32_bf16 a[196:199], v[176:179], a[60:63], a[196:199]
    ds_write_b128 v92, a[184:187] offset:64
    v_mfma_f32_16x16x32_bf16 a[200:203], v[180:183], a[60:63], a[200:203]
    s_and_b64 vcc, vcc, s[86:87]
    s_sub_u32 s36, s36, 106496
    v_mfma_f32_16x16x32_bf16 a[200:203], v[200:203], a[56:59], a[200:203]
    s_or_b64 vcc, vcc, s[62:63]
    s_cbranch_scc1 L_late4
L_go4:
    v_mfma_f32_16x16x32_bf16 a[204:207], v[204:207], a[56:59], a[204:207]
    buffer_load_dwordx4 a[0:3], v1, s[36:39], 0 offen sc1
    v_mfma_f32_16x16x32_bf16 a[204:207], v[184:187], a[60:63], a[204:207]
    ds_write_b128 v92, a[188:191] offset:96
    v_mfma_f32_16x16x32_bf16 a[208:211], v[188:191], a[60:63], a[208:211]
    v_add_u32 v10, 1, v10
    v_mfma_f32_16x16x32_bf16 a[208:211], v[208:211], a[56:59], a[208:211]
    s_cmp_lg_u32 s62, 0
    s_waitcnt vmcnt(6)
    s_cbranch_scc1 L_slow5
    buffer_store_dword v10, v9, s[48:51], 0 offen
L_sigd5:
    v_mfma_f32_16x16x32_bf16 a[212:215], v[212:215], a[56:59], a[212:215]
    ds_write_b128 v92, a[192:195] offset:128
    v_mfma_f32_16x16x32_bf16 a[212:215], v[192:195], a[60:63], a[212:215]
    buffer_load_dwordx4 a[4:7], v1, s[36:39], 0 offen offset:1024 sc1
    v_mfma_f32_16x16x32_bf16 a[212:215], v[172:175], a[64:67], a[212:215]
    v_mfma_f32_16x16x32_bf16 a[212:215], v[152:155], a[68:71], a[212:215]
    v_mfma_f32_16x16x32_bf16 a[208:211], v[148:151], a[68:71], a[208:211]
    v_mfma_f32_16x16x32_bf16 a[208:211], v[168:171], a[64:67], a[208:211]
    s_waitcnt lgkmcnt(0)
    s_barrier
    ds_read_b128 v[16:19], v93
    v_mfma_f32_16x16x32_bf16 a[204:207], v[164:167], a[64:67], a[204:207]
    buffer_load_dwordx4 a[8:11], v1, s[36:39], 0 offen offset:2048 sc1
    v_lshlrev_b32 v52, 16, v48
    v_mfma_f32_16x16x32_bf16 a[204:207], v[144:147], a[68:71], a[204:207]
    ds_read_b128 v[20:23], v93 offset:2624
    v_and_b32 v53, 0xffff0000, v48
    v_mfma_f32_16x16x32_bf16 a[200:203], v[140:143], a[68:71], a[200:203]
    ds_read_b128 v[24:27], v93 offset:5248
    v_lshlrev_b32 v54, 16, v49
    v_mfma_f32_16x16x32_bf16 a[200:203], v[160:163], a[64:67], a[200:203]
    ds_read_b128 v[28:31], v93 offset:7872
    v_and_b32 v55, 0xffff0000, v49
    v_mfma_f32_16x16x32_bf16 a[196:199], v[156:159], a[64:67], a[196:199]
    ds_read_b128 v[32:35], v93 offset:10496
    v_lshlrev_b32 v56, 16, v50
    v_mfma_f32_16x16x32_bf16 a[196:199], v[136:139], a[68:71], a[196:199]
    s_waitcnt vmcnt(8)
    buffer_load_dwordx4 a[12:15], v1, s[36:39], 0 offen offset:3072 sc1
    ds_read_b128 v[36:39], v93 offset:13120
    v_mfma_f32_16x16x32_bf16 a[196:199], v[116:119], a[72:75], a[196:199]
    v_and_b32 v57, 0xffff0000, v50
    v_mfma_f32_16x16x32_bf16 a[196:199], v[96:99], a[76:79], a[196:199]
    ds_read_b128 v[40:43], v93 offset:15744
    v_lshlrev_b32 v58, 16, v51
    v_mfma_f32_16x16x32_bf16 a[200:203], v[100:103], a[76:79], a[200:203]
    ds_read_b128 v[44:47], v93 offset:18368
    v_and_b32 v59, 0xffff0000, v51
    v_mfma_f32_16x16x32_bf16 a[200:203], v[120:123], a[72:75], a[200:203]
    v_mfma_f32_16x16x32_bf16 a[204:207], v[124:127], a[72:75], a[204:207]
    s_waitcnt lgkmcnt(4)
    buffer_load_dwordx4 a[16:19], v2, s[36:39], 0 offen sc1
    v_add_f32 v16, v16, v24
    v_mfma_f32_16x16x32_bf16 a[204:207], v[104:107], a[76:79], a[204:207]
    v_add_f32 v17, v17, v25
    v_add_f32 v18, v18, v26
    v_mfma_f32_16x16x32_bf16 a[208:211], v[108:111], a[76:79], a[208:211]
    v_add_f32 v19, v19, v27
    v_add_f32 v20, v20, v28
    v_mfma_f32_16x16x32_bf16 a[208:211], v[128:131], a[72:75], a[208:211]
    v_add_f32 v21, v21, v29
    v_add_f32 v22, v22, v30
    v_mfma_f32_16x16x32_bf16 a[212:215], v[132:135], a[72:75], a[212:215]
    v_add_f32 v23, v23, v31
    s_waitcnt lgkmcnt(0)
    v_mfma_f32_16x16x32_bf16 a[212:215], v[112:115], a[76:79], a[212:215]
    s_waitcnt vmcnt(8)
    buffer_load_dwordx4 a[20:23], v2, s[36:39], 0 offen offset:1024 sc1
    v_add_f32 v32, v32, v40
    v_mfma_f32_16x16x32_bf16 a[212:215], a[112:115], a[80:83], a[212:215]
    v_add_f32 v33, v33, v41
    v_add_f32 v34, v34, v42
    v_mfma_f32_16x16x32_bf16 a[212:215], a[132:135], a[84:87], a[212:215]
    v_add_f32 v35, v35, v43
    v_add_f32 v36, v36, v44
    v_mfma_f32_16x16x32_bf16 a[208:211], a[128:131], a[84:87], a[208:211]
    v_add_f32 v37, v37, v45
    v_add_f32 v38, v38, v46
    v_mfma_f32_16x16x32_bf16 a[208:211], a[108:111], a[80:83], a[208:211]
    v_add_f32 v39, v39, v47
    v_add_f32 v16, v16, v52
    v_mfma_f32_16x16x32_bf16 a[204:207], a[104:107], a[80:83], a[204:207]
    buffer_load_dwordx4 a[24:27], v2, s[36:39], 0 offen offset:2048 sc1
    v_add_f32 v17, v17, v53
    v_mfma_f32_16x16x32_bf16 a[204:207], a[124:127], a[84:87], a[204:207]
    v_add_f32 v18, v18, v54
    v_add_f32 v19, v19, v55
    v_mfma_f32_16x16x32_bf16 a[200:203], a[120:123], a[84:87], a[200:203]
    v_add_f32 v20, v20, v56
    v_add_f32 v21, v21, v57
    v_mfma_f32_16x16x32_bf16 a[200:203], a[100:103], a[80:83], a[200:203]
    v_add_f32 v22, v22, v58
    v_add_f32 v23, v23, v59
    v_mfma_f32_16x16x32_bf16 a[196:199], a[96:99], a[80:83], a[196:199]
    v_add_f32 v16, v16, v32
    v_add_f32 v17, v17, v33
    v_mfma_f32_16x16x32_bf16 a[196:199], a[116:119], a[84:87], a[196:199]
    s_waitcnt vmcnt(8)
    buffer_load_dwordx4 a[28:31], v2, s[36:39], 0 offen offset:3072 sc1
    v_add_f32 v18, v18, v34
    v_mfma_f32_16x16x32_bf16 a[196:199], a[136:139], a[88:91], a[196:199]
    buffer_load_dword v91, v11, s[48:51], 0 offen sc1
    v_add_f32 v19, v19, v35
    v_mfma_f32_16x16x32_bf16 a[196:199], a[156:159], a[92:95], a[196:199]
    v_add_f32 v20, v20, v36
    v_add_f32 v21, v21, v37
    v_mfma_f32_16x16x32_bf16 a[200:203], a[160:163], a[92:95], a[200:203]
    s_sub_u32 s36, s36, 3072
    v_add_f32 v22, v22, v38
    v_add_f32 v23, v23, v39
    v_mfma_f32_16x16x32_bf16 a[200:203], a[140:143], a[88:91], a[200:203]
    v_cvt_pk_bf16_f32 v60, v16, v17
    v_cvt_pk_bf16_f32 v61, v18, v19
    v_mfma_f32_16x16x32_bf16 a[204:207], a[144:147], a[88:91], a[204:207]
    buffer_load_dwordx4 a[32:35], v1, s[36:39], 0 offen sc1
    v_cvt_pk_bf16_f32 v62, v20, v21
    v_mfma_f32_16x16x32_bf16 a[204:207], a[164:167], a[92:95], a[204:207]
    v_cvt_pk_bf16_f32 v63, v22, v23
    v_mfma_f32_16x16x32_bf16 a[208:211], a[168:171], a[92:95], a[208:211]
    buffer_store_dwordx4 v[60:63], v95, s[28:31], 0 offen nt
    v_mfma_f32_16x16x32_bf16 a[208:211], a[148:151], a[88:91], a[208:211]
    s_add_u32 s28, s28, 20480
    s_addc_u32 s29, s29, 0
    v_mfma_f32_16x16x32_bf16 a[212:215], a[152:155], a[88:91], a[212:215]
    v_mfma_f32_16x16x32_bf16 a[212:215], a[172:175], a[92:95], a[212:215]
    buffer_load_dwordx4 a[36:39], v1, s[36:39], 0 offen offset:1024 sc1
    s_waitcnt vmcnt(10)
    v_mfma_f32_16x16x32_bf16 a[192:195], v[252:255], a[0:3], 0
    v_mfma_f32_16x16x32_bf16 a[192:195], v[232:235], a[4:7], a[192:195]
    ds_read_b128 v[48:51], v94 offset:2560
    v_mfma_f32_16x16x32_bf16 a[188:191], v[228:231], a[4:7], 0
    v_mfma_f32_16x16x32_bf16 a[188:191], v[248:251], a[0:3], a[188:191]
    v_mfma_f32_16x16x32_bf16 a[184:187], v[244:247], a[0:3], 0
    buffer_load_dwordx4 a[40:43], v1, s[36:39], 0 offen offset:2048 sc1
    v_mfma_f32_16x16x32_bf16 a[184:187], v[224:227], a[4:7], a[184:187]
    ds_write_b128 v92, a[196:199] offset:20992
    v_mfma_f32_16x16x32_bf16 a[180:183], v[220:223], a[4:7], 0
    v_mfma_f32_16x16x32_bf16 a[180:183], v[240:243], a[0:3], a[180:183]
    s_add_u32 s36, s36, 11264
    v_mfma_f32_16x16x32_bf16 a[176:179], v[236:239], a[0:3], 0
    ds_write_b128 v92, a[200:203] offset:21024
    v_mfma_f32_16x16x32_bf16 a[176:179], v[216:219], a[4:7], a[176:179]
    s_waitcnt vmcnt(9)
    buffer_load_dwordx4 a[44:47], v1, s[36:39], 0 offen sc1
    v_mfma_f32_16x16x32_bf16 a[176:179], v[196:199], a[8:11], a[176:179]
    v_mfma_f32_16x16x32_bf16 a[176:179], v[176:179], a[12:15], a[176:179]
    ds_write_b128 v92, a[204:207] offset:21056
    v_mfma_f32_16x16x32_bf16 a[180:183], v[180:183], a[12:15], a[180:183]
    v_mfma_f32_16x16x32_bf16 a[180:183], v[200:203], a[8:11], a[180:183]
    v_mfma_f32_16x16x32_bf16 a[184:187], v[204:207], a[8:11], a[184:187]
    ds_write_b128 v92, a[208:211] offset:21088
    v_mfma_f32_16x16x32_bf16 a[184:187], v[184:187], a[12:15], a[184:187]
    v_mfma_f32_16x16x32_bf16 a[188:191], v[188:191], a[12:15], a[188:191]
    s_waitcnt vmcnt(5)
    v_mfma_f32_16x16x32_bf16 a[188:191], v[208:211], a[8:11], a[188:191]
    v_subrev_u32 v91, s60, v91
    v_mfma_f32_16x16x32_bf16 a[192:195], v[212:215], a[8:11], a[192:195]
    v_cmp_gt_u32 vcc, 6, v91
    v_mfma_f32_16x16x32_bf16 a[192:195], v[192:195], a[12:15], a[192:195]
    ds_write_b128 v92, a[212:215] offset:21120
    v_mfma_f32_16x16x32_bf16 a[192:195], v[172:175], a[16:19], a[192:195]
    s_and_b64 vcc, vcc, s[86:87]
    s_sub_u32 s36, s36, 106496
    v_mfma_f32_16x16x32_bf16 a[192:195], v[152:155], a[20:23], a[192:195]
    s_or_b64 vcc, vcc, s[62:63]
    s_cbranch_scc1 L_late5
L_go5:
    v_mfma_f32_16x16x32_bf16 a[188:191], v[148:151], a[20:23], a[188:191]
    buffer_load_dwordx4 a[48:51], v1, s[36:39], 0 offen sc1
    v_mfma_f32_16x16x32_bf16 a[188:191], v[168:171], a[16:19], a[188:191]
    v_mfma_f32_16x16x32_bf16 a[184:187], v[164:167], a[16:19], a[184:187]
    s_waitcnt lgkmcnt(0)
    s_barrier
    ds_read_b128 v[16:19], v93 offset:20992
    v_mfma_f32_16x16x32_bf16 a[184:187], v[144:147], a[20:23], a[184:187]
    v_lshlrev_b32 v52, 16, v48
    v_mfma_f32_16x16x32_bf16 a[180:183], v[140:143], a[20:23], a[180:183]
    buffer_load_dwordx4 a[52:55], v1, s[36:39], 0 offen offset:1024 sc1
    ds_read_b128 v[20:23], v93 offset:23616
    v_mfma_f32_16x16x32_bf16 a[180:183], v[160:163], a[16:19], a[180:183]
    v_and_b32 v53, 0xffff0000, v48
    v_mfma_f32_16x16x32_bf16 a[176:179], v[156:159], a[16:19], a[176:179]
    ds_read_b128 v[24:27], v93 offset:26240
    v_lshlrev_b32 v54, 16, v49
    v_mfma_f32_16x16x32_bf16 a[176:179], v[136:139], a[20:23], a[176:179]
    ds_read_b128 v[28:31], v93 offset:28864
    v_and_b32 v55, 0xffff0000, v49
    v_mfma_f32_16x16x32_bf16 a[176:179], v[116:119], a[24:27], a[176:179]
    buffer_load_dwordx4 a[56:59], v1, s[36:39], 0 offen offset:2048 sc1
    ds_read_b128 v[32:35], v93 offset:31488
    v_mfma_f32_16x16x32_bf16 a[176:179], v[96:99], a[28:31], a[176:179]
    v_lshlrev_b32 v56, 16, v50
    v_mfma_f32_16x16x32_bf16 a[180:183], v[100:103], a[28:31], a[180:183]
    ds_read_b128 v[36:39], v93 offset:34112
    v_and_b32 v57, 0xffff0000, v50
    v_mfma_f32_16x16x32_bf16 a[180:183], v[120:123], a[24:27], a[180:183]
    ds_read_b128 v[40:43], v93 offset:36736
    v_lshlrev_b32 v58, 16, v51
    v_mfma_f32_16x16x32_bf16 a[184:187], v[124:127], a[24:27], a[184:187]
    buffer_load_dwordx4 a[60:63], v1, s[36:39], 0 offen offset:3072 sc1
    ds_read_b128 v[44:47], v93 offset:39360
    v_mfma_f32_16x16x32_bf16 a[184:187], v[104:107], a[28:31], a[184:187]
    v_and_b32 v59, 0xffff0000, v51
    v_mfma_f32_16x16x32_bf16 a[188:191], v[108:111], a[28:31], a[188:191]
    v_mfma_f32_16x16x32_bf16 a[188:191], v[128:131], a[24:27], a[188:191]
    s_waitcnt lgkmcnt(4)
    v_add_f32 v16, v16, v24
    v_add_f32 v17, v17, v25
    v_mfma_f32_16x16x32_bf16 a[192:195], v[132:135], a[24:27], a[192:195]
    buffer_load_dwordx4 a[64:67], v2, s[36:39], 0 offen sc1
    v_add_f32 v18, v18, v26
    v_mfma_f32_16x16x32_bf16 a[192:195], v[112:115], a[28:31], a[192:195]
    s_waitcnt vmcnt(7)
    v_add_f32 v19, v19, v27
    v_add_f32 v20, v20, v28
    v_mfma_f32_16x16x32_bf16 a[192:195], a[112:115], a[32:35], a[192:195]
    v_add_f32 v21, v21, v29
    v_add_f32 v22, v22, v30
    v_mfma_f32_16x16x32_bf16 a[192:195], a[132:135], a[36:39], a[192:195]
    v_add_f32 v23, v23, v31
    s_waitcnt lgkmcnt(0)
    v_mfma_f32_16x16x32_bf16 a[188:191], a[128:131], a[36:39], a[188:191]
    buffer_load_dwordx4 a[68:71], v2, s[36:39], 0 offen offset:1024 sc1
    v_add_f32 v32, v32, v40
    v_mfma_f32_16x16x32_bf16 a[188:191], a[108:111], a[32:35], a[188:191]
    v_add_f32 v33, v33, v41
    v_add_f32 v34, v34, v42
    v_mfma_f32_16x16x32_bf16 a[184:187], a[104:107], a[32:35], a[184:187]
    v_add_f32 v35, v35, v43
    v_add_f32 v36, v36, v44
    v_mfma_f32_16x16x32_bf16 a[184:187], a[124:127], a[36:39], a[184:187]
    v_add_f32 v37, v37, v45
    v_add_f32 v38, v38, v46
    v_mfma_f32_16x16x32_bf16 a[180:183], a[120:123], a[36:39], a[180:183]
    buffer_load_dwordx4 a[72:75], v2, s[36:39], 0 offen offset:2048 sc1
    v_add_f32 v39, v39, v47
    v_mfma_f32_16x16x32_bf16 a[180:183], a[100:103], a[32:35], a[180:183]
    v_add_f32 v16, v16, v52
    v_add_f32 v17, v17, v53
    v_mfma_f32_16x16x32_bf16 a[176:179], a[96:99], a[32:35], a[176:179]
    v_add_f32 v18, v18, v54
    v_add_f32 v19, v19, v55
    v_mfma_f32_16x16x32_bf16 a[176:179], a[116:119], a[36:39], a[176:179]
    s_waitcnt vmcnt(7)
    v_add_f32 v20, v20, v56
    v_add_f32 v21, v21, v57
    v_mfma_f32_16x16x32_bf16 a[176:179], a[136:139], a[40:43], a[176:179]
    buffer_load_dwordx4 a[76:79], v2, s[36:39], 0 offen offset:3072 sc1
    v_add_f32 v22, v22, v58
    v_mfma_f32_16x16x32_bf16 a[176:179], a[156:159], a[44:47], a[176:179]
    v_add_f32 v23, v23, v59
    v_add_f32 v16, v16, v32
    v_mfma_f32_16x16x32_bf16 a[180:183], a[160:163], a[44:47], a[180:183]
    s_sub_u32 s36, s36, 3072
    v_add_f32 v17, v17, v33
    v_add_f32 v18, v18, v34
    v_mfma_f32_16x16x32_bf16 a[180:183], a[140:143], a[40:43], a[180:183]
    v_add_f32 v19, v19, v35
    v_add_f32 v20, v20, v36
    v_mfma_f32_16x16x32_bf16 a[184:187], a[144:147], a[40:43], a[184:187]
    buffer_load_dwordx4 a[80:83], v1, s[36:39], 0 offen sc1
    v_add_f32 v21, v21, v37
    v_mfma_f32_16x16x32_bf16 a[184:187], a[164:167], a[44:47], a[184:187]
    v_add_f32 v22, v22, v38
    v_add_f32 v23, v23, v39
    v_mfma_f32_16x16x32_bf16 a[188:191], a[168:171], a[44:47], a[188:191]
    v_cvt_pk_bf16_f32 v60, v16, v17
    v_cvt_pk_bf16_f32 v61, v18, v19
    v_mfma_f32_16x16x32_bf16 a[188:191], a[148:151], a[40:43], a[188:191]
    v_cvt_pk_bf16_f32 v62, v20, v21
    v_cvt_pk_bf16_f32 v63, v22, v23
    v_mfma_f32_16x16x32_bf16 a[192:195], a[152:155], a[40:43], a[192:195]
    buffer_load_dwordx4 a[84:87], v1, s[36:39], 0 offen offset:1024 sc1
    v_mfma_f32_16x16x32_bf16 a[192:195], a[172:175], a[44:47], a[192:195]
L_wp9:
    s_cbranch_execz L_wret1
    buffer_store_dwordx4 v[60:63], v95, s[28:31], 0 offen nt
    s_add_u32 s28, s28, 20480
    s_addc_u32 s29, s29, 0
    s_waitcnt vmcnt(9)
    v_mfma_f32_16x16x32_bf16 a[196:199], v[236:239], a[48:51], 0
    v_mfma_f32_16x16x32_bf16 a[196:199], v[216:219], a[52:55], a[196:199]
    ds_read_b128 v[48:51], v94 offset:5120
    v_mfma_f32_16x16x32_bf16 a[200:203], v[220:223], a[52:55], 0
    buffer_load_dwordx4 a[88:91], v1, s[36:39], 0 offen offset:2048 sc1
    ds_read_b128 v[64:67], v94 offset:7680
    v_mfma_f32_16x16x32_bf16 a[200:203], v[240:243], a[48:51], a[200:203]
    v_mfma_f32_16x16x32_bf16 a[204:207], v[244:247], a[48:51], 0
    s_add_u32 s36, s36, 11264
    ds_write_b128 v92, a[176:179]
    v_mfma_f32_16x16x32_bf16 a[204:207], v[224:227], a[52:55], a[204:207]
    v_mfma_f32_16x16x32_bf16 a[208:211], v[228:231], a[52:55], 0
    buffer_load_dwordx4 a[92:95], v1, s[36:39], 0 offen sc1
    v_mfma_f32_16x16x32_bf16 a[208:211], v[248:251], a[48:51], a[208:211]
    ds_write_b128 v92, a[180:183] offset:32
    v_mfma_f32_16x16x32_bf16 a[212:215], v[252:255], a[48:51], 0
    v_mfma_f32_16x16x32_bf16 a[212:215], v[232:235], a[52:55], a[212:215]
    s_waitcnt vmcnt(9)
    v_mfma_f32_16x16x32_bf16 a[212:215], v[212:215], a[56:59], a[212:215]
    s_waitcnt lgkmcnt(2)
    v_lshlrev_b32 v68, 16, v64
    v_and_b32 v69, 0xffff0000, v64
    v_mfma_f32_16x16x32_bf16 a[212:215], v[192:195], a[60:63], a[212:215]
    v_lshlrev_b32 v70, 16, v65
    v_mfma_f32_16x16x32_bf16 a[208:211], v[188:191], a[60:63], a[208:211]
    ds_write_b128 v92, a[184:187] offset:64
    v_mfma_f32_16x16x32_bf16 a[208:211], v[208:211], a[56:59], a[208:211]
    v_mfma_f32_16x16x32_bf16 a[204:207], v[204:207], a[56:59], a[204:207]
    s_or_b32 s75, s2, s56
    s_cselect_b32 s75, 0x7ff00000, 0
    v_and_b32 v71, 0xffff0000, v65
    v_mfma_f32_16x16x32_bf16 a[204:207], v[184:187], a[60:63], a[204:207]
    ds_write_b128 v92, a[188:191] offset:96
    v_mfma_f32_16x16x32_bf16 a[200:203], v[180:183], a[60:63], a[200:203]
    v_mov_b32 v84, s60
    v_lshlrev_b32 v72, 16, v66
    v_mfma_f32_16x16x32_bf16 a[200:203], v[200:203], a[56:59], a[200:203]
    v_mfma_f32_16x16x32_bf16 a[196:199], v[196:199], a[56:59], a[196:199]
    v_mov_b32 v85, s75
    v_mfma_f32_16x16x32_bf16 a[196:199], v[176:179], a[60:63], a[196:199]
    s_waitcnt vmcnt(7)
    v_and_b32 v73, 0xffff0000, v66
    v_mfma_f32_16x16x32_bf16 a[196:199], v[156:159], a[64:67], a[196:199]
    buffer_store_dword v84, v85, s[44:47], 0 offen
    v_mfma_f32_16x16x32_bf16 a[196:199], v[136:139], a[68:71], a[196:199]
    v_lshlrev_b32 v74, 16, v67
    v_mfma_f32_16x16x32_bf16 a[200:203], v[140:143], a[68:71], a[200:203]
    ds_write_b128 v92, a[192:195] offset:128
    v_mfma_f32_16x16x32_bf16 a[200:203], v[160:163], a[64:67], a[200:203]
    v_mfma_f32_16x16x32_bf16 a[204:207], v[164:167], a[64:67], a[204:207]
    v_and_b32 v75, 0xffff0000, v67
    v_mfma_f32_16x16x32_bf16 a[204:207], v[144:147], a[68:71], a[204:207]
    v_mfma_f32_16x16x32_bf16 a[208:211], v[148:151], a[68:71], a[208:211]
    v_mfma_f32_16x16x32_bf16 a[208:211], v[168:171], a[64:67], a[208:211]
    s_waitcnt lgkmcnt(0)
    s_barrier
    ds_read_b128 v[16:19], v93
    v_mfma_f32_16x16x32_bf16 a[212:215], v[172:175], a[64:67], a[212:215]
    v_lshlrev_b32 v52, 16, v48
    v_mfma_f32_16x16x32_bf16 a[212:215], v[152:155], a[68:71], a[212:215]
    s_waitcnt vmcnt(6)
    ds_read_b128 v[20:23], v93 offset:2624
    v_and_b32 v53, 0xffff0000, v48
    v_mfma_f32_16x16x32_bf16 a[212:215], v[132:135], a[72:75], a[212:215]
    ds_read_b128 v[24:27], v93 offset:5248
    v_lshlrev_b32 v54, 16, v49
    v_mfma_f32_16x16x32_bf16 a[212:215], v[112:115], a[76:79], a[212:215]
    ds_read_b128 v[28:31], v93 offset:7872
    v_and_b32 v55, 0xffff0000, v49
    v_mfma_f32_16x16x32_bf16 a[208:211], v[108:111], a[76:79], a[208:211]
    ds_read_b128 v[32:35], v93 offset:10496
    v_lshlrev_b32 v56, 16, v50
    v_mfma_f32_16x16x32_bf16 a[208:211], v[128:131], a[72:75], a[208:211]
    ds_read_b128 v[36:39], v93 offset:13120
    v_and_b32 v57, 0xffff0000, v50
    v_mfma_f32_16x16x32_bf16 a[204:207], v[124:127], a[72:75], a[204:207]
    ds_read_b128 v[40:43], v93 offset:15744
    v_lshlrev_b32 v58, 16, v51
    v_mfma_f32_16x16x32_bf16 a[204:207], v[104:107], a[76:79], a[204:207]
    ds_read_b128 v[44:47], v93 offset:18368
    v_and_b32 v59, 0xffff0000, v51
    v_mfma_f32_16x16x32_bf16 a[200:203], v[100:103], a[76:79], a[200:203]
    s_lshr_b32 s75, s2, 3
    s_or_b32 s75, s75, s56
    s_cbranch_scc0 L_wb2
    buffer_load_dword v91, v11, s[48:51], 0 offen
L_wb2d:
    v_mfma_f32_16x16x32_bf16 a[200:203], v[120:123], a[72:75], a[200:203]
    s_waitcnt lgkmcnt(4)
    v_add_f32 v16, v16, v24
    v_add_f32 v17, v17, v25
    v_mfma_f32_16x16x32_bf16 a[196:199], v[116:119], a[72:75], a[196:199]
    v_add_f32 v18, v18, v26
    v_add_f32 v19, v19, v27
    v_mfma_f32_16x16x32_bf16 a[196:199], v[96:99], a[76:79], a[196:199]
    s_waitcnt vmcnt(5)
    v_add_f32 v20, v20, v28
    v_add_f32 v21, v21, v29
    v_mfma_f32_16x16x32_bf16 a[196:199], a[96:99], a[80:83], a[196:199]
    v_add_f32 v22, v22, v30
    v_add_f32 v23, v23, v31
    v_mfma_f32_16x16x32_bf16 a[196:199], a[116:119], a[84:87], a[196:199]
    s_waitcnt vmcnt(2)
    s_waitcnt lgkmcnt(0)
    v_add_f32 v32, v32, v40
    v_mfma_f32_16x16x32_bf16 a[196:199], a[136:139], a[88:91], a[196:199]
    v_add_f32 v33, v33, v41
    v_add_f32 v34, v34, v42
    v_mfma_f32_16x16x32_bf16 a[196:199], a[156:159], a[92:95], a[196:199]
    v_add_f32 v35, v35, v43
    v_add_f32 v36, v36, v44
    v_mfma_f32_16x16x32_bf16 a[200:203], a[160:163], a[92:95], a[200:203]
    v_add_f32 v37, v37, v45
    v_add_f32 v38, v38, v46
    v_mfma_f32_16x16x32_bf16 a[200:203], a[140:143], a[88:91], a[200:203]
    v_add_f32 v39, v39, v47
    v_add_f32 v16, v16, v52
    v_mfma_f32_16x16x32_bf16 a[200:203], a[120:123], a[84:87], a[200:203]
    v_add_f32 v17, v17, v53
    v_add_f32 v18, v18, v54
    v_mfma_f32_16x16x32_bf16 a[200:203], a[100:103], a[80:83], a[200:203]
    v_add_f32 v19, v19, v55
    v_add_f32 v20, v20, v56
    v_mfma_f32_16x16x32_bf16 a[204:207], a[104:107], a[80:83], a[204:207]
    ds_write_b128 v92, a[196:199] offset:20992
    v_mfma_f32_16x16x32_bf16 a[204:207], a[124:127], a[84:87], a[204:207]
    v_add_f32 v21, v21, v57
    v_add_f32 v22, v22, v58
    v_mfma_f32_16x16x32_bf16 a[204:207], a[144:147], a[88:91], a[204:207]
    v_add_f32 v23, v23, v59
    v_add_f32 v16, v16, v32
    v_mfma_f32_16x16x32_bf16 a[204:207], a[164:167], a[92:95], a[204:207]
    v_add_f32 v17, v17, v33
    v_add_f32 v18, v18, v34
    v_mfma_f32_16x16x32_bf16 a[208:211], a[168:171], a[92:95], a[208:211]
    ds_write_b128 v92, a[200:203] offset:21024
    v_mfma_f32_16x16x32_bf16 a[208:211], a[148:151], a[88:91], a[208:211]
    v_add_f32 v19, v19, v35
    v_add_f32 v20, v20, v36
    v_add_f32 v21, v21, v37
    v_add_f32 v22, v22, v38
    v_add_f32 v23, v23, v39
    v_cvt_pk_bf16_f32 v60, v16, v17
    v_cvt_pk_bf16_f32 v61, v18, v19
    v_cvt_pk_bf16_f32 v62, v20, v21
    v_cvt_pk_bf16_f32 v63, v22, v23
    buffer_store_dwordx4 v[60:63], v95, s[28:31], 0 offen nt
    s_add_u32 s28, s28, 20480
    s_addc_u32 s29, s29, 0
    v_mfma_f32_16x16x32_bf16 a[208:211], a[128:131], a[84:87], a[208:211]
    v_mfma_f32_16x16x32_bf16 a[208:211], a[108:111], a[80:83], a[208:211]
    v_mfma_f32_16x16x32_bf16 a[212:215], a[112:115], a[80:83], a[212:215]
    ds_write_b128 v92, a[204:207] offset:21056
    v_mfma_f32_16x16x32_bf16 a[212:215], a[132:135], a[84:87], a[212:215]
    v_mfma_f32_16x16x32_bf16 a[212:215], a[152:155], a[88:91], a[212:215]
    v_mfma_f32_16x16x32_bf16 a[212:215], a[172:175], a[92:95], a[212:215]
    s_nop 2
    ds_write_b128 v92, a[208:211] offset:21088
    s_nop 3
    ds_write_b128 v92, a[212:215] offset:21120
    s_waitcnt lgkmcnt(0)
    s_barrier
    ds_read_b128 v[16:19], v93 offset:20992
    ds_read_b128 v[20:23], v93 offset:23616
    ds_read_b128 v[24:27], v93 offset:26240
    ds_read_b128 v[28:31], v93 offset:28864
    ds_read_b128 v[32:35], v93 offset:31488
    ds_read_b128 v[36:39], v93 offset:34112
    ds_read_b128 v[40:43], v93 offset:36736
    ds_read_b128 v[44:47], v93 offset:39360
    s_waitcnt lgkmcnt(6)
    v_pk_add_f32 v[16:17], v[16:17], v[68:69]
    v_pk_add_f32 v[18:19], v[18:19], v[70:71]
    v_pk_add_f32 v[20:21], v[20:21], v[72:73]
    v_pk_add_f32 v[22:23], v[22:23], v[74:75]
    s_waitcnt lgkmcnt(4)
    v_pk_add_f32 v[16:17], v[16:17], v[24:25]
    v_pk_add_f32 v[18:19], v[18:19], v[26:27]
    v_pk_add_f32 v[20:21], v[20:21], v[28:29]
    v_pk_add_f32 v[22:23], v[22:23], v[30:31]
    s_waitcnt lgkmcnt(2)
    v_pk_add_f32 v[16:17], v[16:17], v[32:33]
    v_pk_add_f32 v[18:19], v[18:19], v[34:35]
    v_pk_add_f32 v[20:21], v[20:21], v[36:37]
    v_pk_add_f32 v[22:23], v[22:23], v[38:39]
    s_waitcnt lgkmcnt(0)
    v_pk_add_f32 v[16:17], v[16:17], v[40:41]
    v_pk_add_f32 v[18:19], v[18:19], v[42:43]
    v_pk_add_f32 v[20:21], v[20:21], v[44:45]
    v_pk_add_f32 v[22:23], v[22:23], v[46:47]
    v_cvt_pk_bf16_f32 v60, v16, v17
    v_cvt_pk_bf16_f32 v61, v18, v19
    v_cvt_pk_bf16_f32 v62, v20, v21
    v_cvt_pk_bf16_f32 v63, v22, v23
    buffer_store_dwordx4 v[60:63], v95, s[28:31], 0 offen nt
L_fin:
L_end:
    s_endpgm
L_kvlate:
    s_sub_u32 s3, s3, 1
    s_cbranch_scc1 L_kvok
    buffer_load_dwordx4 v[204:207], v1, s[44:47], s76 offen sc1
    buffer_load_dwordx4 v[208:211], v1, s[44:47], s76 offen offset:1024 sc1
    s_waitcnt vmcnt(0)
    s_branch L_kvchk
L_rowmax:
    s_waitcnt vmcnt(0)
    s_mov_b32 s76, 262144
    v_mov_b32 v40, 0xff800000
    v_mov_b32 v41, 0xff800000
    v_mov_b32 v42, 0xff800000
    v_mov_b32 v43, 0xff800000
L_rmloop:
    buffer_load_dwordx4 v[28:31], v1, s[44:47], s76 offen sc1
    buffer_load_dwordx4 v[76:79], v1, s[44:47], s76 offen offset:3072 sc1
    s_add_u32 s76, s76, 4096
    buffer_load_dwordx4 v[32:35], v1, s[44:47], s76 offen sc1
    s_add_u32 s76, s76, 4096
    s_waitcnt vmcnt(0)
    v_mfma_f32_32x32x16_bf16 v[60:75], v[28:31], v[172:175], 0
    v_mfma_f32_32x32x8_bf16 v[60:75], v[76:77], v[188:189], v[60:75]
    s_nop 11
    v_max3_f32 v40, v60, v61, v40
    v_max3_f32 v40, v62, v63, v40
    v_max3_f32 v40, v64, v65, v40
    v_max3_f32 v40, v66, v67, v40
    v_max3_f32 v40, v68, v69, v40
    v_max3_f32 v40, v70, v71, v40
    v_max3_f32 v40, v72, v73, v40
    v_max3_f32 v40, v74, v75, v40
    v_mfma_f32_32x32x16_bf16 v[60:75], v[28:31], v[176:179], 0
    v_mfma_f32_32x32x8_bf16 v[60:75], v[76:77], v[190:191], v[60:75]
    s_nop 11
    v_max3_f32 v41, v60, v61, v41
    v_max3_f32 v41, v62, v63, v41
    v_max3_f32 v41, v64, v65, v41
    v_max3_f32 v41, v66, v67, v41
    v_max3_f32 v41, v68, v69, v41
    v_max3_f32 v41, v70, v71, v41
    v_max3_f32 v41, v72, v73, v41
    v_max3_f32 v41, v74, v75, v41
    v_mfma_f32_32x32x16_bf16 v[60:75], v[28:31], v[180:183], 0
    v_mfma_f32_32x32x8_bf16 v[60:75], v[76:77], v[192:193], v[60:75]
    s_nop 11
    v_max3_f32 v42, v60, v61, v42
    v_max3_f32 v42, v62, v63, v42
    v_max3_f32 v42, v64, v65, v42
    v_max3_f32 v42, v66, v67, v42
    v_max3_f32 v42, v68, v69, v42
    v_max3_f32 v42, v70, v71, v42
    v_max3_f32 v42, v72, v73, v42
    v_max3_f32 v42, v74, v75, v42
    v_mfma_f32_32x32x16_bf16 v[60:75], v[28:31], v[184:187], 0
    v_mfma_f32_32x32x8_bf16 v[60:75], v[76:77], v[194:195], v[60:75]
    s_nop 11
    v_max3_f32 v43, v60, v61, v43
    v_max3_f32 v43, v62, v63, v43
    v_max3_f32 v43, v64, v65, v43
    v_max3_f32 v43, v66, v67, v43
    v_max3_f32 v43, v68, v69, v43
    v_max3_f32 v43, v70, v71, v43
    v_max3_f32 v43, v72, v73, v43
    v_max3_f32 v43, v74, v75, v43
    v_mfma_f32_32x32x16_bf16 v[60:75], v[32:35], v[172:175], 0
    v_mfma_f32_32x32x8_bf16 v[60:75], v[78:79], v[188:189], v[60:75]
    s_nop 11
    v_max3_f32 v40, v60, v61, v40
    v_max3_f32 v40, v62, v63, v40
    v_max3_f32 v40, v64, v65, v40
    v_max3_f32 v40, v66, v67, v40
    v_max3_f32 v40, v68, v69, v40
    v_max3_f32 v40, v70, v71, v40
    v_max3_f32 v40, v72, v73, v40
    v_max3_f32 v40, v74, v75, v40
    v_mfma_f32_32x32x16_bf16 v[60:75], v[32:35], v[176:179], 0
    v_mfma_f32_32x32x8_bf16 v[60:75], v[78:79], v[190:191], v[60:75]
    s_nop 11
    v_max3_f32 v41, v60, v61, v41
    v_max3_f32 v41, v62, v63, v41
    v_max3_f32 v41, v64, v65, v41
    v_max3_f32 v41, v66, v67, v41
    v_max3_f32 v41, v68, v69, v41
    v_max3_f32 v41, v70, v71, v41
    v_max3_f32 v41, v72, v73, v41
    v_max3_f32 v41, v74, v75, v41
    v_mfma_f32_32x32x16_bf16 v[60:75], v[32:35], v[180:183], 0
    v_mfma_f32_32x32x8_bf16 v[60:75], v[78:79], v[192:193], v[60:75]
    s_nop 11
    v_max3_f32 v42, v60, v61, v42
    v_max3_f32 v42, v62, v63, v42
    v_max3_f32 v42, v64, v65, v42
    v_max3_f32 v42, v66, v67, v42
    v_max3_f32 v42, v68, v69, v42
    v_max3_f32 v42, v70, v71, v42
    v_max3_f32 v42, v72, v73, v42
    v_max3_f32 v42, v74, v75, v42
    v_mfma_f32_32x32x16_bf16 v[60:75], v[32:35], v[184:187], 0
    v_mfma_f32_32x32x8_bf16 v[60:75], v[78:79], v[194:195], v[60:75]
    s_nop 11
    v_max3_f32 v43, v60, v61, v43
    v_max3_f32 v43, v62, v63, v43
    v_max3_f32 v43, v64, v65, v43
    v_max3_f32 v43, v66, v67, v43
    v_max3_f32 v43, v68, v69, v43
    v_max3_f32 v43, v70, v71, v43
    v_max3_f32 v43, v72, v73, v43
    v_max3_f32 v43, v74, v75, v43
    s_cmp_lt_u32 s76, 524288
    s_cbranch_scc1 L_rmloop
    v_mov_b32 v47, v40
    s_nop 1
    v_permlane32_swap_b32 v40, v47
    v_max_f32 v40, v40, v47
    v_sub_f32 v40, 0, v40
    v_and_b32 v47, 0xffff0000, v40
    v_sub_f32 v40, v40, v47
    v_and_b32 v46, 0xffff0000, v40
    v_sub_f32 v40, v40, v46
    v_lshrrev_b32 v47, 16, v47
    s_mov_b32 exec_lo, 0
    v_or_b32 v188, v47, v46
    v_lshrrev_b32 v189, 16, v40
    s_mov_b32 exec_lo, -1
    v_mov_b32 v47, v41
    s_nop 1
    v_permlane32_swap_b32 v41, v47
    v_max_f32 v41, v41, v47
    v_sub_f32 v41, 0, v41
    v_and_b32 v47, 0xffff0000, v41
    v_sub_f32 v41, v41, v47
    v_and_b32 v46, 0xffff0000, v41
    v_sub_f32 v41, v41, v46
    v_lshrrev_b32 v47, 16, v47
    s_mov_b32 exec_lo, 0
    v_or_b32 v190, v47, v46
    v_lshrrev_b32 v191, 16, v41
    s_mov_b32 exec_lo, -1
    v_mov_b32 v47, v42
    s_nop 1
    v_permlane32_swap_b32 v42, v47
    v_max_f32 v42, v42, v47
    v_sub_f32 v42, 0, v42
    v_and_b32 v47, 0xffff0000, v42
    v_sub_f32 v42, v42, v47
    v_and_b32 v46, 0xffff0000, v42
    v_sub_f32 v42, v42, v46
    v_lshrrev_b32 v47, 16, v47
    s_mov_b32 exec_lo, 0
    v_or_b32 v192, v47, v46
    v_lshrrev_b32 v193, 16, v42
    s_mov_b32 exec_lo, -1
    v_mov_b32 v47, v43
    s_nop 1
    v_permlane32_swap_b32 v43, v47
    v_max_f32 v43, v43, v47
    v_sub_f32 v43, 0, v43
    v_and_b32 v47, 0xffff0000, v43
    v_sub_f32 v43, v43, v47
    v_and_b32 v46, 0xffff0000, v43
    v_sub_f32 v43, v43, v46
    v_lshrrev_b32 v47, 16, v47
    s_mov_b32 exec_lo, 0
    v_or_b32 v194, v47, v46
    v_lshrrev_b32 v195, 16, v43
    s_mov_b32 exec_lo, -1
    v_mfma_f32_32x32x8_bf16 v[60:75], v[244:245], v[188:189], 0
    v_mfma_f32_32x32x16_bf16 v[60:75], v[196:199], v[172:175], v[60:75]
    s_nop 15
    s_branch L_attn
L_bl1:
    s_mov_b32 s3, 1048576
L_bs1:
    ds_read_b32 v5, v25
    s_sub_u32 s3, s3, 1
    s_waitcnt lgkmcnt(0)
    s_cbranch_scc1 L_bk1
    v_cmp_gt_u32 vcc, 4, v5
    s_cbranch_vccnz L_bs1
    s_branch L_bk1
L_bl2:
    s_mov_b32 s3, 1048576
L_bs2:
    ds_read_b32 v5, v25
    s_sub_u32 s3, s3, 1
    s_waitcnt lgkmcnt(0)
    s_cbranch_scc1 L_bk2
    v_cmp_gt_u32 vcc, 8, v5
    s_cbranch_vccnz L_bs2
    s_branch L_bk2
L_bl3:
    s_mov_b32 s3, 1048576
L_bs3:
    ds_read_b32 v5, v25
    s_sub_u32 s3, s3, 1
    s_waitcnt lgkmcnt(0)
    s_cbranch_scc1 L_bk3
    v_cmp_gt_u32 vcc, 12, v5
    s_cbranch_vccnz L_bs3
    s_branch L_bk3
L_gulate:
    s_mov_b32 s3, 1048576
L_guspin:
    buffer_load_dwordx2 v[26:27], v1, s[44:47], s79 offen sc1
    s_sub_u32 s3, s3, 1
    s_waitcnt vmcnt(0)
    s_cbranch_scc1 L_guok
    v_xor_b32 v26, s60, v26
    v_xor_b32 v27, s13, v27
    v_or_b32 v26, v26, v27
    v_cmp_ne_u32 vcc, 0, v26
    s_cbranch_vccnz L_guspin
    s_branch L_guok
L_rplate:
    s_mov_b32 s3, 1048576
L_rpspin:
    buffer_load_dwordx2 v[26:27], v1, s[44:47], s79 offen sc1
    s_sub_u32 s3, s3, 1
    s_waitcnt vmcnt(0)
    s_cbranch_scc1 L_rpok
    v_xor_b32 v26, s60, v26
    v_xor_b32 v27, s13, v27
    v_or_b32 v26, v26, v27
    v_cmp_ne_u32 vcc, 0, v26
    s_cbranch_vccnz L_rpspin
    s_branch L_rpok
L_slow0:
    s_waitcnt vmcnt(0)
    buffer_wbl2 sc1
    s_waitcnt vmcnt(0)
    buffer_store_dword v10, v9, s[48:51], 0 offen sc1
    s_branch L_sigd0
L_late0:
    s_mov_b32 s3, 1048576
L_poll0:
    buffer_load_dword v59, v11, s[48:51], 0 offen sc1
    s_sub_u32 s3, s3, 1
    s_cbranch_scc1 L_pdone0
    s_waitcnt vmcnt(0)
    v_subrev_u32 v59, s60, v59
    v_cmp_gt_u32 vcc, 1, v59
    s_nop 0
    s_and_b64 vcc, vcc, s[86:87]
    s_cbranch_scc1 L_poll0
L_pdone0:
    s_cmp_eq_u32 s62, 0
    s_cbranch_scc1 L_pq0
    buffer_inv sc1
L_pq0:
    s_waitcnt vmcnt(0)
    s_branch L_go0
L_slow1:
    s_waitcnt vmcnt(0)
    buffer_wbl2 sc1
    s_waitcnt vmcnt(0)
    buffer_store_dword v10, v9, s[48:51], 0 offen sc1
    s_branch L_sigd1
L_slow2:
    s_waitcnt vmcnt(0)
    buffer_wbl2 sc1
    s_waitcnt vmcnt(0)
    buffer_store_dword v10, v9, s[48:51], 0 offen sc1
    s_branch L_sigd2
L_slow3:
    s_waitcnt vmcnt(0)
    buffer_wbl2 sc1
    s_waitcnt vmcnt(0)
    buffer_store_dword v10, v9, s[48:51], 0 offen sc1
    s_branch L_sigd3
L_late2:
    s_mov_b32 s3, 1048576
L_poll2:
    buffer_load_dword v91, v11, s[48:51], 0 offen sc1
    s_sub_u32 s3, s3, 1
    s_cbranch_scc1 L_pdone2
    s_waitcnt vmcnt(0)
    v_subrev_u32 v91, s60, v91
    v_cmp_gt_u32 vcc, 3, v91
    s_nop 0
    s_and_b64 vcc, vcc, s[86:87]
    s_cbranch_scc1 L_poll2
L_pdone2:
    s_cmp_eq_u32 s62, 0
    s_cbranch_scc1 L_pq2
    buffer_inv sc1
L_pq2:
    s_waitcnt vmcnt(0)
    s_branch L_go2
L_late3:
    s_mov_b32 s3, 1048576
L_poll3:
    buffer_load_dword v91, v11, s[48:51], 0 offen sc1
    s_sub_u32 s3, s3, 1
    s_cbranch_scc1 L_pdone3
    s_waitcnt vmcnt(0)
    v_subrev_u32 v91, s60, v91
    v_cmp_gt_u32 vcc, 4, v91
    s_nop 0
    s_and_b64 vcc, vcc, s[86:87]
    s_cbranch_scc1 L_poll3
L_pdone3:
    s_cmp_eq_u32 s62, 0
    s_cbranch_scc1 L_pq3
    buffer_inv sc1
L_pq3:
    s_waitcnt vmcnt(0)
    s_branch L_go3
L_slow4:
    s_waitcnt vmcnt(0)
    buffer_wbl2 sc1
    s_waitcnt vmcnt(0)
    buffer_store_dword v10, v9, s[48:51], 0 offen sc1
    s_branch L_sigd4
L_late4:
    s_mov_b32 s3, 1048576
L_poll4:
    buffer_load_dword v91, v11, s[48:51], 0 offen sc1
    s_sub_u32 s3, s3, 1
    s_cbranch_scc1 L_pdone4
    s_waitcnt vmcnt(0)
    v_subrev_u32 v91, s60, v91
    v_cmp_gt_u32 vcc, 5, v91
    s_nop 0
    s_and_b64 vcc, vcc, s[86:87]
    s_cbranch_scc1 L_poll4
L_pdone4:
    s_cmp_eq_u32 s62, 0
    s_cbranch_scc1 L_pq4
    buffer_inv sc1
L_pq4:
    s_waitcnt vmcnt(0)
    s_branch L_go4
L_slow5:
    s_waitcnt vmcnt(0)
    buffer_wbl2 sc1
    s_waitcnt vmcnt(0)
    buffer_store_dword v10, v9, s[48:51], 0 offen sc1
    s_branch L_sigd5
L_late5:
    s_mov_b32 s3, 1048576
L_poll5:
    buffer_load_dword v91, v11, s[48:51], 0 offen sc1
    s_sub_u32 s3, s3, 1
    s_cbranch_scc1 L_pdone5
    s_waitcnt vmcnt(0)
    v_subrev_u32 v91, s60, v91
    v_cmp_gt_u32 vcc, 6, v91
    s_nop 0
    s_and_b64 vcc, vcc, s[86:87]
    s_cbranch_scc1 L_poll5
L_pdone5:
    s_cmp_eq_u32 s62, 0
    s_cbranch_scc1 L_pq5
    buffer_inv sc1
L_pq5:
    s_waitcnt vmcnt(0)
    s_branch L_go5
L_wb2:
    buffer_wbl2 sc1
    s_branch L_wb2d
L_codeend:
.section .rodata,"a"
.p2align 6
.amdhsa_kernel sequential_preLN__grouped_kv_mqa__swiglu_ffn__prompt_kernel
  .amdhsa_next_free_vgpr 512
  .amdhsa_next_free_sgpr 102
  .amdhsa_accum_offset 256
  .amdhsa_group_segment_fixed_size 0
  .amdhsa_kernarg_size 96
  .amdhsa_user_sgpr_count 2
  .amdhsa_user_sgpr_kernarg_segment_ptr 1
  .amdhsa_system_sgpr_workgroup_id_x 1
.end_amdhsa_kernel
```
